```python
import torch

def _softmax(x, axis=-1):
    return torch.softmax(x, dim=axis)
def _gelu(x):
    return torch.nn.functional.gelu(x, approximate="tanh")
def _silu(x):
    return torch.nn.functional.silu(x)
def _sigmoid(x):
    return torch.sigmoid(x)
def _layernorm(x, axis=-1, eps=1e-5):
    m = x.mean(dim=axis, keepdim=True)
    v = x.var(dim=axis, keepdim=True, unbiased=False)
    return (x - m) / torch.sqrt(v + eps)
def _scatter_add(tgt, idx, src, axis=0):
    return tgt.clone().index_add_(axis, idx, src)
def _segment_sum(src, seg, n):
    out = torch.zeros((n,) + src.shape[1:], dtype=src.dtype)
    return out.index_add_(0, seg, src)
def _pad(x, pw):
    flat = tuple(v for pair in reversed(pw) for v in pair)
    return torch.nn.functional.pad(x, flat)

kernel_name = 'sequential_preLN__ssm_conv_h3__dense_activation_mish__prompt'

def setup_inputs():

    _w = (lambda a: (lambda t: t.to(torch.bfloat16) if t.is_floating_point() else t)(torch.as_tensor(a)))
    def _A_setup():
        B, S, D = 1, 2048, 576
        ks = 4
        return {
            "q": _w((lambda *s: torch.randn(*s, dtype=torch.bfloat16) * 0.05)(B, S, D)),
            "k": _w((lambda *s: torch.randn(*s, dtype=torch.bfloat16) * 0.2)(B, S, D)),
            "v": _w((lambda *s: torch.randn(*s, dtype=torch.bfloat16) * 0.2)(B, S, D)),
            "shift_k": _w((lambda *s: torch.randn(*s, dtype=torch.bfloat16) * 0.2)(D, ks) * 0.5),
            "ssm_k": _w((lambda *s: torch.randn(*s, dtype=torch.bfloat16) * 0.8)(D, S) * (1.0 / S ** 0.5)),
            "ssm_D": _w((lambda *s: torch.randn(*s, dtype=torch.bfloat16) * 0.2)(D)),
        }
    _A_in = _A_setup()

    def _B_setup():
        B, S, D, F = 1, 2048, 576, 4608
        return {
            "x": _w((lambda *s: torch.randn(*s, dtype=torch.bfloat16) * 0.05)(B, S, D)),
            "w1": _w((lambda *s: torch.randn(*s, dtype=torch.bfloat16) * 0.8)(D, F) * (D ** -0.5)),
            "b1": _w((lambda *s: torch.randn(*s, dtype=torch.bfloat16) * 0.2)(F)),
            "w2": _w((lambda *s: torch.randn(*s, dtype=torch.bfloat16) * 0.1)(F, D) * (F ** -0.5)),
        }
    _B_in = _B_setup()

    return {
        "A_q": _A_in["q"],
        "A_k": _A_in["k"],
        "A_v": _A_in["v"],
        "A_shift_k": _A_in["shift_k"],
        "A_ssm_k": _A_in["ssm_k"],
        "A_ssm_D": _A_in["ssm_D"],
        "B_x": _B_in["x"],
        "B_w1": _B_in["w1"],
        "B_b1": _B_in["b1"],
        "B_w2": _B_in["w2"],
    }

def reference(A_q, A_k, A_v, A_shift_k, A_ssm_k, A_ssm_D, B_x, B_w1, B_b1, B_w2):
    def _A_ref(q, k, v, shift_k, ssm_k, ssm_D):
        B, S, D = q.shape
        ks = shift_k.shape[-1]
        k_pad = _pad(k, ((0, 0), (ks - 1, 0), (0, 0)))
        k_shift = torch.zeros_like(k)
        for t in range(ks):
            k_shift = k_shift + k_pad[:, t:t + S, :] * shift_k[:, ks - 1 - t][None, None, :]
        kv = k_shift * v
        L = 2 * S
        kv_pad = _pad(kv, ((0, 0), (0, S), (0, 0)))
        kf_pad = _pad(ssm_k, ((0, 0), (0, S)))
        kv_f = (lambda x, axes=(-2,-1): torch.fft.rfft2(x.float(), dim=axes))(kv_pad[:, None, :, :], axes=(1, 2))
        kf_f = (lambda x, axes=(-2,-1): torch.fft.rfft2(x.float(), dim=axes))(kf_pad[:, None, :], axes=(1, 2))
        kf_f = (lambda x, *d: x.permute(*d))(kf_f, 1, 2, 0)
        y_f = kv_f * kf_f[None, :, :, :]
        y = (lambda x, s, axes=(-2,-1): torch.fft.irfft2(x, s=s, dim=axes).to(torch.bfloat16))(y_f, (1, L), axes=(1, 2))[:, 0, :S, :]
        y = y + kv * ssm_D[None, None, :]
        return q * y

    def _B_ref(x, w1, b1, w2):
        h = torch.einsum("bsd,df->bsf", x, w1) + b1
        sp = torch.log1p(torch.exp(-torch.abs(h))) + torch.where(h > 0, h, torch.zeros_like(h))
        act = h * torch.tanh(sp)
        return torch.einsum("bsf,fd->bsd", act, w2)

    x = A_q
    h = x + _A_ref(_layernorm(x, axis=-1), A_k, A_v, A_shift_k, A_ssm_k, A_ssm_D)
    h2 = h + _B_ref(_layernorm(h, axis=-1), B_w1, B_b1, B_w2)
    return h2
```

```asm
; @launch grid=(256,1,1) block=(256,1,1) lds=152576
.amdgcn_target "amdgcn-amd-amdhsa--gfx950"
.text
.globl sequential_preLN__ssm_conv_h3__dense_activation_mish__prompt_kernel
.p2align 8
.type sequential_preLN__ssm_conv_h3__dense_activation_mish__prompt_kernel,@function
sequential_preLN__ssm_conv_h3__dense_activation_mish__prompt_kernel:
  s_cmp_ge_u32 s2, 256
  s_cbranch_scc1 L_end
  s_load_dwordx4 s[8:11], s[0:1], 0
  s_load_dwordx4 s[12:15], s[0:1], 16
  s_load_dwordx2 s[4:5], s[0:1], 96
  s_load_dwordx4 s[48:51], s[0:1], 32
  s_load_dwordx4 s[56:59], s[0:1], 56
  s_load_dwordx4 s[60:63], s[0:1], 72
  v_lshrrev_b32 v1, 6, v0
  v_and_b32 v0, 63, v0
  v_readfirstlane_b32 s3, v1
  v_and_b32 v3, 15, v0
  v_lshrrev_b32 v4, 4, v0
  v_lshlrev_b32 v5, 4, v0
  s_mul_i32 s33, s2, 9216
  s_add_u32 s34, s3, 3
  s_and_b32 s34, s34, 3
  s_lshl_b32 s34, s34, 10
  s_add_u32 s35, s3, 2
  s_and_b32 s35, s35, 3
  s_lshl_b32 s35, s35, 10
  s_add_u32 s36, s3, 1
  s_and_b32 s36, s36, 3
  s_lshl_b32 s36, s36, 10
  s_add_u32 s37, s33, s34
  s_add_u32 s38, s33, s36
  s_add_u32 s39, s33, s35
  s_sub_u32 s39, s39, 3456
  v_add_u32 v8, s39, v5
  s_and_b32 s64, s2, 7
  s_mul_i32 s64, s64, 18
  s_lshr_b32 s65, s2, 3
  s_add_u32 s64, s64, s65
  s_lshl_b32 s65, s64, 2
  s_add_u32 s66, s65, s3
  s_cmp_lt_u32 s2, 144
  s_cselect_b32 s7, s66, 0
  s_and_b32 s7, s7, 0xfffffffe
  s_lshl_b32 s7, s7, 1
  v_lshlrev_b32 v2, 3, v0
  s_lshl_b32 s40, s3, 9
  s_add_u32 s41, s40, 2048
  s_cmp_eq_u32 s3, 0
  s_cselect_b32 s42, 4096, 0x40000000
  s_waitcnt lgkmcnt(0)
  s_mov_b32 s16, s8
  s_mov_b32 s17, s9
  s_mov_b32 s18, 2359296
  s_mov_b32 s19, 0x20000
  s_mov_b32 s20, s10
  s_mov_b32 s21, s11
  s_mov_b32 s22, 2359296
  s_mov_b32 s23, 0x20000
  s_mov_b32 s24, s12
  s_mov_b32 s25, s13
  s_mov_b32 s26, 2359296
  s_mov_b32 s27, 0x20000
  s_add_u32 m0, s34, 0
  s_nop 0
  buffer_load_dwordx4 v5, s[16:19], s37 offen lds
  s_add_u32 s37, s37, 4096
  s_add_u32 m0, s34, 4096
  s_nop 0
  buffer_load_dwordx4 v5, s[16:19], s37 offen lds
  s_add_u32 s37, s37, 4096
  s_add_u32 m0, s35, 11264
  s_nop 0
  buffer_load_dwordx4 v8, s[20:23], 0 offen lds
  v_add_u32 v8, 0x1000, v8
  s_add_u32 m0, s35, 15360
  s_nop 0
  buffer_load_dwordx4 v8, s[20:23], 0 offen lds
  v_add_u32 v8, 0x1000, v8
  s_add_u32 m0, s35, 19456
  s_nop 0
  buffer_load_dwordx4 v8, s[20:23], 0 offen lds
  v_add_u32 v8, 0x1000, v8
  s_add_u32 m0, s36, 24576
  s_nop 0
  buffer_load_dwordx4 v5, s[24:27], s38 offen lds
  s_add_u32 s38, s38, 4096
  s_add_u32 m0, s36, 28672
  s_nop 0
  buffer_load_dwordx4 v5, s[24:27], s38 offen lds
  s_add_u32 s38, s38, 4096
  s_cmp_lg_u32 s34, 0
  s_cbranch_scc1 L1_x
  s_movk_i32 m0, 8192
  s_nop 0
  buffer_load_dwordx4 v5, s[16:19], s37 offen lds
L1_x:
  s_cmp_lg_u32 s35, 0
  s_cbranch_scc1 L2_x
  s_movk_i32 m0, 23552
  s_nop 0
  buffer_load_dwordx4 v8, s[20:23], 0 offen lds
L2_x:
  s_cmp_lg_u32 s36, 0
  s_cbranch_scc1 L3_x
  s_mov_b32 m0, 32768
  s_nop 0
  buffer_load_dwordx4 v5, s[24:27], s38 offen lds
L3_x:
  s_mov_b32 s28, s14
  s_mov_b32 s29, s15
  s_mov_b32 s30, 4608
  s_mov_b32 s31, 0x20000
  s_add_u32 s52, s4, 41943040
  s_addc_u32 s53, s5, 0
  s_mov_b32 s54, 655360
  s_mov_b32 s55, 0x20000
  buffer_load_dword v250, off, s[52:55], 0 sc1
  buffer_load_dwordx2 v[10:11], v2, s[28:31], s40 offen
  buffer_load_dwordx2 v[12:13], v2, s[28:31], s41 offen
  buffer_load_dwordx2 v[14:15], v2, s[28:31], s42 offen
  s_load_dword s7, s[50:51], s7
  s_getpc_b64 s[16:17]
L4_pc:
  s_cmp_ge_u32 s2, 240
  s_cselect_b32 s19, -1, 0
  s_lshl_b32 s18, s3, 13
  v_lshl_add_u32 v6, v0, 7, s18
  v_min_u32 v249, code_pf_end-L4_pc-4, v6
  v_and_b32 v249, s19, v249
  global_load_dword v248, v249, s[16:17]
  v_add_u32 v6, 0x8000, v6
  v_min_u32 v249, code_pf_end-L4_pc-4, v6
  v_and_b32 v249, s19, v249
  global_load_dword v251, v249, s[16:17]
  v_add_u32 v6, 0x8000, v6
  s_mov_b32 s44, s48
  s_mov_b32 s45, s49
  s_mov_b32 s46, 2359296
  s_mov_b32 s47, 0x20000
  s_lshl_b32 s67, s66, 12
  s_cmp_lt_u32 s2, 144
  s_cselect_b32 s67, s67, 0x40000000
  buffer_load_dwordx4 v[192:195], v5, s[44:47], s67 offen offset:0
  buffer_load_dwordx4 v[208:211], v5, s[44:47], s67 offen offset:4
  buffer_load_dwordx4 v[224:227], v5, s[44:47], s67 offen offset:8
  buffer_load_dwordx4 v[196:199], v5, s[44:47], s67 offen offset:1024
  buffer_load_dwordx4 v[212:215], v5, s[44:47], s67 offen offset:1028
  buffer_load_dwordx4 v[228:231], v5, s[44:47], s67 offen offset:1032
  buffer_load_dwordx4 v[200:203], v5, s[44:47], s67 offen offset:2048
  buffer_load_dwordx4 v[216:219], v5, s[44:47], s67 offen offset:2052
  buffer_load_dwordx4 v[232:235], v5, s[44:47], s67 offen offset:2056
  buffer_load_dwordx4 v[204:207], v5, s[44:47], s67 offen offset:3072
  buffer_load_dwordx4 v[220:223], v5, s[44:47], s67 offen offset:3076
  buffer_load_dwordx4 v[236:239], v5, s[44:47], s67 offen offset:3080
  s_mov_b32 s36, s4
  s_mov_b32 s37, s5
  s_mov_b32 s38, 4718592
  s_mov_b32 s39, 0x20000
  s_add_u32 s40, s4, 7077888
  s_addc_u32 s41, s5, 0
  s_mov_b32 s42, 16384
  s_mov_b32 s43, 0x20000
  s_mov_b32 s8, 0x3f803f80
  s_mov_b32 s9, 0xffff0000
  v_lshrrev_b32 v6, 2, v3
  v_mul_u32_u24 v6, 1152, v6
  v_and_b32 v7, 3, v3
  v_lshl_add_u32 v6, v7, 3, v6
  v_lshl_add_u32 v6, v4, 5, v6
  s_lshl_b32 s12, s3, 7
  v_add_u32 v6, s12, v6
  s_lshl_b32 s12, s3, 10
  s_add_u32 s14, s33, s12
  s_add_u32 s15, s14, 2359296
  s_mul_i32 s12, s3, 2304
  v_add_u32 v7, s12, v5
  v_and_b32 v9, 31, v0
  v_lshl_add_u32 v9, v9, 2, s12
  s_waitcnt vmcnt(14) lgkmcnt(0)
  s_barrier
  v_readfirstlane_b32 s6, v250
  ds_read_b64_tr_b16 v[20:21], v6 offset:10112
  ds_read_b64_tr_b16 v[22:23], v6 offset:14720
  ds_read_b64_tr_b16 v[24:25], v6 offset:19328
  ds_read_b64_tr_b16 v[26:27], v6 offset:24576
  ds_read_b64_tr_b16 v[28:29], v6 offset:29184
  ds_read_b64_tr_b16 v[36:37], v6 offset:10624
  ds_read_b64_tr_b16 v[38:39], v6 offset:15232
  ds_read_b64_tr_b16 v[40:41], v6 offset:19840
  ds_read_b64_tr_b16 v[42:43], v6 offset:25088
  ds_read_b64_tr_b16 v[44:45], v6 offset:29696
  s_add_u32 s6, s6, 2654435761
  s_or_b32 s6, s6, 1
  v_lshlrev_b32 v112, 16, v10
  v_and_b32 v113, s9, v10
  v_lshlrev_b32 v114, 16, v11
  v_and_b32 v115, s9, v11
  s_waitcnt lgkmcnt(9)
  v_and_b32 v100, s9, v20
  v_lshlrev_b32 v101, 16, v21
  v_and_b32 v102, s9, v21
  s_waitcnt lgkmcnt(8)
  v_lshlrev_b32 v103, 16, v22
  v_and_b32 v104, s9, v22
  v_lshlrev_b32 v105, 16, v23
  v_and_b32 v106, s9, v23
  s_waitcnt lgkmcnt(7)
  v_lshlrev_b32 v107, 16, v24
  v_and_b32 v108, s9, v24
  v_lshlrev_b32 v109, 16, v25
  v_and_b32 v110, s9, v25
  v_mul_f32 v124, v100, v115
  v_mul_f32 v125, v101, v115
  v_mul_f32 v126, v102, v115
  v_mul_f32 v127, v103, v115
  v_mul_f32 v128, v104, v115
  v_mul_f32 v129, v105, v115
  v_mul_f32 v130, v106, v115
  v_mul_f32 v131, v107, v115
  v_fmac_f32 v124, v101, v114
  v_fmac_f32 v125, v102, v114
  v_fmac_f32 v126, v103, v114
  v_fmac_f32 v127, v104, v114
  v_fmac_f32 v128, v105, v114
  v_fmac_f32 v129, v106, v114
  v_fmac_f32 v130, v107, v114
  v_fmac_f32 v131, v108, v114
  v_fmac_f32 v124, v102, v113
  v_fmac_f32 v125, v103, v113
  v_fmac_f32 v126, v104, v113
  v_fmac_f32 v127, v105, v113
  v_fmac_f32 v128, v106, v113
  v_fmac_f32 v129, v107, v113
  v_fmac_f32 v130, v108, v113
  v_fmac_f32 v131, v109, v113
  v_fmac_f32 v124, v103, v112
  v_fmac_f32 v125, v104, v112
  v_fmac_f32 v126, v105, v112
  v_fmac_f32 v127, v106, v112
  v_fmac_f32 v128, v107, v112
  v_fmac_f32 v129, v108, v112
  v_fmac_f32 v130, v109, v112
  v_fmac_f32 v131, v110, v112
  s_waitcnt lgkmcnt(6)
  v_lshlrev_b32 v116, 16, v26
  v_and_b32 v117, s9, v26
  v_lshlrev_b32 v118, 16, v27
  v_and_b32 v119, s9, v27
  s_waitcnt lgkmcnt(5)
  v_lshlrev_b32 v120, 16, v28
  v_and_b32 v121, s9, v28
  v_lshlrev_b32 v122, 16, v29
  v_and_b32 v123, s9, v29
  v_mul_f32 v124, v124, v116
  v_mul_f32 v125, v125, v117
  v_mul_f32 v126, v126, v118
  v_mul_f32 v127, v127, v119
  v_mul_f32 v128, v128, v120
  v_mul_f32 v129, v129, v121
  v_mul_f32 v130, v130, v122
  v_mul_f32 v131, v131, v123
  v_cvt_pk_bf16_f32 v20, v131, v130
  v_cvt_pk_bf16_f32 v21, v129, v128
  v_cvt_pk_bf16_f32 v22, v127, v126
  v_cvt_pk_bf16_f32 v23, v125, v124
  s_add_u32 s16, s14, 0
  buffer_store_dwordx4 v[20:23], v5, s[36:39], s16 offen sc1
  ds_read_b64_tr_b16 v[52:53], v6 offset:11136
  ds_read_b64_tr_b16 v[54:55], v6 offset:15744
  ds_read_b64_tr_b16 v[56:57], v6 offset:20352
  ds_read_b64_tr_b16 v[58:59], v6 offset:25600
  ds_read_b64_tr_b16 v[60:61], v6 offset:30208
  ds_read_b64_tr_b16 v[16:17], v6 offset:0
  ds_read_b64_tr_b16 v[18:19], v6 offset:4608
  ds_read_b64_tr_b16 v[32:33], v6 offset:512
  ds_read_b64_tr_b16 v[34:35], v6 offset:5120
  ds_read_b64_tr_b16 v[48:49], v6 offset:1024
  ds_read_b64_tr_b16 v[50:51], v6 offset:5632
  ds_read_b128 v[64:67], v7 offset:0
  ds_read_b32 v68, v9 offset:1024
  ds_read_b128 v[70:73], v7 offset:1152
  ds_read_b32 v74, v9 offset:2176
  v_lshlrev_b32 v112, 16, v12
  v_and_b32 v113, s9, v12
  v_lshlrev_b32 v114, 16, v13
  v_and_b32 v115, s9, v13
  s_waitcnt lgkmcnt(15)
  v_and_b32 v100, s9, v36
  v_lshlrev_b32 v101, 16, v37
  v_and_b32 v102, s9, v37
  v_lshlrev_b32 v103, 16, v38
  v_and_b32 v104, s9, v38
  v_lshlrev_b32 v105, 16, v39
  v_and_b32 v106, s9, v39
  v_lshlrev_b32 v107, 16, v40
  v_and_b32 v108, s9, v40
  v_lshlrev_b32 v109, 16, v41
  v_and_b32 v110, s9, v41
  v_mul_f32 v124, v100, v115
  v_mul_f32 v125, v101, v115
  v_mul_f32 v126, v102, v115
  v_mul_f32 v127, v103, v115
  v_mul_f32 v128, v104, v115
  v_mul_f32 v129, v105, v115
  v_mul_f32 v130, v106, v115
  v_mul_f32 v131, v107, v115
  v_fmac_f32 v124, v101, v114
  v_fmac_f32 v125, v102, v114
  v_fmac_f32 v126, v103, v114
  v_fmac_f32 v127, v104, v114
  v_fmac_f32 v128, v105, v114
  v_fmac_f32 v129, v106, v114
  v_fmac_f32 v130, v107, v114
  v_fmac_f32 v131, v108, v114
  v_fmac_f32 v124, v102, v113
  v_fmac_f32 v125, v103, v113
  v_fmac_f32 v126, v104, v113
  v_fmac_f32 v127, v105, v113
  v_fmac_f32 v128, v106, v113
  v_fmac_f32 v129, v107, v113
  v_fmac_f32 v130, v108, v113
  v_fmac_f32 v131, v109, v113
  v_fmac_f32 v124, v103, v112
  v_fmac_f32 v125, v104, v112
  v_fmac_f32 v126, v105, v112
  v_fmac_f32 v127, v106, v112
  v_fmac_f32 v128, v107, v112
  v_fmac_f32 v129, v108, v112
  v_fmac_f32 v130, v109, v112
  v_fmac_f32 v131, v110, v112
  v_lshlrev_b32 v116, 16, v42
  v_and_b32 v117, s9, v42
  v_lshlrev_b32 v118, 16, v43
  v_and_b32 v119, s9, v43
  v_lshlrev_b32 v120, 16, v44
  v_and_b32 v121, s9, v44
  v_lshlrev_b32 v122, 16, v45
  v_and_b32 v123, s9, v45
  v_mul_f32 v124, v124, v116
  v_mul_f32 v125, v125, v117
  v_mul_f32 v126, v126, v118
  v_mul_f32 v127, v127, v119
  v_mul_f32 v128, v128, v120
  v_mul_f32 v129, v129, v121
  v_mul_f32 v130, v130, v122
  v_mul_f32 v131, v131, v123
  v_cvt_pk_bf16_f32 v36, v131, v130
  v_cvt_pk_bf16_f32 v37, v129, v128
  v_cvt_pk_bf16_f32 v38, v127, v126
  v_cvt_pk_bf16_f32 v39, v125, v124
  s_add_u32 s16, s14, 4096
  buffer_store_dwordx4 v[36:39], v5, s[36:39], s16 offen sc1
  s_cmp_lg_u32 s3, 0
  s_cbranch_scc1 L5_w0
  v_lshlrev_b32 v112, 16, v14
  v_and_b32 v113, s9, v14
  v_lshlrev_b32 v114, 16, v15
  v_and_b32 v115, s9, v15
  s_waitcnt lgkmcnt(14)
  v_and_b32 v100, s9, v52
  v_lshlrev_b32 v101, 16, v53
  v_and_b32 v102, s9, v53
  s_waitcnt lgkmcnt(13)
  v_lshlrev_b32 v103, 16, v54
  v_and_b32 v104, s9, v54
  v_lshlrev_b32 v105, 16, v55
  v_and_b32 v106, s9, v55
  s_waitcnt lgkmcnt(12)
  v_lshlrev_b32 v107, 16, v56
  v_and_b32 v108, s9, v56
  v_lshlrev_b32 v109, 16, v57
  v_and_b32 v110, s9, v57
  v_mul_f32 v124, v100, v115
  v_mul_f32 v125, v101, v115
  v_mul_f32 v126, v102, v115
  v_mul_f32 v127, v103, v115
  v_mul_f32 v128, v104, v115
  v_mul_f32 v129, v105, v115
  v_mul_f32 v130, v106, v115
  v_mul_f32 v131, v107, v115
  v_fmac_f32 v124, v101, v114
  v_fmac_f32 v125, v102, v114
  v_fmac_f32 v126, v103, v114
  v_fmac_f32 v127, v104, v114
  v_fmac_f32 v128, v105, v114
  v_fmac_f32 v129, v106, v114
  v_fmac_f32 v130, v107, v114
  v_fmac_f32 v131, v108, v114
  v_fmac_f32 v124, v102, v113
  v_fmac_f32 v125, v103, v113
  v_fmac_f32 v126, v104, v113
  v_fmac_f32 v127, v105, v113
  v_fmac_f32 v128, v106, v113
  v_fmac_f32 v129, v107, v113
  v_fmac_f32 v130, v108, v113
  v_fmac_f32 v131, v109, v113
  v_fmac_f32 v124, v103, v112
  v_fmac_f32 v125, v104, v112
  v_fmac_f32 v126, v105, v112
  v_fmac_f32 v127, v106, v112
  v_fmac_f32 v128, v107, v112
  v_fmac_f32 v129, v108, v112
  v_fmac_f32 v130, v109, v112
  v_fmac_f32 v131, v110, v112
  s_waitcnt lgkmcnt(11)
  v_lshlrev_b32 v116, 16, v58
  v_and_b32 v117, s9, v58
  v_lshlrev_b32 v118, 16, v59
  v_and_b32 v119, s9, v59
  s_waitcnt lgkmcnt(10)
  v_lshlrev_b32 v120, 16, v60
  v_and_b32 v121, s9, v60
  v_lshlrev_b32 v122, 16, v61
  v_and_b32 v123, s9, v61
  v_mul_f32 v124, v124, v116
  v_mul_f32 v125, v125, v117
  v_mul_f32 v126, v126, v118
  v_mul_f32 v127, v127, v119
  v_mul_f32 v128, v128, v120
  v_mul_f32 v129, v129, v121
  v_mul_f32 v130, v130, v122
  v_mul_f32 v131, v131, v123
  v_cvt_pk_bf16_f32 v52, v131, v130
  v_cvt_pk_bf16_f32 v53, v129, v128
  v_cvt_pk_bf16_f32 v54, v127, v126
  v_cvt_pk_bf16_f32 v55, v125, v124
  s_add_u32 s16, s14, 8192
  buffer_store_dwordx4 v[52:55], v5, s[36:39], s16 offen sc1
L5_w0:
  s_add_u32 s16, s15, 0
  s_waitcnt lgkmcnt(8)
  buffer_store_dwordx4 v[16:19], v5, s[36:39], s16 offen sc1
  s_add_u32 s16, s15, 4096
  s_waitcnt lgkmcnt(6)
  buffer_store_dwordx4 v[32:35], v5, s[36:39], s16 offen sc1
  s_cmp_eq_u32 s3, 0
  s_cselect_b32 s15, s15, 0x40000000
  s_add_u32 s16, s15, 8192
  s_waitcnt lgkmcnt(4)
  buffer_store_dwordx4 v[48:51], v5, s[36:39], s16 offen sc1
  v_cmp_gt_u32 vcc, 32, v0
  s_waitcnt lgkmcnt(2)
  s_nop 0
  v_cndmask_b32 v68, 0, v68, vcc
  s_waitcnt lgkmcnt(0)
  v_cndmask_b32 v74, 0, v74, vcc
  v_dot2_f32_bf16 v80, v64, s8, 0
  v_dot2_f32_bf16 v82, v64, v64, 0
  v_dot2_f32_bf16 v81, v70, s8, 0
  v_dot2_f32_bf16 v83, v70, v70, 0
  v_dot2_f32_bf16 v80, v65, s8, v80
  v_dot2_f32_bf16 v82, v65, v65, v82
  v_dot2_f32_bf16 v81, v71, s8, v81
  v_dot2_f32_bf16 v83, v71, v71, v83
  v_dot2_f32_bf16 v80, v66, s8, v80
  v_dot2_f32_bf16 v82, v66, v66, v82
  v_dot2_f32_bf16 v81, v72, s8, v81
  v_dot2_f32_bf16 v83, v72, v72, v83
  v_dot2_f32_bf16 v80, v67, s8, v80
  v_dot2_f32_bf16 v82, v67, v67, v82
  v_dot2_f32_bf16 v81, v73, s8, v81
  v_dot2_f32_bf16 v83, v73, v73, v83
  v_dot2_f32_bf16 v80, v68, s8, v80
  v_dot2_f32_bf16 v82, v68, v68, v82
  v_dot2_f32_bf16 v81, v74, s8, v81
  v_dot2_f32_bf16 v83, v74, v74, v83
  s_nop 0
  v_permlane32_swap_b32 v80, v82
  s_nop 0
  v_permlane32_swap_b32 v81, v83
  v_add_f32 v80, v80, v82
  v_add_f32 v81, v81, v83
  s_nop 1
  v_permlane16_swap_b32 v80, v81
  v_add_f32 v80, v80, v81
  s_nop 1
  v_add_f32_dpp v80, v80, v80 row_ror:8 row_mask:0xf bank_mask:0xf
  s_nop 1
  v_add_f32_dpp v80, v80, v80 row_ror:4 row_mask:0xf bank_mask:0xf
  s_nop 1
  v_add_f32_dpp v80, v80, v80 row_ror:2 row_mask:0xf bank_mask:0xf
  s_nop 1
  v_add_f32_dpp v80, v80, v80 row_ror:1 row_mask:0xf bank_mask:0xf
  v_mov_b32 v82, v80
  s_nop 1
  v_permlane32_swap_b32 v80, v82
  s_mov_b32 s17, 0x3ae38e39
  v_mul_f32 v80, s17, v80
  v_mul_f32 v82, s17, v82
  v_fma_f32 v82, -v80, v80, v82
  v_max_f32 v82, 0, v82
  v_cvt_pk_bf16_f32 v80, v80, v82
  v_lshlrev_b32 v84, 16, v80
  v_and_b32 v82, 0xffff0000, v80
  v_add_f32 v82, 0x3727c5ac, v82
  v_cvt_pk_bf16_f32 v82, v82, v82
  v_and_b32 v82, 0xffff0000, v82
  v_sqrt_f32 v82, v82
  s_nop 0
  v_cvt_pk_bf16_f32 v82, v82, v82
  v_and_b32 v85, 0xffff0000, v82
  v_rcp_f32 v85, v85
  v_mov_b32 v87, 2146435072
  v_lshlrev_b32 v86, 2, v4
  v_cmp_eq_u32 vcc, 0, v3
  s_nop 1
  v_cndmask_b32 v86, v87, v86, vcc
  v_cmp_gt_u32 vcc, 32, v0
  s_nop 1
  v_cndmask_b32 v86, v87, v86, vcc
  s_lshl_b32 s18, s2, 5
  s_lshl_b32 s19, s3, 3
  s_add_u32 s18, s18, s19
  s_add_u32 s19, s18, 8192
  buffer_store_dword v84, v86, s[40:43], s18 offen sc1
  buffer_store_dword v85, v86, s[40:43], s19 offen sc1
  s_cmp_ge_u32 s2, 144
  s_cbranch_scc1 L_notconv
code_pf_begin:
  s_mov_b32 s20, s4
  s_mov_b32 s21, s5
  s_mov_b32 s22, 4718592
  s_mov_b32 s23, 0x20000
  s_add_u32 s24, s4, 7077888
  s_addc_u32 s25, s5, 0
  s_mov_b32 s26, 16384
  s_mov_b32 s27, 0x20000
  s_add_u32 s28, s4, 4718592
  s_addc_u32 s29, s5, 0
  s_mov_b32 s30, 2359296
  s_mov_b32 s31, 0x20000
  s_mul_i32 s39, s3, 16640
  v_add_u32 v10, s39, v5
  s_mul_i32 s40, s3, 4576
  s_add_u32 s40, s40, 66560
  v_add_u32 v11, s40, v5
  v_mov_b32 v88, 0
  v_mov_b32 v89, 0
  v_mov_b32 v90, 0
  v_mov_b32 v91, 0
  s_mov_b32 exec_lo, 0x3fffffff
  s_mov_b32 exec_hi, 0
  ds_write_b128 v11, v[88:91]
  s_mov_b64 exec, -1
  s_and_b32 s46, s66, 1
  s_lshl_b32 s46, s46, 4
  s_lshr_b32 s7, s7, s46
  s_and_b32 s7, s7, 0xffff
  v_lshlrev_b32 v14, 3, v4
  v_add_u32 v14, v14, v3
  v_sub_u32 v14, 15, v14
  v_and_b32 v15, 1, v14
  v_lshlrev_b32 v15, 4, v15
  v_lshlrev_b32 v15, v15, s7
  v_ashrrev_i32 v14, 1, v14
  v_cmp_eq_u32 vcc, 0, v14
  s_nop 1
  v_cndmask_b32 v96, 0, v15, vcc
  v_cmp_eq_u32 vcc, 1, v14
  s_nop 1
  v_cndmask_b32 v97, 0, v15, vcc
  v_cmp_eq_u32 vcc, 2, v14
  s_nop 1
  v_cndmask_b32 v98, 0, v15, vcc
  v_cmp_eq_u32 vcc, 3, v14
  s_nop 1
  v_cndmask_b32 v99, 0, v15, vcc
  v_lshrrev_b32 v6, 2, v0
  v_lshl_add_u32 v6, s3, 6, v6
  v_and_b32 v7, 3, v0
  s_movk_i32 s34, 9216
  v_mul_lo_u32 v8, v6, s34
  v_add_u32 v9, s65, v7
  v_lshl_add_u32 v8, v9, 4, v8
  s_movk_i32 s34, 4576
  v_mul_lo_u32 v9, v7, s34
  v_lshl_add_u32 v9, v6, 4, v9
  v_add_u32 v9, 67040, v9
  v_and_b32 v12, 3, v3
  s_movk_i32 s34, 4160
  v_mul_lo_u32 v12, v12, s34
  v_lshl_add_u32 v12, v4, 4, v12
  v_lshrrev_b32 v13, 2, v3
  v_lshl_add_u32 v12, v13, 3, v12
  v_add_u32 v12, s39, v12
  v_lshlrev_b32 v13, 5, v3
  v_lshlrev_b32 v14, 4, v4
  v_sub_u32 v13, v13, v14
  s_add_u32 s41, s40, 48
  v_add_u32 v13, s41, v13
  v_lshrrev_b32 v14, 1, v4
  v_lshlrev_b32 v14, 6, v14
  v_lshl_add_u32 v14, v3, 7, v14
  v_and_b32 v15, 1, v4
  v_lshl_add_u32 v14, v15, 3, v14
  s_lshl_b32 s46, s3, 4
  s_add_u32 s46, s46, 84992
  v_add_u32 v14, s46, v14
  v_lshlrev_b32 v15, 6, v3
  v_lshl_add_u32 v15, v4, 4, v15
  v_add_u32 v15, 101376, v15
  s_movk_i32 s34, 4160
  v_mul_lo_u32 v100, v0, s34
  v_add_u32 v100, s39, v100
  v_add_u32 v2, 0x800, v12
  s_lshl_b32 s17, s3, 13
  s_add_u32 s17, s17, 4096
  v_lshlrev_b32 v6, 7, v0
  s_waitcnt vmcnt(5)
  s_barrier
  s_cmp_lg_u32 s3, 0
  s_cbranch_scc1 L6_sa
  s_lshl_b32 s16, s2, 7
  s_add_u32 s16, s16, 4096
  s_mov_b64 exec, 1
  v_mov_b32 v250, s6
  buffer_store_dword v250, off, s[52:55], s16 sc1
  s_mov_b64 exec, -1
L6_sa:
  v_alignbyte_b32 v240, v208, v192, 2
  v_alignbyte_b32 v241, v209, v193, 2
  v_alignbyte_b32 v242, v210, v194, 2
  v_alignbyte_b32 v243, v211, v195, 2
  ds_write_b128 v10, v[240:243] offset:32
  ds_write_b128 v10, v[208:211] offset:4192
  v_alignbyte_b32 v244, v224, v208, 2
  v_alignbyte_b32 v245, v225, v209, 2
  v_alignbyte_b32 v246, v226, v210, 2
  v_alignbyte_b32 v247, v227, v211, 2
  ds_write_b128 v10, v[244:247] offset:8352
  ds_write_b128 v10, v[224:227] offset:12512
  v_readfirstlane_b32 s42, v192
  v_readfirstlane_b32 s43, v193
  v_alignbyte_b32 v240, v212, v196, 2
  v_alignbyte_b32 v241, v213, v197, 2
  v_alignbyte_b32 v242, v214, v198, 2
  v_alignbyte_b32 v243, v215, v199, 2
  ds_write_b128 v10, v[240:243] offset:1056
  ds_write_b128 v10, v[212:215] offset:5216
  v_alignbyte_b32 v244, v228, v212, 2
  v_alignbyte_b32 v245, v229, v213, 2
  v_alignbyte_b32 v246, v230, v214, 2
  v_alignbyte_b32 v247, v231, v215, 2
  ds_write_b128 v10, v[244:247] offset:9376
  ds_write_b128 v10, v[228:231] offset:13536
  s_lshl_b32 s44, s42, 16
  s_lshr_b32 s45, s42, 16
  s_lshl_b32 s46, s43, 16
  s_or_b32 s45, s45, s46
  v_mov_b32 v92, 0
  v_mov_b32 v93, 0
  v_mov_b32 v94, 0
  v_mov_b32 v95, s44
  v_writelane_b32 v94, s44, 2
  v_writelane_b32 v94, s42, 3
  v_writelane_b32 v95, s42, 1
  v_writelane_b32 v95, s45, 2
  v_writelane_b32 v95, s43, 3
  s_mov_b64 exec, 15
  ds_write_b128 v100, v[88:91]
  ds_write_b128 v100, v[92:95] offset:16
  s_mov_b64 exec, -1
  v_alignbyte_b32 v240, v216, v200, 2
  v_alignbyte_b32 v241, v217, v201, 2
  v_alignbyte_b32 v242, v218, v202, 2
  v_alignbyte_b32 v243, v219, v203, 2
  ds_write_b128 v10, v[240:243] offset:2080
  ds_write_b128 v10, v[216:219] offset:6240
  v_alignbyte_b32 v244, v232, v216, 2
  v_alignbyte_b32 v245, v233, v217, 2
  v_alignbyte_b32 v246, v234, v218, 2
  v_alignbyte_b32 v247, v235, v219, 2
  ds_write_b128 v10, v[244:247] offset:10400
  ds_write_b128 v10, v[232:235] offset:14560
  v_alignbyte_b32 v240, v220, v204, 2
  v_alignbyte_b32 v241, v221, v205, 2
  v_alignbyte_b32 v242, v222, v206, 2
  v_alignbyte_b32 v243, v223, v207, 2
  ds_write_b128 v10, v[240:243] offset:3104
  ds_write_b128 v10, v[220:223] offset:7264
  v_alignbyte_b32 v244, v236, v220, 2
  v_alignbyte_b32 v245, v237, v221, 2
  v_alignbyte_b32 v246, v238, v222, 2
  v_alignbyte_b32 v247, v239, v223, 2
  ds_write_b128 v10, v[244:247] offset:11424
  ds_write_b128 v10, v[236:239] offset:15584
  buffer_load_dword v7, v6, s[52:55], s17 offen sc1
  s_waitcnt vmcnt(1)
  s_barrier
  s_cmp_lg_u32 s3, 0
  s_cbranch_scc1 L7_sx
  s_lshl_b32 s13, s2, 7
  s_add_u32 s13, s13, 73728
  s_mov_b64 exec, 1
  v_mov_b32 v250, s6
  buffer_store_dword v250, off, s[52:55], s13 sc1
  s_mov_b64 exec, -1
L7_sx:
  s_waitcnt vmcnt(0)
  v_cmp_ne_u32 vcc, s6, v7
  s_nop 3
  s_cbranch_vccz L8_ok
  s_mov_b32 s7, 262144
L9_poll:
  buffer_load_dword v7, v6, s[52:55], s17 offen sc1
  s_waitcnt vmcnt(0)
  v_cmp_ne_u32 vcc, s6, v7
  s_sub_u32 s7, s7, 1
  s_cmp_eq_u32 s7, 0
  s_cbranch_scc1 L10_pollx
  s_nop 0
  s_cbranch_vccnz L9_poll
L10_pollx:
L8_ok:
  s_mov_b32 s38, 0
  buffer_load_dwordx4 v[16:19], v8, s[20:23], s38 offen sc1
  s_mov_b32 s38, 147456
  buffer_load_dwordx4 v[20:23], v8, s[20:23], s38 offen sc1
  s_mov_b32 s38, 294912
  buffer_load_dwordx4 v[24:27], v8, s[20:23], s38 offen sc1
  s_mov_b32 s38, 442368
  buffer_load_dwordx4 v[28:31], v8, s[20:23], s38 offen sc1
  s_lshl_b32 s42, s3, 12
  s_lshl_b32 s43, s3, 11
  s_waitcnt lgkmcnt(0)
  ds_read_b64 a[0:1], v12 offset:0
  ds_read_b64 a[2:3], v12 offset:8
  ds_read_b64 a[4:5], v12 offset:512
  ds_read_b64 a[6:7], v12 offset:520
  ds_read_b64 a[8:9], v12 offset:1024
  ds_read_b64 a[10:11], v12 offset:1032
  ds_read_b64 a[12:13], v12 offset:1536
  ds_read_b64 a[14:15], v12 offset:1544
  ds_read_b64 a[16:17], v12 offset:2048
  ds_read_b64 a[18:19], v12 offset:2056
  ds_read_b64 a[20:21], v12 offset:2560
  ds_read_b64 a[22:23], v12 offset:2568
  ds_read_b64 a[24:25], v12 offset:3072
  ds_read_b64 a[26:27], v12 offset:3080
  ds_read_b64 a[28:29], v12 offset:3584
  ds_read_b64 a[30:31], v12 offset:3592
  s_waitcnt vmcnt(3)
  ds_write_b128 v9, v[16:19] offset:0
  s_add_u32 s17, s17, 69632
  v_lshlrev_b32 v116, 7, v0
  buffer_load_dword v117, v116, s[52:55], s17 offen sc1
  s_waitcnt vmcnt(3)
  ds_write_b128 v9, v[20:23] offset:256
  s_waitcnt vmcnt(2)
  ds_write_b128 v9, v[24:27] offset:512
  s_waitcnt vmcnt(1)
  ds_write_b128 v9, v[28:31] offset:768
  s_waitcnt lgkmcnt(0)
  s_barrier
  ds_read_b128 a[32:35], v13 offset:448
  ds_read_b128 a[36:39], v13 offset:960
  ds_read_b128 a[40:43], v13 offset:1472
  ds_read_b128 a[44:47], v13 offset:1984
  ds_read_b128 a[48:51], v13 offset:2496
  ds_read_b128 a[52:55], v13 offset:3008
  ds_read_b128 a[56:59], v13 offset:3520
  ds_read_b128 a[60:63], v13 offset:4032
  s_waitcnt lgkmcnt(7)
  v_mfma_f32_16x16x32_bf16 v[144:147], a[0:3], a[32:35], 0
  ds_read_b64 a[64:65], v12 offset:64
  v_mfma_f32_16x16x32_bf16 v[144:147], v[96:99], a[32:35], v[144:147]
  ds_read_b64 a[66:67], v12 offset:72
  s_waitcnt lgkmcnt(8)
  v_mfma_f32_16x16x32_bf16 v[148:151], a[0:3], a[36:39], 0
  v_mfma_f32_16x16x32_bf16 v[148:151], a[4:7], a[32:35], v[148:151]
  ds_read_b128 a[96:99], v13 offset:384
  v_mfma_f32_16x16x32_bf16 v[148:151], v[96:99], a[36:39], v[148:151]
  s_waitcnt lgkmcnt(8)
  v_mfma_f32_16x16x32_bf16 v[152:155], a[0:3], a[40:43], 0
  ds_read_b64 a[68:69], v12 offset:576
  v_mfma_f32_16x16x32_bf16 v[152:155], a[4:7], a[36:39], v[152:155]
  v_mfma_f32_16x16x32_bf16 v[152:155], a[8:11], a[32:35], v[152:155]
  ds_read_b64 a[70:71], v12 offset:584
  v_mfma_f32_16x16x32_bf16 v[152:155], v[96:99], a[40:43], v[152:155]
  s_waitcnt lgkmcnt(9)
  v_mfma_f32_16x16x32_bf16 v[156:159], a[0:3], a[44:47], 0
  ds_read_b128 a[100:103], v13 offset:896
  v_mfma_f32_16x16x32_bf16 v[156:159], a[4:7], a[40:43], v[156:159]
  v_mfma_f32_16x16x32_bf16 v[156:159], a[8:11], a[36:39], v[156:159]
  ds_read_b64 a[72:73], v12 offset:1088
  v_mfma_f32_16x16x32_bf16 v[156:159], a[12:15], a[32:35], v[156:159]
  ds_read_b64 a[74:75], v12 offset:1096
  v_mfma_f32_16x16x32_bf16 v[156:159], v[96:99], a[44:47], v[156:159]
  s_waitcnt lgkmcnt(11)
  v_mfma_f32_16x16x32_bf16 v[160:163], a[0:3], a[48:51], 0
  ds_read_b128 a[104:107], v13 offset:1408
  v_mfma_f32_16x16x32_bf16 v[160:163], a[4:7], a[44:47], v[160:163]
  v_mfma_f32_16x16x32_bf16 v[160:163], a[8:11], a[40:43], v[160:163]
  ds_read_b64 a[76:77], v12 offset:1600
  v_mfma_f32_16x16x32_bf16 v[160:163], a[12:15], a[36:39], v[160:163]
  v_mfma_f32_16x16x32_bf16 v[160:163], a[16:19], a[32:35], v[160:163]
  ds_read_b64 a[78:79], v12 offset:1608
  v_mfma_f32_16x16x32_bf16 v[160:163], v[96:99], a[48:51], v[160:163]
  s_waitcnt lgkmcnt(13)
  v_mfma_f32_16x16x32_bf16 v[164:167], a[0:3], a[52:55], 0
  ds_read_b128 a[108:111], v13 offset:1920
  v_mfma_f32_16x16x32_bf16 v[164:167], a[4:7], a[48:51], v[164:167]
  v_mfma_f32_16x16x32_bf16 v[164:167], a[8:11], a[44:47], v[164:167]
  ds_read_b64 a[80:81], v12 offset:2112
  v_mfma_f32_16x16x32_bf16 v[164:167], a[12:15], a[40:43], v[164:167]
  ds_read_b64 a[82:83], v12 offset:2120
  v_mfma_f32_16x16x32_bf16 v[164:167], a[16:19], a[36:39], v[164:167]
  v_mfma_f32_16x16x32_bf16 v[164:167], a[20:23], a[32:35], v[164:167]
  ds_read_b128 a[112:115], v13 offset:2432
  v_mfma_f32_16x16x32_bf16 v[164:167], v[96:99], a[52:55], v[164:167]
  s_waitcnt lgkmcnt(15)
  v_mfma_f32_16x16x32_bf16 v[168:171], a[0:3], a[56:59], 0
  ds_read_b64 a[84:85], v12 offset:2624
  v_mfma_f32_16x16x32_bf16 v[168:171], a[4:7], a[52:55], v[168:171]
  v_mfma_f32_16x16x32_bf16 v[168:171], a[8:11], a[48:51], v[168:171]
  ds_read_b64 a[86:87], v12 offset:2632
  v_mfma_f32_16x16x32_bf16 v[168:171], a[12:15], a[44:47], v[168:171]
  v_mfma_f32_16x16x32_bf16 v[168:171], a[16:19], a[40:43], v[168:171]
  ds_read_b128 a[116:119], v13 offset:2944
  v_mfma_f32_16x16x32_bf16 v[168:171], a[20:23], a[36:39], v[168:171]
  v_mfma_f32_16x16x32_bf16 v[168:171], a[24:27], a[32:35], v[168:171]
  ds_read_b64 a[88:89], v12 offset:3136
  v_mfma_f32_16x16x32_bf16 v[168:171], v[96:99], a[56:59], v[168:171]
  ds_read_b64 a[90:91], v12 offset:3144
  v_mfma_f32_16x16x32_bf16 v[172:175], a[0:3], a[60:63], 0
  v_mfma_f32_16x16x32_bf16 v[172:175], a[4:7], a[56:59], v[172:175]
  ds_read_b128 a[120:123], v13 offset:3456
  v_mfma_f32_16x16x32_bf16 v[172:175], a[8:11], a[52:55], v[172:175]
  v_mfma_f32_16x16x32_bf16 v[172:175], a[12:15], a[48:51], v[172:175]
  ds_read_b64 a[92:93], v12 offset:3648
  v_mfma_f32_16x16x32_bf16 v[172:175], a[16:19], a[44:47], v[172:175]
  v_mfma_f32_16x16x32_bf16 v[172:175], a[20:23], a[40:43], v[172:175]
  ds_read_b64 a[94:95], v12 offset:3656
  v_mfma_f32_16x16x32_bf16 v[172:175], a[24:27], a[36:39], v[172:175]
  v_mfma_f32_16x16x32_bf16 v[172:175], a[28:31], a[32:35], v[172:175]
  ds_read_b128 a[124:127], v13 offset:3968
  v_mfma_f32_16x16x32_bf16 v[172:175], v[96:99], a[60:63], v[172:175]
  s_waitcnt vmcnt(0)
  v_cmp_ne_u32 vcc, s6, v117
  s_nop 3
  s_cbranch_vccz L11_ok
  s_mov_b32 s7, 262144
L12_poll:
  buffer_load_dword v117, v116, s[52:55], s17 offen sc1
  s_waitcnt vmcnt(0)
  v_cmp_ne_u32 vcc, s6, v117
  s_sub_u32 s7, s7, 1
  s_cmp_eq_u32 s7, 0
  s_cbranch_scc1 L13_pollx
  s_nop 0
  s_cbranch_vccnz L12_poll
L13_pollx:
L11_ok:
  s_waitcnt lgkmcnt(15)
  v_mfma_f32_16x16x32_bf16 v[144:147], a[64:67], a[96:99], v[144:147]
  s_add_u32 m0, s42, 84992
  s_mov_b32 s38, 2359296
  buffer_load_dwordx4 v8, s[20:23], s38 offen sc1 lds
  v_mfma_f32_16x16x32_bf16 v[148:151], a[64:67], a[100:103], v[148:151]
  s_add_u32 m0, s42, 86016
  s_mov_b32 s38, 2506752
  buffer_load_dwordx4 v8, s[20:23], s38 offen sc1 lds
  v_mfma_f32_16x16x32_bf16 v[148:151], a[68:71], a[96:99], v[148:151]
  s_add_u32 m0, s42, 87040
  s_mov_b32 s38, 2654208
  buffer_load_dwordx4 v8, s[20:23], s38 offen sc1 lds
  v_mfma_f32_16x16x32_bf16 v[152:155], a[64:67], a[104:107], v[152:155]
  s_add_u32 m0, s42, 88064
  s_mov_b32 s38, 2801664
  buffer_load_dwordx4 v8, s[20:23], s38 offen sc1 lds
  v_mfma_f32_16x16x32_bf16 v[152:155], a[68:71], a[100:103], v[152:155]
  s_add_u32 s38, s43, 0
  s_add_u32 m0, s38, 101376
  s_nop 0
  buffer_load_dwordx4 v5, s[24:27], s38 offen sc1 lds
  v_mfma_f32_16x16x32_bf16 v[152:155], a[72:75], a[96:99], v[152:155]
  s_add_u32 s38, s43, 1024
  s_add_u32 m0, s38, 101376
  s_nop 0
  buffer_load_dwordx4 v5, s[24:27], s38 offen sc1 lds
  s_waitcnt lgkmcnt(12)
  v_mfma_f32_16x16x32_bf16 v[156:159], a[64:67], a[108:111], v[156:159]
  s_add_u32 s38, s43, 8192
  s_add_u32 m0, s38, 101376
  s_nop 0
  buffer_load_dwordx4 v5, s[24:27], s38 offen sc1 lds
  v_mfma_f32_16x16x32_bf16 v[156:159], a[68:71], a[104:107], v[156:159]
  s_add_u32 s38, s43, 9216
  s_add_u32 m0, s38, 101376
  s_nop 0
  buffer_load_dwordx4 v5, s[24:27], s38 offen sc1 lds
  v_mfma_f32_16x16x32_bf16 v[156:159], a[72:75], a[100:103], v[156:159]
  v_mfma_f32_16x16x32_bf16 v[156:159], a[76:79], a[96:99], v[156:159]
  ds_read_b64 a[0:1], v12 offset:128
  s_waitcnt lgkmcnt(10)
  v_mfma_f32_16x16x32_bf16 v[160:163], a[64:67], a[112:115], v[160:163]
  ds_read_b64 a[2:3], v12 offset:136
  v_mfma_f32_16x16x32_bf16 v[160:163], a[68:71], a[108:111], v[160:163]
  ds_read_b128 a[32:35], v13 offset:320
  v_mfma_f32_16x16x32_bf16 v[160:163], a[72:75], a[104:107], v[160:163]
  ds_read_b64 a[4:5], v12 offset:640
  v_mfma_f32_16x16x32_bf16 v[160:163], a[76:79], a[100:103], v[160:163]
  ds_read_b64 a[6:7], v12 offset:648
  v_mfma_f32_16x16x32_bf16 v[160:163], a[80:83], a[96:99], v[160:163]
  ds_read_b128 a[36:39], v13 offset:832
  s_waitcnt lgkmcnt(12)
  v_mfma_f32_16x16x32_bf16 v[164:167], a[64:67], a[116:119], v[164:167]
  ds_read_b64 a[8:9], v12 offset:1152
  v_mfma_f32_16x16x32_bf16 v[164:167], a[68:71], a[112:115], v[164:167]
  ds_read_b64 a[10:11], v12 offset:1160
  v_mfma_f32_16x16x32_bf16 v[164:167], a[72:75], a[108:111], v[164:167]
  v_mfma_f32_16x16x32_bf16 v[164:167], a[76:79], a[104:107], v[164:167]
  ds_read_b128 a[40:43], v13 offset:1344
  v_mfma_f32_16x16x32_bf16 v[164:167], a[80:83], a[100:103], v[164:167]
  ds_read_b64 a[12:13], v12 offset:1664
  v_mfma_f32_16x16x32_bf16 v[164:167], a[84:87], a[96:99], v[164:167]
  ds_read_b64 a[14:15], v12 offset:1672
  s_waitcnt lgkmcnt(14)
  v_mfma_f32_16x16x32_bf16 v[168:171], a[64:67], a[120:123], v[168:171]
  ds_read_b128 a[44:47], v13 offset:1856
  v_mfma_f32_16x16x32_bf16 v[168:171], a[68:71], a[116:119], v[168:171]
  ds_read_b64 a[16:17], v12 offset:2176
  v_mfma_f32_16x16x32_bf16 v[168:171], a[72:75], a[112:115], v[168:171]
  ds_read_b64 a[18:19], v12 offset:2184
  v_mfma_f32_16x16x32_bf16 v[168:171], a[76:79], a[108:111], v[168:171]
  ds_read_b128 a[48:51], v13 offset:2368
  v_mfma_f32_16x16x32_bf16 v[168:171], a[80:83], a[104:107], v[168:171]
  ds_read_b64 a[20:21], v12 offset:2688
  v_mfma_f32_16x16x32_bf16 v[168:171], a[84:87], a[100:103], v[168:171]
  v_mfma_f32_16x16x32_bf16 v[168:171], a[88:91], a[96:99], v[168:171]
  ds_read_b64 a[22:23], v12 offset:2696
  s_waitcnt lgkmcnt(15)
  v_mfma_f32_16x16x32_bf16 v[172:175], a[64:67], a[124:127], v[172:175]
  ds_read_b128 a[52:55], v13 offset:2880
  v_mfma_f32_16x16x32_bf16 v[172:175], a[68:71], a[120:123], v[172:175]
  ds_read_b64 a[24:25], v12 offset:3200
  v_mfma_f32_16x16x32_bf16 v[172:175], a[72:75], a[116:119], v[172:175]
  ds_read_b64 a[26:27], v12 offset:3208
  v_mfma_f32_16x16x32_bf16 v[172:175], a[76:79], a[112:115], v[172:175]
  ds_read_b128 a[56:59], v13 offset:3392
  v_mfma_f32_16x16x32_bf16 v[172:175], a[80:83], a[108:111], v[172:175]
  ds_read_b64 a[28:29], v12 offset:3712
  v_mfma_f32_16x16x32_bf16 v[172:175], a[84:87], a[104:107], v[172:175]
  ds_read_b64 a[30:31], v12 offset:3720
  v_mfma_f32_16x16x32_bf16 v[172:175], a[88:91], a[100:103], v[172:175]
  ds_read_b128 a[60:63], v13 offset:3904
  v_mfma_f32_16x16x32_bf16 v[172:175], a[92:95], a[96:99], v[172:175]
  s_waitcnt lgkmcnt(15)
  v_mfma_f32_16x16x32_bf16 v[144:147], a[0:3], a[32:35], v[144:147]
  ds_read_b64 a[64:65], v12 offset:192
  v_mfma_f32_16x16x32_bf16 v[148:151], a[0:3], a[36:39], v[148:151]
  ds_read_b64 a[66:67], v12 offset:200
  v_mfma_f32_16x16x32_bf16 v[148:151], a[4:7], a[32:35], v[148:151]
  ds_read_b128 a[96:99], v13 offset:256
  v_mfma_f32_16x16x32_bf16 v[152:155], a[0:3], a[40:43], v[152:155]
  ds_read_b64 a[68:69], v12 offset:704
  v_mfma_f32_16x16x32_bf16 v[152:155], a[4:7], a[36:39], v[152:155]
  ds_read_b64 a[70:71], v12 offset:712
  v_mfma_f32_16x16x32_bf16 v[152:155], a[8:11], a[32:35], v[152:155]
  ds_read_b128 a[100:103], v13 offset:768
  s_waitcnt lgkmcnt(15)
  v_mfma_f32_16x16x32_bf16 v[156:159], a[0:3], a[44:47], v[156:159]
  ds_read_b64 a[72:73], v12 offset:1216
  v_mfma_f32_16x16x32_bf16 v[156:159], a[4:7], a[40:43], v[156:159]
  ds_read_b64 a[74:75], v12 offset:1224
  v_mfma_f32_16x16x32_bf16 v[156:159], a[8:11], a[36:39], v[156:159]
  ds_read_b128 a[104:107], v13 offset:1280
  v_mfma_f32_16x16x32_bf16 v[156:159], a[12:15], a[32:35], v[156:159]
  ds_read_b64 a[76:77], v12 offset:1728
  v_mfma_f32_16x16x32_bf16 v[160:163], a[0:3], a[48:51], v[160:163]
  ds_read_b64 a[78:79], v12 offset:1736
  v_mfma_f32_16x16x32_bf16 v[160:163], a[4:7], a[44:47], v[160:163]
  ds_read_b128 a[108:111], v13 offset:1792
  v_mfma_f32_16x16x32_bf16 v[160:163], a[8:11], a[40:43], v[160:163]
  ds_read_b64 a[80:81], v12 offset:2240
  v_mfma_f32_16x16x32_bf16 v[160:163], a[12:15], a[36:39], v[160:163]
  ds_read_b64 a[82:83], v12 offset:2248
  v_mfma_f32_16x16x32_bf16 v[160:163], a[16:19], a[32:35], v[160:163]
  ds_read_b128 a[112:115], v13 offset:2304
  s_waitcnt lgkmcnt(15)
  v_mfma_f32_16x16x32_bf16 v[164:167], a[0:3], a[52:55], v[164:167]
  ds_read_b64 a[84:85], v12 offset:2752
  v_mfma_f32_16x16x32_bf16 v[164:167], a[4:7], a[48:51], v[164:167]
  ds_read_b64 a[86:87], v12 offset:2760
  v_mfma_f32_16x16x32_bf16 v[164:167], a[8:11], a[44:47], v[164:167]
  ds_read_b128 a[116:119], v13 offset:2816
  v_mfma_f32_16x16x32_bf16 v[164:167], a[12:15], a[40:43], v[164:167]
  ds_read_b64 a[88:89], v12 offset:3264
  v_mfma_f32_16x16x32_bf16 v[164:167], a[16:19], a[36:39], v[164:167]
  ds_read_b64 a[90:91], v12 offset:3272
  v_mfma_f32_16x16x32_bf16 v[164:167], a[20:23], a[32:35], v[164:167]
  ds_read_b128 a[120:123], v13 offset:3328
  v_mfma_f32_16x16x32_bf16 v[168:171], a[0:3], a[56:59], v[168:171]
  ds_read_b64 a[92:93], v12 offset:3776
  v_mfma_f32_16x16x32_bf16 v[168:171], a[4:7], a[52:55], v[168:171]
  ds_read_b64 a[94:95], v12 offset:3784
  v_mfma_f32_16x16x32_bf16 v[168:171], a[8:11], a[48:51], v[168:171]
  ds_read_b128 a[124:127], v13 offset:3840
  v_mfma_f32_16x16x32_bf16 v[168:171], a[12:15], a[44:47], v[168:171]
  v_lshlrev_b32 v6, 5, v3
  v_mfma_f32_16x16x32_bf16 v[168:171], a[16:19], a[40:43], v[168:171]
  v_lshl_add_u32 v6, v4, 3, v6
  v_mfma_f32_16x16x32_bf16 v[168:171], a[20:23], a[36:39], v[168:171]
  v_add_u32 v6, s39, v6
  v_mfma_f32_16x16x32_bf16 v[168:171], a[24:27], a[32:35], v[168:171]
  v_lshrrev_b32 v7, 3, v0
  v_mfma_f32_16x16x32_bf16 v[172:175], a[0:3], a[60:63], v[172:175]
  s_mov_b32 s34, 73728
  v_mfma_f32_16x16x32_bf16 v[172:175], a[4:7], a[56:59], v[172:175]
  v_mul_lo_u32 v7, v7, s34
  v_mfma_f32_16x16x32_bf16 v[172:175], a[8:11], a[52:55], v[172:175]
  v_and_b32 v8, 7, v0
  v_mfma_f32_16x16x32_bf16 v[172:175], a[12:15], a[48:51], v[172:175]
  v_lshl_add_u32 v7, v8, 4, v7
  v_mfma_f32_16x16x32_bf16 v[172:175], a[16:19], a[44:47], v[172:175]
  s_lshl_b32 s46, s66, 7
  v_mfma_f32_16x16x32_bf16 v[172:175], a[20:23], a[40:43], v[172:175]
  v_add_u32 v7, s46, v7
  v_mfma_f32_16x16x32_bf16 v[172:175], a[24:27], a[36:39], v[172:175]
  s_mov_b32 s49, 0xffff0000
  v_mfma_f32_16x16x32_bf16 v[172:175], a[28:31], a[32:35], v[172:175]
  s_waitcnt lgkmcnt(15)
  v_mfma_f32_16x16x32_bf16 v[144:147], a[64:67], a[96:99], v[144:147]
  ds_read_b64 a[0:1], v12 offset:256
  v_mfma_f32_16x16x32_bf16 v[148:151], a[64:67], a[100:103], v[148:151]
  ds_read_b64 a[2:3], v12 offset:264
  v_mfma_f32_16x16x32_bf16 v[148:151], a[68:71], a[96:99], v[148:151]
  v_mfma_f32_16x16x32_bf16 v[152:155], a[64:67], a[104:107], v[152:155]
  ds_read_b128 a[32:35], v13 offset:192
  v_mfma_f32_16x16x32_bf16 v[152:155], a[68:71], a[100:103], v[152:155]
  ds_read_b64 a[4:5], v12 offset:768
  v_mfma_f32_16x16x32_bf16 v[152:155], a[72:75], a[96:99], v[152:155]
  s_waitcnt lgkmcnt(15)
  v_mfma_f32_16x16x32_bf16 v[156:159], a[64:67], a[108:111], v[156:159]
  ds_read_b64 a[6:7], v12 offset:776
  v_mfma_f32_16x16x32_bf16 v[156:159], a[68:71], a[104:107], v[156:159]
  ds_read_b128 a[36:39], v13 offset:704
  v_mfma_f32_16x16x32_bf16 v[156:159], a[72:75], a[100:103], v[156:159]
  v_mfma_f32_16x16x32_bf16 v[156:159], a[76:79], a[96:99], v[156:159]
  ds_read_b64 a[8:9], v12 offset:1280
  s_waitcnt lgkmcnt(15)
  v_mfma_f32_16x16x32_bf16 v[160:163], a[64:67], a[112:115], v[160:163]
  ds_read_b64 a[10:11], v12 offset:1288
  v_mfma_f32_16x16x32_bf16 v[160:163], a[68:71], a[108:111], v[160:163]
  v_mfma_f32_16x16x32_bf16 v[160:163], a[72:75], a[104:107], v[160:163]
  ds_read_b128 a[40:43], v13 offset:1216
  v_mfma_f32_16x16x32_bf16 v[160:163], a[76:79], a[100:103], v[160:163]
  ds_read_b64 a[12:13], v12 offset:1792
  v_mfma_f32_16x16x32_bf16 v[160:163], a[80:83], a[96:99], v[160:163]
  s_waitcnt lgkmcnt(15)
  v_mfma_f32_16x16x32_bf16 v[164:167], a[64:67], a[116:119], v[164:167]
  ds_read_b64 a[14:15], v12 offset:1800
  v_mfma_f32_16x16x32_bf16 v[164:167], a[68:71], a[112:115], v[164:167]
  ds_read_b128 a[44:47], v13 offset:1728
  v_mfma_f32_16x16x32_bf16 v[164:167], a[72:75], a[108:111], v[164:167]
  v_mfma_f32_16x16x32_bf16 v[164:167], a[76:79], a[104:107], v[164:167]
  ds_read_b64 a[16:17], v12 offset:2304
  v_mfma_f32_16x16x32_bf16 v[164:167], a[80:83], a[100:103], v[164:167]
  ds_read_b64 a[18:19], v12 offset:2312
  v_mfma_f32_16x16x32_bf16 v[164:167], a[84:87], a[96:99], v[164:167]
  s_waitcnt lgkmcnt(15)
  v_mfma_f32_16x16x32_bf16 v[168:171], a[64:67], a[120:123], v[168:171]
  ds_read_b128 a[48:51], v13 offset:2240
  v_mfma_f32_16x16x32_bf16 v[168:171], a[68:71], a[116:119], v[168:171]
  ds_read_b64 a[20:21], v12 offset:2816
  v_mfma_f32_16x16x32_bf16 v[168:171], a[72:75], a[112:115], v[168:171]
  v_mfma_f32_16x16x32_bf16 v[168:171], a[76:79], a[108:111], v[168:171]
  ds_read_b64 a[22:23], v12 offset:2824
  v_mfma_f32_16x16x32_bf16 v[168:171], a[80:83], a[104:107], v[168:171]
  ds_read_b128 a[52:55], v13 offset:2752
  v_mfma_f32_16x16x32_bf16 v[168:171], a[84:87], a[100:103], v[168:171]
  v_mfma_f32_16x16x32_bf16 v[168:171], a[88:91], a[96:99], v[168:171]
  ds_read_b64 a[24:25], v12 offset:3328
  s_waitcnt lgkmcnt(15)
  v_mfma_f32_16x16x32_bf16 v[172:175], a[64:67], a[124:127], v[172:175]
  ds_read_b64 a[26:27], v12 offset:3336
  v_mfma_f32_16x16x32_bf16 v[172:175], a[68:71], a[120:123], v[172:175]
  v_mfma_f32_16x16x32_bf16 v[172:175], a[72:75], a[116:119], v[172:175]
  ds_read_b128 a[56:59], v13 offset:3264
  v_mfma_f32_16x16x32_bf16 v[172:175], a[76:79], a[112:115], v[172:175]
  ds_read_b64 a[28:29], v12 offset:3840
  v_mfma_f32_16x16x32_bf16 v[172:175], a[80:83], a[108:111], v[172:175]
  v_mfma_f32_16x16x32_bf16 v[172:175], a[84:87], a[104:107], v[172:175]
  ds_read_b64 a[30:31], v12 offset:3848
  v_mfma_f32_16x16x32_bf16 v[172:175], a[88:91], a[100:103], v[172:175]
  ds_read_b128 a[60:63], v13 offset:3776
  v_mfma_f32_16x16x32_bf16 v[172:175], a[92:95], a[96:99], v[172:175]
  v_mfma_f32_16x16x32_bf16 v[144:147], a[0:3], a[32:35], v[144:147]
  ds_read_b64 a[64:65], v12 offset:320
  s_waitcnt lgkmcnt(15)
  v_mfma_f32_16x16x32_bf16 v[148:151], a[0:3], a[36:39], v[148:151]
  ds_read_b64 a[66:67], v12 offset:328
  v_mfma_f32_16x16x32_bf16 v[148:151], a[4:7], a[32:35], v[148:151]
  ds_read_b128 a[96:99], v13 offset:128
  v_mfma_f32_16x16x32_bf16 v[152:155], a[0:3], a[40:43], v[152:155]
  ds_read_b64 a[68:69], v12 offset:832
  v_mfma_f32_16x16x32_bf16 v[152:155], a[4:7], a[36:39], v[152:155]
  ds_read_b64 a[70:71], v12 offset:840
  v_mfma_f32_16x16x32_bf16 v[152:155], a[8:11], a[32:35], v[152:155]
  ds_read_b128 a[100:103], v13 offset:640
  s_waitcnt lgkmcnt(15)
  v_mfma_f32_16x16x32_bf16 v[156:159], a[0:3], a[44:47], v[156:159]
  ds_read_b64 a[72:73], v12 offset:1344
  v_mfma_f32_16x16x32_bf16 v[156:159], a[4:7], a[40:43], v[156:159]
  v_mfma_f32_16x16x32_bf16 v[156:159], a[8:11], a[36:39], v[156:159]
  ds_read_b64 a[74:75], v12 offset:1352
  v_mfma_f32_16x16x32_bf16 v[156:159], a[12:15], a[32:35], v[156:159]
  ds_read_b128 a[104:107], v13 offset:1152
  v_mfma_f32_16x16x32_bf16 v[160:163], a[0:3], a[48:51], v[160:163]
  ds_read_b64 a[76:77], v12 offset:1856
  v_mfma_f32_16x16x32_bf16 v[160:163], a[4:7], a[44:47], v[160:163]
  ds_read_b64 a[78:79], v12 offset:1864
  v_mfma_f32_16x16x32_bf16 v[160:163], a[8:11], a[40:43], v[160:163]
  ds_read_b128 a[108:111], v13 offset:1664
  v_mfma_f32_16x16x32_bf16 v[160:163], a[12:15], a[36:39], v[160:163]
  ds_read_b64 a[80:81], v12 offset:2368
  v_mfma_f32_16x16x32_bf16 v[160:163], a[16:19], a[32:35], v[160:163]
  s_waitcnt lgkmcnt(15)
  v_mfma_f32_16x16x32_bf16 v[164:167], a[0:3], a[52:55], v[164:167]
  ds_read_b64 a[82:83], v12 offset:2376
  v_mfma_f32_16x16x32_bf16 v[164:167], a[4:7], a[48:51], v[164:167]
  ds_read_b128 a[112:115], v13 offset:2176
  v_mfma_f32_16x16x32_bf16 v[164:167], a[8:11], a[44:47], v[164:167]
  ds_read_b64 a[84:85], v12 offset:2880
  v_mfma_f32_16x16x32_bf16 v[164:167], a[12:15], a[40:43], v[164:167]
  ds_read_b64 a[86:87], v12 offset:2888
  v_mfma_f32_16x16x32_bf16 v[164:167], a[16:19], a[36:39], v[164:167]
  ds_read_b128 a[116:119], v13 offset:2688
  v_mfma_f32_16x16x32_bf16 v[164:167], a[20:23], a[32:35], v[164:167]
  ds_read_b64 a[88:89], v12 offset:3392
  v_mfma_f32_16x16x32_bf16 v[168:171], a[0:3], a[56:59], v[168:171]
  v_mfma_f32_16x16x32_bf16 v[168:171], a[4:7], a[52:55], v[168:171]
  ds_read_b64 a[90:91], v12 offset:3400
  v_mfma_f32_16x16x32_bf16 v[168:171], a[8:11], a[48:51], v[168:171]
  ds_read_b128 a[120:123], v13 offset:3200
  v_mfma_f32_16x16x32_bf16 v[168:171], a[12:15], a[44:47], v[168:171]
  ds_read_b64 a[92:93], v12 offset:3904
  v_mfma_f32_16x16x32_bf16 v[168:171], a[16:19], a[40:43], v[168:171]
  ds_read_b64 a[94:95], v12 offset:3912
  v_mfma_f32_16x16x32_bf16 v[168:171], a[20:23], a[36:39], v[168:171]
  ds_read_b128 a[124:127], v13 offset:3712
  v_mfma_f32_16x16x32_bf16 v[168:171], a[24:27], a[32:35], v[168:171]
  s_waitcnt vmcnt(0)
  s_barrier
  s_waitcnt lgkmcnt(15)
  v_mfma_f32_16x16x32_bf16 v[172:175], a[0:3], a[60:63], v[172:175]
  v_mfma_f32_16x16x32_bf16 v[172:175], a[4:7], a[56:59], v[172:175]
  ds_read_b64 v[100:101], v14 offset:0
  v_mfma_f32_16x16x32_bf16 v[172:175], a[8:11], a[52:55], v[172:175]
  ds_read_b128 v[176:179], v15 offset:0
  v_mfma_f32_16x16x32_bf16 v[172:175], a[12:15], a[48:51], v[172:175]
  ds_read_b128 v[184:187], v15 offset:8192
  v_mfma_f32_16x16x32_bf16 v[172:175], a[16:19], a[44:47], v[172:175]
  ds_read_b64 v[102:103], v14 offset:2048
  v_mfma_f32_16x16x32_bf16 v[172:175], a[20:23], a[40:43], v[172:175]
  ds_read_b128 v[180:183], v15 offset:1024
  v_mfma_f32_16x16x32_bf16 v[172:175], a[24:27], a[36:39], v[172:175]
  ds_read_b128 v[188:191], v15 offset:9216
  v_mfma_f32_16x16x32_bf16 v[172:175], a[28:31], a[32:35], v[172:175]
  v_mfma_f32_16x16x32_bf16 v[144:147], a[64:67], a[96:99], v[144:147]
  ds_read_b64 a[0:1], v12 offset:384
  ds_read_b64 a[2:3], v12 offset:392
  ds_read_b128 a[32:35], v13 offset:64
  v_mfma_f32_16x16x32_bf16 v[148:151], a[64:67], a[100:103], v[148:151]
  ds_read_b64 a[4:5], v12 offset:896
  ds_read_b64 a[6:7], v12 offset:904
  v_mfma_f32_16x16x32_bf16 v[148:151], a[68:71], a[96:99], v[148:151]
  ds_read_b128 a[36:39], v13 offset:576
  ds_read_b64 a[8:9], v12 offset:1408
  v_mfma_f32_16x16x32_bf16 v[152:155], a[64:67], a[104:107], v[152:155]
  ds_read_b64 a[10:11], v12 offset:1416
  ds_read_b128 a[40:43], v13 offset:1088
  ds_read_b64 a[12:13], v12 offset:1920
  v_mfma_f32_16x16x32_bf16 v[152:155], a[68:71], a[100:103], v[152:155]
  ds_read_b64 a[14:15], v12 offset:1928
  ds_read_b128 a[44:47], v13 offset:1600
  v_mfma_f32_16x16x32_bf16 v[152:155], a[72:75], a[96:99], v[152:155]
  ds_read_b64 a[16:17], v12 offset:2432
  ds_read_b64 a[18:19], v12 offset:2440
  s_waitcnt lgkmcnt(15)
  v_mfma_f32_16x16x32_bf16 v[156:159], a[64:67], a[108:111], v[156:159]
  ds_read_b128 a[48:51], v13 offset:2112
  ds_read_b64 a[20:21], v12 offset:2944
  ds_read_b64 a[22:23], v12 offset:2952
  v_mfma_f32_16x16x32_bf16 v[156:159], a[68:71], a[104:107], v[156:159]
  ds_read_b128 a[52:55], v13 offset:2624
  ds_read_b64 a[24:25], v12 offset:3456
  v_mfma_f32_16x16x32_bf16 v[156:159], a[72:75], a[100:103], v[156:159]
  ds_read_b64 a[26:27], v12 offset:3464
  ds_read_b128 a[56:59], v13 offset:3136
  v_mfma_f32_16x16x32_bf16 v[156:159], a[76:79], a[96:99], v[156:159]
  ds_read_b64 a[28:29], v12 offset:3968
  ds_read_b64 a[30:31], v12 offset:3976
  ds_read_b128 a[60:63], v13 offset:3648
  v_mfma_f32_16x16x32_bf16 v[160:163], a[64:67], a[112:115], v[160:163]
  v_lshlrev_b32 v16, 16, v100
  v_and_b32 v17, s49, v100
  v_mfma_f32_16x16x32_bf16 v[160:163], a[68:71], a[108:111], v[160:163]
  v_lshlrev_b32 v18, 16, v101
  v_and_b32 v19, s49, v101
  v_mfma_f32_16x16x32_bf16 v[160:163], a[72:75], a[104:107], v[160:163]
  v_sub_f32 v48, v16, v176
  v_sub_f32 v49, v17, v177
  v_sub_f32 v50, v18, v178
  v_mfma_f32_16x16x32_bf16 v[160:163], a[76:79], a[100:103], v[160:163]
  v_sub_f32 v51, v19, v179
  v_mul_f32 v48, v48, v184
  v_mfma_f32_16x16x32_bf16 v[160:163], a[80:83], a[96:99], v[160:163]
  v_mul_f32 v49, v49, v185
  v_mul_f32 v50, v50, v186
  v_mfma_f32_16x16x32_bf16 v[164:167], a[64:67], a[116:119], v[164:167]
  v_mul_f32 v51, v51, v187
  ds_read_b64 v[104:105], v14 offset:4096
  ds_read_b128 v[176:179], v15 offset:2048
  v_mfma_f32_16x16x32_bf16 v[164:167], a[68:71], a[112:115], v[164:167]
  ds_read_b128 v[184:187], v15 offset:10240
  v_lshlrev_b32 v20, 16, v102
  v_mfma_f32_16x16x32_bf16 v[164:167], a[72:75], a[108:111], v[164:167]
  v_and_b32 v21, s49, v102
  v_lshlrev_b32 v22, 16, v103
  v_mfma_f32_16x16x32_bf16 v[164:167], a[76:79], a[104:107], v[164:167]
  v_and_b32 v23, s49, v103
  v_sub_f32 v52, v20, v180
  v_sub_f32 v53, v21, v181
  v_mfma_f32_16x16x32_bf16 v[164:167], a[80:83], a[100:103], v[164:167]
  v_sub_f32 v54, v22, v182
  v_sub_f32 v55, v23, v183
  v_mfma_f32_16x16x32_bf16 v[164:167], a[84:87], a[96:99], v[164:167]
  s_waitcnt lgkmcnt(15)
  v_mul_f32 v52, v52, v188
  v_mul_f32 v53, v53, v189
  v_mfma_f32_16x16x32_bf16 v[168:171], a[64:67], a[120:123], v[168:171]
  v_mul_f32 v54, v54, v190
  v_mul_f32 v55, v55, v191
  ds_read_b64 v[106:107], v14 offset:6144
  v_mfma_f32_16x16x32_bf16 v[168:171], a[68:71], a[116:119], v[168:171]
  ds_read_b128 v[180:183], v15 offset:3072
  ds_read_b128 v[188:191], v15 offset:11264
  v_mfma_f32_16x16x32_bf16 v[168:171], a[72:75], a[112:115], v[168:171]
  s_waitcnt lgkmcnt(5)
  v_lshlrev_b32 v24, 16, v104
  v_and_b32 v25, s49, v104
  v_mfma_f32_16x16x32_bf16 v[168:171], a[76:79], a[108:111], v[168:171]
  v_lshlrev_b32 v26, 16, v105
  v_and_b32 v27, s49, v105
  s_waitcnt lgkmcnt(4)
  v_sub_f32 v56, v24, v176
  v_mfma_f32_16x16x32_bf16 v[168:171], a[80:83], a[104:107], v[168:171]
  v_sub_f32 v57, v25, v177
  v_sub_f32 v58, v26, v178
  v_mfma_f32_16x16x32_bf16 v[168:171], a[84:87], a[100:103], v[168:171]
  v_sub_f32 v59, v27, v179
  s_waitcnt lgkmcnt(3)
  v_mul_f32 v56, v56, v184
  v_mfma_f32_16x16x32_bf16 v[168:171], a[88:91], a[96:99], v[168:171]
  v_mul_f32 v57, v57, v185
  v_mul_f32 v58, v58, v186
  v_mul_f32 v59, v59, v187
  v_mfma_f32_16x16x32_bf16 v[172:175], a[64:67], a[124:127], v[172:175]
  ds_read_b64 v[108:109], v14 offset:8192
  ds_read_b128 v[176:179], v15 offset:4096
  v_mfma_f32_16x16x32_bf16 v[172:175], a[68:71], a[120:123], v[172:175]
  ds_read_b128 v[184:187], v15 offset:12288
  s_waitcnt lgkmcnt(5)
  v_lshlrev_b32 v28, 16, v106
  v_mfma_f32_16x16x32_bf16 v[172:175], a[72:75], a[116:119], v[172:175]
  v_and_b32 v29, s49, v106
  v_lshlrev_b32 v30, 16, v107
  v_and_b32 v31, s49, v107
  v_mfma_f32_16x16x32_bf16 v[172:175], a[76:79], a[112:115], v[172:175]
  s_waitcnt lgkmcnt(4)
  v_sub_f32 v60, v28, v180
  v_sub_f32 v61, v29, v181
  v_mfma_f32_16x16x32_bf16 v[172:175], a[80:83], a[108:111], v[172:175]
  v_sub_f32 v62, v30, v182
  v_sub_f32 v63, v31, v183
  v_mfma_f32_16x16x32_bf16 v[172:175], a[84:87], a[104:107], v[172:175]
  s_waitcnt lgkmcnt(3)
  v_mul_f32 v60, v60, v188
  v_mul_f32 v61, v61, v189
  v_mul_f32 v62, v62, v190
  v_mfma_f32_16x16x32_bf16 v[172:175], a[88:91], a[100:103], v[172:175]
  v_mul_f32 v63, v63, v191
  ds_read_b64 v[110:111], v14 offset:10240
  v_mfma_f32_16x16x32_bf16 v[172:175], a[92:95], a[96:99], v[172:175]
  ds_read_b128 v[180:183], v15 offset:5120
  ds_read_b128 v[188:191], v15 offset:13312
  v_mfma_f32_16x16x32_bf16 v[144:147], a[0:3], a[32:35], v[144:147]
  ds_read_b64 a[64:65], v12 offset:448
  ds_read_b64 a[66:67], v12 offset:456
  ds_read_b128 a[96:99], v13 offset:0
  v_mfma_f32_16x16x32_bf16 v[148:151], a[0:3], a[36:39], v[148:151]
  ds_read_b64 a[68:69], v12 offset:960
  ds_read_b64 a[70:71], v12 offset:968
  v_mfma_f32_16x16x32_bf16 v[148:151], a[4:7], a[32:35], v[148:151]
  ds_read_b128 a[100:103], v13 offset:512
  ds_read_b64 a[72:73], v12 offset:1472
  v_mfma_f32_16x16x32_bf16 v[152:155], a[0:3], a[40:43], v[152:155]
  ds_read_b64 a[74:75], v12 offset:1480
  ds_read_b128 a[104:107], v13 offset:1024
  v_mfma_f32_16x16x32_bf16 v[152:155], a[4:7], a[36:39], v[152:155]
  ds_read_b64 a[76:77], v12 offset:1984
  ds_read_b64 a[78:79], v12 offset:1992
  v_mfma_f32_16x16x32_bf16 v[152:155], a[8:11], a[32:35], v[152:155]
  ds_read_b128 a[108:111], v13 offset:1536
  ds_read_b64 a[80:81], v12 offset:2496
  ds_read_b64 a[82:83], v12 offset:2504
  v_mfma_f32_16x16x32_bf16 v[156:159], a[0:3], a[44:47], v[156:159]
  ds_read_b128 a[112:115], v13 offset:2048
  ds_read_b64 a[84:85], v12 offset:3008
  v_mfma_f32_16x16x32_bf16 v[156:159], a[4:7], a[40:43], v[156:159]
  ds_read_b64 a[86:87], v12 offset:3016
  ds_read_b128 a[116:119], v13 offset:2560
  v_mfma_f32_16x16x32_bf16 v[156:159], a[8:11], a[36:39], v[156:159]
  ds_read_b64 a[88:89], v12 offset:3520
  ds_read_b64 a[90:91], v12 offset:3528
  v_mfma_f32_16x16x32_bf16 v[156:159], a[12:15], a[32:35], v[156:159]
  ds_read_b128 a[120:123], v13 offset:3072
  ds_read_b64 a[92:93], v12 offset:4032
  v_mfma_f32_16x16x32_bf16 v[160:163], a[0:3], a[48:51], v[160:163]
  ds_read_b64 a[94:95], v12 offset:4040
  ds_read_b128 a[124:127], v13 offset:3584
  s_or_b32 s16, s2, s3
  s_cmp_eq_u32 s16, 0
  s_cselect_b32 s16, 71680, 0x40000000
  s_mov_b64 exec, 1
  v_mov_b32 v132, s6
  buffer_store_dword v132, off, s[52:55], s16 sc1
  s_mov_b64 exec, -1
  v_mfma_f32_16x16x32_bf16 v[160:163], a[4:7], a[44:47], v[160:163]
  s_waitcnt lgkmcnt(15)
  v_lshlrev_b32 v32, 16, v108
  v_and_b32 v33, s49, v108
  v_mfma_f32_16x16x32_bf16 v[160:163], a[8:11], a[40:43], v[160:163]
  v_lshlrev_b32 v34, 16, v109
  v_and_b32 v35, s49, v109
  v_mfma_f32_16x16x32_bf16 v[160:163], a[12:15], a[36:39], v[160:163]
  v_sub_f32 v64, v32, v176
  v_sub_f32 v65, v33, v177
  v_mfma_f32_16x16x32_bf16 v[160:163], a[16:19], a[32:35], v[160:163]
  v_sub_f32 v66, v34, v178
  v_sub_f32 v67, v35, v179
  v_mfma_f32_16x16x32_bf16 v[164:167], a[0:3], a[52:55], v[164:167]
  v_mul_f32 v64, v64, v184
  v_mul_f32 v65, v65, v185
  v_mul_f32 v66, v66, v186
  v_mfma_f32_16x16x32_bf16 v[164:167], a[4:7], a[48:51], v[164:167]
  v_mul_f32 v67, v67, v187
  ds_read_b64 v[112:113], v14 offset:12288
  v_mfma_f32_16x16x32_bf16 v[164:167], a[8:11], a[44:47], v[164:167]
  ds_read_b128 v[176:179], v15 offset:6144
  ds_read_b128 v[184:187], v15 offset:14336
  v_mfma_f32_16x16x32_bf16 v[164:167], a[12:15], a[40:43], v[164:167]
  v_lshlrev_b32 v36, 16, v110
  v_and_b32 v37, s49, v110
  v_mfma_f32_16x16x32_bf16 v[164:167], a[16:19], a[36:39], v[164:167]
  v_lshlrev_b32 v38, 16, v111
  v_and_b32 v39, s49, v111
  v_mfma_f32_16x16x32_bf16 v[164:167], a[20:23], a[32:35], v[164:167]
  v_sub_f32 v68, v36, v180
  v_sub_f32 v69, v37, v181
  v_sub_f32 v70, v38, v182
  v_mfma_f32_16x16x32_bf16 v[168:171], a[0:3], a[56:59], v[168:171]
  v_sub_f32 v71, v39, v183
  v_mul_f32 v68, v68, v188
  v_mfma_f32_16x16x32_bf16 v[168:171], a[4:7], a[52:55], v[168:171]
  v_mul_f32 v69, v69, v189
  v_mul_f32 v70, v70, v190
  v_mfma_f32_16x16x32_bf16 v[168:171], a[8:11], a[48:51], v[168:171]
  v_mul_f32 v71, v71, v191
  ds_read_b64 v[114:115], v14 offset:14336
  v_mfma_f32_16x16x32_bf16 v[168:171], a[12:15], a[44:47], v[168:171]
  ds_read_b128 v[180:183], v15 offset:7168
  ds_read_b128 v[188:191], v15 offset:15360
  v_mfma_f32_16x16x32_bf16 v[168:171], a[16:19], a[40:43], v[168:171]
  s_waitcnt lgkmcnt(5)
  v_lshlrev_b32 v40, 16, v112
  v_and_b32 v41, s49, v112
  v_lshlrev_b32 v42, 16, v113
  v_mfma_f32_16x16x32_bf16 v[168:171], a[20:23], a[36:39], v[168:171]
  v_and_b32 v43, s49, v113
  s_waitcnt lgkmcnt(4)
  v_sub_f32 v72, v40, v176
  v_mfma_f32_16x16x32_bf16 v[168:171], a[24:27], a[32:35], v[168:171]
  v_sub_f32 v73, v41, v177
  v_sub_f32 v74, v42, v178
  v_mfma_f32_16x16x32_bf16 v[172:175], a[0:3], a[60:63], v[172:175]
  v_sub_f32 v75, v43, v179
  s_waitcnt lgkmcnt(3)
  v_mul_f32 v72, v72, v184
  v_mfma_f32_16x16x32_bf16 v[172:175], a[4:7], a[56:59], v[172:175]
  v_mul_f32 v73, v73, v185
  v_mul_f32 v74, v74, v186
  v_mfma_f32_16x16x32_bf16 v[172:175], a[8:11], a[52:55], v[172:175]
  v_mul_f32 v75, v75, v187
  s_waitcnt lgkmcnt(2)
  v_lshlrev_b32 v44, 16, v114
  v_and_b32 v45, s49, v114
  v_mfma_f32_16x16x32_bf16 v[172:175], a[12:15], a[48:51], v[172:175]
  v_lshlrev_b32 v46, 16, v115
  v_and_b32 v47, s49, v115
  v_mfma_f32_16x16x32_bf16 v[172:175], a[16:19], a[44:47], v[172:175]
  s_waitcnt lgkmcnt(1)
  v_sub_f32 v76, v44, v180
  v_sub_f32 v77, v45, v181
  v_mfma_f32_16x16x32_bf16 v[172:175], a[20:23], a[40:43], v[172:175]
  v_sub_f32 v78, v46, v182
  v_sub_f32 v79, v47, v183
  v_mfma_f32_16x16x32_bf16 v[172:175], a[24:27], a[36:39], v[172:175]
  s_waitcnt lgkmcnt(0)
  v_mul_f32 v76, v76, v188
  v_mul_f32 v77, v77, v189
  v_mfma_f32_16x16x32_bf16 v[172:175], a[28:31], a[32:35], v[172:175]
  v_mul_f32 v78, v78, v190
  v_mul_f32 v79, v79, v191
  v_mfma_f32_16x16x32_bf16 v[144:147], a[64:67], a[96:99], v[144:147]
  v_mfma_f32_16x16x32_bf16 v[148:151], a[64:67], a[100:103], v[148:151]
  v_mfma_f32_16x16x32_bf16 v[148:151], a[68:71], a[96:99], v[148:151]
  v_mfma_f32_16x16x32_bf16 v[152:155], a[64:67], a[104:107], v[152:155]
  v_mfma_f32_16x16x32_bf16 v[152:155], a[68:71], a[100:103], v[152:155]
  v_mfma_f32_16x16x32_bf16 v[152:155], a[72:75], a[96:99], v[152:155]
  s_nop 2
  v_fma_f32 v16, v48, v144, v16
  v_fma_f32 v17, v49, v145, v17
  v_mfma_f32_16x16x32_bf16 v[156:159], a[64:67], a[108:111], v[156:159]
  v_fma_f32 v18, v50, v146, v18
  v_fma_f32 v19, v51, v147, v19
  v_mfma_f32_16x16x32_bf16 v[156:159], a[68:71], a[104:107], v[156:159]
  v_cvt_pk_bf16_f32 v100, v16, v17
  v_cvt_pk_bf16_f32 v101, v18, v19
  v_mfma_f32_16x16x32_bf16 v[156:159], a[72:75], a[100:103], v[156:159]
  ds_write_b64 v6, v[100:101] offset:0
  v_mfma_f32_16x16x32_bf16 v[156:159], a[76:79], a[96:99], v[156:159]
  v_fma_f32 v20, v52, v148, v20
  v_fma_f32 v21, v53, v149, v21
  v_mfma_f32_16x16x32_bf16 v[160:163], a[64:67], a[112:115], v[160:163]
  v_fma_f32 v22, v54, v150, v22
  v_fma_f32 v23, v55, v151, v23
  v_mfma_f32_16x16x32_bf16 v[160:163], a[68:71], a[108:111], v[160:163]
  v_cvt_pk_bf16_f32 v102, v20, v21
  v_cvt_pk_bf16_f32 v103, v22, v23
  v_mfma_f32_16x16x32_bf16 v[160:163], a[72:75], a[104:107], v[160:163]
  ds_write_b64 v6, v[102:103] offset:512
  v_mfma_f32_16x16x32_bf16 v[160:163], a[76:79], a[100:103], v[160:163]
  ds_read_b128 v[116:119], v10 offset:0
  v_fma_f32 v24, v56, v152, v24
  v_fma_f32 v25, v57, v153, v25
  v_mfma_f32_16x16x32_bf16 v[160:163], a[80:83], a[96:99], v[160:163]
  v_fma_f32 v26, v58, v154, v26
  v_fma_f32 v27, v59, v155, v27
  v_mfma_f32_16x16x32_bf16 v[164:167], a[64:67], a[116:119], v[164:167]
  v_cvt_pk_bf16_f32 v104, v24, v25
  v_cvt_pk_bf16_f32 v105, v26, v27
  v_mfma_f32_16x16x32_bf16 v[164:167], a[68:71], a[112:115], v[164:167]
  ds_write_b64 v6, v[104:105] offset:1024
  v_mfma_f32_16x16x32_bf16 v[164:167], a[72:75], a[108:111], v[164:167]
  s_mov_b32 s47, 0
  s_waitcnt lgkmcnt(1)
  buffer_store_dwordx4 v[116:119], v7, s[28:31], s47 offen sc1
  v_fma_f32 v28, v60, v156, v28
  v_fma_f32 v29, v61, v157, v29
  v_mfma_f32_16x16x32_bf16 v[164:167], a[76:79], a[104:107], v[164:167]
  v_fma_f32 v30, v62, v158, v30
  v_fma_f32 v31, v63, v159, v31
  v_mfma_f32_16x16x32_bf16 v[164:167], a[80:83], a[100:103], v[164:167]
  v_cvt_pk_bf16_f32 v106, v28, v29
  v_cvt_pk_bf16_f32 v107, v30, v31
  v_mfma_f32_16x16x32_bf16 v[164:167], a[84:87], a[96:99], v[164:167]
  ds_write_b64 v6, v[106:107] offset:1536
  v_mfma_f32_16x16x32_bf16 v[168:171], a[64:67], a[120:123], v[168:171]
  ds_read_b128 v[120:123], v10 offset:1024
  v_fma_f32 v32, v64, v160, v32
  v_fma_f32 v33, v65, v161, v33
  v_mfma_f32_16x16x32_bf16 v[168:171], a[68:71], a[116:119], v[168:171]
  v_fma_f32 v34, v66, v162, v34
  v_fma_f32 v35, v67, v163, v35
  v_mfma_f32_16x16x32_bf16 v[168:171], a[72:75], a[112:115], v[168:171]
  v_cvt_pk_bf16_f32 v108, v32, v33
  v_cvt_pk_bf16_f32 v109, v34, v35
  v_mfma_f32_16x16x32_bf16 v[168:171], a[76:79], a[108:111], v[168:171]
  ds_write_b64 v6, v[108:109] offset:2048
  v_mfma_f32_16x16x32_bf16 v[168:171], a[80:83], a[104:107], v[168:171]
  s_mov_b32 s47, 589824
  s_waitcnt lgkmcnt(1)
  buffer_store_dwordx4 v[120:123], v7, s[28:31], s47 offen sc1
  v_fma_f32 v36, v68, v164, v36
  v_fma_f32 v37, v69, v165, v37
  v_mfma_f32_16x16x32_bf16 v[168:171], a[84:87], a[100:103], v[168:171]
  v_fma_f32 v38, v70, v166, v38
  v_fma_f32 v39, v71, v167, v39
  v_mfma_f32_16x16x32_bf16 v[168:171], a[88:91], a[96:99], v[168:171]
  v_cvt_pk_bf16_f32 v110, v36, v37
  v_cvt_pk_bf16_f32 v111, v38, v39
  v_mfma_f32_16x16x32_bf16 v[172:175], a[64:67], a[124:127], v[172:175]
  ds_write_b64 v6, v[110:111] offset:2560
  v_mfma_f32_16x16x32_bf16 v[172:175], a[68:71], a[120:123], v[172:175]
  ds_read_b128 v[124:127], v10 offset:2048
  v_mfma_f32_16x16x32_bf16 v[172:175], a[72:75], a[116:119], v[172:175]
  v_mfma_f32_16x16x32_bf16 v[172:175], a[76:79], a[112:115], v[172:175]
  v_mfma_f32_16x16x32_bf16 v[172:175], a[80:83], a[108:111], v[172:175]
  v_fma_f32 v40, v72, v168, v40
  v_fma_f32 v41, v73, v169, v41
  v_mfma_f32_16x16x32_bf16 v[172:175], a[84:87], a[104:107], v[172:175]
  s_mov_b32 s47, 1179648
  s_waitcnt lgkmcnt(0)
  buffer_store_dwordx4 v[124:127], v7, s[28:31], s47 offen sc1
  v_fma_f32 v42, v74, v170, v42
  v_fma_f32 v43, v75, v171, v43
  v_mfma_f32_16x16x32_bf16 v[172:175], a[88:91], a[100:103], v[172:175]
  v_cvt_pk_bf16_f32 v112, v40, v41
  v_cvt_pk_bf16_f32 v113, v42, v43
  v_mfma_f32_16x16x32_bf16 v[172:175], a[92:95], a[96:99], v[172:175]
  ds_write_b64 v6, v[112:113] offset:3072
  s_nop 6
  v_fma_f32 v44, v76, v172, v44
  v_fma_f32 v45, v77, v173, v45
  v_fma_f32 v46, v78, v174, v46
  v_fma_f32 v47, v79, v175, v47
  v_cvt_pk_bf16_f32 v114, v44, v45
  v_cvt_pk_bf16_f32 v115, v46, v47
  ds_write_b64 v6, v[114:115] offset:3584
  ds_read_b128 v[128:131], v10 offset:3072
  s_mov_b32 s47, 1769472
  s_waitcnt lgkmcnt(0)
  buffer_store_dwordx4 v[128:131], v7, s[28:31], s47 offen sc1
  s_lshl_b32 s21, s64, 7
  s_add_u32 s21, s21, 36864
  s_branch L_mlp
L_notconv:
  s_waitcnt vmcnt(5)
  s_barrier
  s_cmp_lg_u32 s3, 0
  s_cbranch_scc1 L14_sa
  s_lshl_b32 s16, s2, 7
  s_add_u32 s16, s16, 4096
  s_mov_b64 exec, 1
  v_mov_b32 v250, s6
  buffer_store_dword v250, off, s[52:55], s16 sc1
  s_mov_b64 exec, -1
L14_sa:
  s_cmp_ge_u32 s2, 240
  s_cbranch_scc1 L_idle
  s_sub_u32 s32, s2, 144
  s_and_b32 s33, s32, 7
  s_lshr_b32 s34, s32, 3
  s_add_u32 s20, s4, 7340032
  s_addc_u32 s21, s5, 0
  s_mov_b32 s22, 5308416
  s_mov_b32 s23, 0x20000
  s_add_u32 s24, s4, 12648448
  s_addc_u32 s25, s5, 0
  s_mov_b32 s26, 5308416
  s_mov_b32 s27, 0x20000
  s_cmp_ge_u32 s34, 6
  s_cbranch_scc1 L15_w2
  s_mov_b32 s16, s56
  s_mov_b32 s17, s57
  s_mov_b32 s18, 5308416
  s_mov_b32 s19, 0x20000
  s_add_u32 s36, s4, 7143424
  s_addc_u32 s37, s5, 0
  s_mov_b32 s38, 110592
  s_mov_b32 s39, 0x20000
  s_mul_i32 s40, s34, 96
  s_lshl_b32 s41, s3, 3
  s_add_u32 s40, s40, s41
  s_mul_i32 s40, s40, 9216
  s_mul_i32 s42, s33, 1152
  s_add_u32 s40, s40, s42
  s_mul_i32 s41, s3, 9216
  s_movk_i32 s42, 911
  s_movk_i32 s43, 9216
  v_add_u32 v6, 0, v0
  v_mul_lo_u32 v7, v6, s42
  v_lshrrev_b32 v7, 16, v7
  v_mul_u32_u24 v8, 72, v7
  v_sub_u32 v8, v6, v8
  v_mul_lo_u32 v7, v7, s43
  v_lshl_add_u32 v10, v8, 4, v7
  s_add_u32 m0, s41, 0
  s_nop 0
  buffer_load_dwordx4 v10, s[16:19], s40 offen lds
  v_add_u32 v6, 64, v0
  v_mul_lo_u32 v7, v6, s42
  v_lshrrev_b32 v7, 16, v7
  v_mul_u32_u24 v8, 72, v7
  v_sub_u32 v8, v6, v8
  v_mul_lo_u32 v7, v7, s43
  v_lshl_add_u32 v11, v8, 4, v7
  s_add_u32 m0, s41, 1024
  s_nop 0
  buffer_load_dwordx4 v11, s[16:19], s40 offen lds
  v_add_u32 v6, 128, v0
  v_mul_lo_u32 v7, v6, s42
  v_lshrrev_b32 v7, 16, v7
  v_mul_u32_u24 v8, 72, v7
  v_sub_u32 v8, v6, v8
  v_mul_lo_u32 v7, v7, s43
  v_lshl_add_u32 v12, v8, 4, v7
  s_add_u32 m0, s41, 2048
  s_nop 0
  buffer_load_dwordx4 v12, s[16:19], s40 offen lds
  v_add_u32 v6, 192, v0
  v_mul_lo_u32 v7, v6, s42
  v_lshrrev_b32 v7, 16, v7
  v_mul_u32_u24 v8, 72, v7
  v_sub_u32 v8, v6, v8
  v_mul_lo_u32 v7, v7, s43
  v_lshl_add_u32 v13, v8, 4, v7
  s_add_u32 m0, s41, 3072
  s_nop 0
  buffer_load_dwordx4 v13, s[16:19], s40 offen lds
  v_add_u32 v6, 256, v0
  v_mul_lo_u32 v7, v6, s42
  v_lshrrev_b32 v7, 16, v7
  v_mul_u32_u24 v8, 72, v7
  v_sub_u32 v8, v6, v8
  v_mul_lo_u32 v7, v7, s43
  v_lshl_add_u32 v14, v8, 4, v7
  s_add_u32 m0, s41, 4096
  s_nop 0
  buffer_load_dwordx4 v14, s[16:19], s40 offen lds
  v_add_u32 v6, 320, v0
  v_mul_lo_u32 v7, v6, s42
  v_lshrrev_b32 v7, 16, v7
  v_mul_u32_u24 v8, 72, v7
  v_sub_u32 v8, v6, v8
  v_mul_lo_u32 v7, v7, s43
  v_lshl_add_u32 v15, v8, 4, v7
  s_add_u32 m0, s41, 5120
  s_nop 0
  buffer_load_dwordx4 v15, s[16:19], s40 offen lds
  v_add_u32 v6, 384, v0
  v_mul_lo_u32 v7, v6, s42
  v_lshrrev_b32 v7, 16, v7
  v_mul_u32_u24 v8, 72, v7
  v_sub_u32 v8, v6, v8
  v_mul_lo_u32 v7, v7, s43
  v_lshl_add_u32 v16, v8, 4, v7
  s_add_u32 m0, s41, 6144
  s_nop 0
  buffer_load_dwordx4 v16, s[16:19], s40 offen lds
  v_add_u32 v6, 448, v0
  v_mul_lo_u32 v7, v6, s42
  v_lshrrev_b32 v7, 16, v7
  v_mul_u32_u24 v8, 72, v7
  v_sub_u32 v8, v6, v8
  v_mul_lo_u32 v7, v7, s43
  v_lshl_add_u32 v17, v8, 4, v7
  s_add_u32 m0, s41, 7168
  s_nop 0
  buffer_load_dwordx4 v17, s[16:19], s40 offen lds
  v_add_u32 v6, 512, v0
  v_mul_lo_u32 v7, v6, s42
  v_lshrrev_b32 v7, 16, v7
  v_mul_u32_u24 v8, 72, v7
  v_sub_u32 v8, v6, v8
  v_mul_lo_u32 v7, v7, s43
  v_lshl_add_u32 v18, v8, 4, v7
  s_add_u32 m0, s41, 8192
  s_nop 0
  buffer_load_dwordx4 v18, s[16:19], s40 offen lds
  s_waitcnt vmcnt(9)
  s_barrier
  s_cmp_lg_u32 s3, 0
  s_cbranch_scc1 L17_sx
  s_lshl_b32 s13, s2, 7
  s_add_u32 s13, s13, 73728
  s_mov_b64 exec, 1
  v_mov_b32 v250, s6
  buffer_store_dword v250, off, s[52:55], s13 sc1
  s_mov_b64 exec, -1
L17_sx:
  s_add_u32 s40, s40, 294912
  s_add_u32 m0, s41, 36864
  s_nop 0
  buffer_load_dwordx4 v10, s[16:19], s40 offen lds
  s_add_u32 m0, s41, 37888
  s_nop 0
  buffer_load_dwordx4 v11, s[16:19], s40 offen lds
  s_add_u32 m0, s41, 38912
  s_nop 0
  buffer_load_dwordx4 v12, s[16:19], s40 offen lds
  s_add_u32 m0, s41, 39936
  s_nop 0
  buffer_load_dwordx4 v13, s[16:19], s40 offen lds
  s_add_u32 m0, s41, 40960
  s_nop 0
  buffer_load_dwordx4 v14, s[16:19], s40 offen lds
  s_add_u32 m0, s41, 41984
  s_nop 0
  buffer_load_dwordx4 v15, s[16:19], s40 offen lds
  s_add_u32 m0, s41, 43008
  s_nop 0
  buffer_load_dwordx4 v16, s[16:19], s40 offen lds
  s_add_u32 m0, s41, 44032
  s_nop 0
  buffer_load_dwordx4 v17, s[16:19], s40 offen lds
  s_add_u32 m0, s41, 45056
  s_nop 0
  buffer_load_dwordx4 v18, s[16:19], s40 offen lds
  s_add_u32 s40, s40, 294912
  s_add_u32 m0, s41, 73728
  s_nop 0
  buffer_load_dwordx4 v10, s[16:19], s40 offen lds
  s_add_u32 m0, s41, 74752
  s_nop 0
  buffer_load_dwordx4 v11, s[16:19], s40 offen lds
  s_add_u32 m0, s41, 75776
  s_nop 0
  buffer_load_dwordx4 v12, s[16:19], s40 offen lds
  s_add_u32 m0, s41, 76800
  s_nop 0
  buffer_load_dwordx4 v13, s[16:19], s40 offen lds
  s_add_u32 m0, s41, 77824
  s_nop 0
  buffer_load_dwordx4 v14, s[16:19], s40 offen lds
  s_add_u32 m0, s41, 78848
  s_nop 0
  buffer_load_dwordx4 v15, s[16:19], s40 offen lds
  s_add_u32 m0, s41, 79872
  s_nop 0
  buffer_load_dwordx4 v16, s[16:19], s40 offen lds
  s_add_u32 m0, s41, 80896
  s_nop 0
  buffer_load_dwordx4 v17, s[16:19], s40 offen lds
  s_add_u32 m0, s41, 81920
  s_nop 0
  buffer_load_dwordx4 v18, s[16:19], s40 offen lds
  v_lshrrev_b32 v7, 2, v3
  v_lshl_add_u32 v7, v4, 3, v7
  v_mul_u32_u24 v7, 1152, v7
  s_mul_i32 s43, s3, 288
  v_add_u32 v7, s43, v7
  v_and_b32 v8, 3, v3
  v_lshl_add_u32 v20, v8, 3, v7
  v_add_u32 v21, 36864, v20
  v_add_u32 v22, 36864, v21
  s_lshl_b32 s44, s33, 2
  s_add_u32 s44, s44, s3
  s_mul_i32 s44, s44, 9*18432
  s_mul_i32 s45, s34, 3072
  s_add_u32 s44, s44, s45
  v_mov_b32 v24, 0x3f803f80
  v_mov_b32 v25, 0x3f803f80
  v_mov_b32 v26, 0x3f803f80
  v_mov_b32 v27, 0x3f803f80
  s_waitcnt vmcnt(18)
  s_barrier
  ds_read_b64_tr_b16 v[32:33], v20 offset:0
  ds_read_b64_tr_b16 v[34:35], v20 offset:4608
  ds_read_b64_tr_b16 v[36:37], v20 offset:32
  ds_read_b64_tr_b16 v[38:39], v20 offset:4640
  ds_read_b64_tr_b16 v[40:41], v20 offset:64
  ds_read_b64_tr_b16 v[42:43], v20 offset:4672
  ds_read_b64_tr_b16 v[44:45], v20 offset:96
  ds_read_b64_tr_b16 v[46:47], v20 offset:4704
  ds_read_b64_tr_b16 v[48:49], v20 offset:128
  ds_read_b64_tr_b16 v[50:51], v20 offset:4736
  ds_read_b64_tr_b16 v[52:53], v20 offset:160
  ds_read_b64_tr_b16 v[54:55], v20 offset:4768
  ds_read_b64_tr_b16 v[56:57], v20 offset:192
  ds_read_b64_tr_b16 v[58:59], v20 offset:4800
  ds_read_b64_tr_b16 v[60:61], v20 offset:224
  ds_read_b64_tr_b16 v[62:63], v20 offset:4832
  ds_read_b64_tr_b16 v[64:65], v20 offset:256
  ds_read_b64_tr_b16 v[66:67], v20 offset:4864
  s_add_u32 s45, s44, 0
  s_waitcnt lgkmcnt(15)
  buffer_store_dwordx4 v[32:35], v5, s[20:23], s45 offen sc1
  s_add_u32 s45, s45, 18432
  v_mfma_f32_16x16x32_bf16 v[144:147], v[24:27], v[32:35], 0
  s_waitcnt lgkmcnt(14)
  buffer_store_dwordx4 v[36:39], v5, s[20:23], s45 offen sc1
  s_add_u32 s45, s45, 18432
  v_mfma_f32_16x16x32_bf16 v[148:151], v[24:27], v[36:39], 0
  s_waitcnt lgkmcnt(12)
  buffer_store_dwordx4 v[40:43], v5, s[20:23], s45 offen sc1
  s_add_u32 s45, s45, 18432
  v_mfma_f32_16x16x32_bf16 v[152:155], v[24:27], v[40:43], 0
  s_waitcnt lgkmcnt(10)
  buffer_store_dwordx4 v[44:47], v5, s[20:23], s45 offen sc1
  s_add_u32 s45, s45, 18432
  v_mfma_f32_16x16x32_bf16 v[156:159], v[24:27], v[44:47], 0
  s_waitcnt lgkmcnt(8)
  buffer_store_dwordx4 v[48:51], v5, s[20:23], s45 offen sc1
  s_add_u32 s45, s45, 18432
  v_mfma_f32_16x16x32_bf16 v[160:163], v[24:27], v[48:51], 0
  s_waitcnt lgkmcnt(6)
  buffer_store_dwordx4 v[52:55], v5, s[20:23], s45 offen sc1
  s_add_u32 s45, s45, 18432
  v_mfma_f32_16x16x32_bf16 v[164:167], v[24:27], v[52:55], 0
  s_waitcnt lgkmcnt(4)
  buffer_store_dwordx4 v[56:59], v5, s[20:23], s45 offen sc1
  s_add_u32 s45, s45, 18432
  v_mfma_f32_16x16x32_bf16 v[168:171], v[24:27], v[56:59], 0
  s_waitcnt lgkmcnt(2)
  buffer_store_dwordx4 v[60:63], v5, s[20:23], s45 offen sc1
  s_add_u32 s45, s45, 18432
  v_mfma_f32_16x16x32_bf16 v[172:175], v[24:27], v[60:63], 0
  s_waitcnt lgkmcnt(0)
  buffer_store_dwordx4 v[64:67], v5, s[20:23], s45 offen sc1
  s_add_u32 s45, s45, 18432
  v_mfma_f32_16x16x32_bf16 v[176:179], v[24:27], v[64:67], 0
  s_waitcnt vmcnt(18)
  s_barrier
  ds_read_b64_tr_b16 v[68:69], v21 offset:0
  ds_read_b64_tr_b16 v[70:71], v21 offset:4608
  ds_read_b64_tr_b16 v[72:73], v21 offset:32
  ds_read_b64_tr_b16 v[74:75], v21 offset:4640
  ds_read_b64_tr_b16 v[76:77], v21 offset:64
  ds_read_b64_tr_b16 v[78:79], v21 offset:4672
  ds_read_b64_tr_b16 v[80:81], v21 offset:96
  ds_read_b64_tr_b16 v[82:83], v21 offset:4704
  ds_read_b64_tr_b16 v[84:85], v21 offset:128
  ds_read_b64_tr_b16 v[86:87], v21 offset:4736
  ds_read_b64_tr_b16 v[88:89], v21 offset:160
  ds_read_b64_tr_b16 v[90:91], v21 offset:4768
  ds_read_b64_tr_b16 v[92:93], v21 offset:192
  ds_read_b64_tr_b16 v[94:95], v21 offset:4800
  ds_read_b64_tr_b16 v[96:97], v21 offset:224
  ds_read_b64_tr_b16 v[98:99], v21 offset:4832
  ds_read_b64_tr_b16 v[100:101], v21 offset:256
  ds_read_b64_tr_b16 v[102:103], v21 offset:4864
  s_add_u32 s45, s44, 1024
  s_waitcnt lgkmcnt(15)
  buffer_store_dwordx4 v[68:71], v5, s[20:23], s45 offen sc1
  s_add_u32 s45, s45, 18432
  v_mfma_f32_16x16x32_bf16 v[144:147], v[24:27], v[68:71], v[144:147]
  s_waitcnt lgkmcnt(14)
  buffer_store_dwordx4 v[72:75], v5, s[20:23], s45 offen sc1
  s_add_u32 s45, s45, 18432
  v_mfma_f32_16x16x32_bf16 v[148:151], v[24:27], v[72:75], v[148:151]
  s_waitcnt lgkmcnt(12)
  buffer_store_dwordx4 v[76:79], v5, s[20:23], s45 offen sc1
  s_add_u32 s45, s45, 18432
  v_mfma_f32_16x16x32_bf16 v[152:155], v[24:27], v[76:79], v[152:155]
  s_waitcnt lgkmcnt(10)
  buffer_store_dwordx4 v[80:83], v5, s[20:23], s45 offen sc1
  s_add_u32 s45, s45, 18432
  v_mfma_f32_16x16x32_bf16 v[156:159], v[24:27], v[80:83], v[156:159]
  s_waitcnt lgkmcnt(8)
  buffer_store_dwordx4 v[84:87], v5, s[20:23], s45 offen sc1
  s_add_u32 s45, s45, 18432
  v_mfma_f32_16x16x32_bf16 v[160:163], v[24:27], v[84:87], v[160:163]
  s_waitcnt lgkmcnt(6)
  buffer_store_dwordx4 v[88:91], v5, s[20:23], s45 offen sc1
  s_add_u32 s45, s45, 18432
  v_mfma_f32_16x16x32_bf16 v[164:167], v[24:27], v[88:91], v[164:167]
  s_waitcnt lgkmcnt(4)
  buffer_store_dwordx4 v[92:95], v5, s[20:23], s45 offen sc1
  s_add_u32 s45, s45, 18432
  v_mfma_f32_16x16x32_bf16 v[168:171], v[24:27], v[92:95], v[168:171]
  s_waitcnt lgkmcnt(2)
  buffer_store_dwordx4 v[96:99], v5, s[20:23], s45 offen sc1
  s_add_u32 s45, s45, 18432
  v_mfma_f32_16x16x32_bf16 v[172:175], v[24:27], v[96:99], v[172:175]
  s_waitcnt lgkmcnt(0)
  buffer_store_dwordx4 v[100:103], v5, s[20:23], s45 offen sc1
  s_add_u32 s45, s45, 18432
  v_mfma_f32_16x16x32_bf16 v[176:179], v[24:27], v[100:103], v[176:179]
  s_waitcnt vmcnt(18)
  s_barrier
  ds_read_b64_tr_b16 v[104:105], v22 offset:0
  ds_read_b64_tr_b16 v[106:107], v22 offset:4608
  ds_read_b64_tr_b16 v[108:109], v22 offset:32
  ds_read_b64_tr_b16 v[110:111], v22 offset:4640
  ds_read_b64_tr_b16 v[112:113], v22 offset:64
  ds_read_b64_tr_b16 v[114:115], v22 offset:4672
  ds_read_b64_tr_b16 v[116:117], v22 offset:96
  ds_read_b64_tr_b16 v[118:119], v22 offset:4704
  ds_read_b64_tr_b16 v[120:121], v22 offset:128
  ds_read_b64_tr_b16 v[122:123], v22 offset:4736
  ds_read_b64_tr_b16 v[124:125], v22 offset:160
  ds_read_b64_tr_b16 v[126:127], v22 offset:4768
  ds_read_b64_tr_b16 v[128:129], v22 offset:192
  ds_read_b64_tr_b16 v[130:131], v22 offset:4800
  ds_read_b64_tr_b16 v[132:133], v22 offset:224
  ds_read_b64_tr_b16 v[134:135], v22 offset:4832
  ds_read_b64_tr_b16 v[136:137], v22 offset:256
  ds_read_b64_tr_b16 v[138:139], v22 offset:4864
  s_add_u32 s45, s44, 2048
  s_waitcnt lgkmcnt(15)
  buffer_store_dwordx4 v[104:107], v5, s[20:23], s45 offen sc1
  s_add_u32 s45, s45, 18432
  v_mfma_f32_16x16x32_bf16 v[144:147], v[24:27], v[104:107], v[144:147]
  s_waitcnt lgkmcnt(14)
  buffer_store_dwordx4 v[108:111], v5, s[20:23], s45 offen sc1
  s_add_u32 s45, s45, 18432
  v_mfma_f32_16x16x32_bf16 v[148:151], v[24:27], v[108:111], v[148:151]
  s_waitcnt lgkmcnt(12)
  buffer_store_dwordx4 v[112:115], v5, s[20:23], s45 offen sc1
  s_add_u32 s45, s45, 18432
  v_mfma_f32_16x16x32_bf16 v[152:155], v[24:27], v[112:115], v[152:155]
  s_waitcnt lgkmcnt(10)
  buffer_store_dwordx4 v[116:119], v5, s[20:23], s45 offen sc1
  s_add_u32 s45, s45, 18432
  v_mfma_f32_16x16x32_bf16 v[156:159], v[24:27], v[116:119], v[156:159]
  s_waitcnt lgkmcnt(8)
  buffer_store_dwordx4 v[120:123], v5, s[20:23], s45 offen sc1
  s_add_u32 s45, s45, 18432
  v_mfma_f32_16x16x32_bf16 v[160:163], v[24:27], v[120:123], v[160:163]
  s_waitcnt lgkmcnt(6)
  buffer_store_dwordx4 v[124:127], v5, s[20:23], s45 offen sc1
  s_add_u32 s45, s45, 18432
  v_mfma_f32_16x16x32_bf16 v[164:167], v[24:27], v[124:127], v[164:167]
  s_waitcnt lgkmcnt(4)
  buffer_store_dwordx4 v[128:131], v5, s[20:23], s45 offen sc1
  s_add_u32 s45, s45, 18432
  v_mfma_f32_16x16x32_bf16 v[168:171], v[24:27], v[128:131], v[168:171]
  s_waitcnt lgkmcnt(2)
  buffer_store_dwordx4 v[132:135], v5, s[20:23], s45 offen sc1
  s_add_u32 s45, s45, 18432
  v_mfma_f32_16x16x32_bf16 v[172:175], v[24:27], v[132:135], v[172:175]
  s_waitcnt lgkmcnt(0)
  buffer_store_dwordx4 v[136:139], v5, s[20:23], s45 offen sc1
  s_add_u32 s45, s45, 18432
  v_mfma_f32_16x16x32_bf16 v[176:179], v[24:27], v[136:139], v[176:179]
  s_mul_i32 s45, s33, 6
  s_add_u32 s45, s45, s34
  s_mul_i32 s45, s45, 2304
  s_mul_i32 s46, s3, 576
  s_add_u32 s45, s45, s46
  v_lshlrev_b32 v6, 2, v0
  v_mov_b32 v7, 2146435072
  v_cmp_gt_u32 vcc, 16, v0
  s_nop 1
  v_cndmask_b32 v7, v7, v6, vcc
  v_cmp_eq_u32 vcc, 1, v4
  s_nop 1
  v_cndmask_b32 v144, v144, v148, vcc
  v_cmp_eq_u32 vcc, 2, v4
  s_nop 1
  v_cndmask_b32 v144, v144, v152, vcc
  v_cmp_eq_u32 vcc, 3, v4
  s_nop 1
  v_cndmask_b32 v144, v144, v156, vcc
  buffer_store_dword v144, v6, s[36:39], s45 offen offset:0 sc1
  v_cmp_eq_u32 vcc, 1, v4
  s_nop 1
  v_cndmask_b32 v160, v160, v164, vcc
  v_cmp_eq_u32 vcc, 2, v4
  s_nop 1
  v_cndmask_b32 v160, v160, v168, vcc
  v_cmp_eq_u32 vcc, 3, v4
  s_nop 1
  v_cndmask_b32 v160, v160, v172, vcc
  buffer_store_dword v160, v6, s[36:39], s45 offen offset:256 sc1
  buffer_store_dword v176, v7, s[36:39], s45 offen offset:512 sc1
  s_branch L16_rdone
L15_w2:
  s_waitcnt vmcnt(0)
  s_barrier
  s_cmp_lg_u32 s3, 0
  s_cbranch_scc1 L18_sx
  s_lshl_b32 s13, s2, 7
  s_add_u32 s13, s13, 73728
  s_mov_b64 exec, 1
  v_mov_b32 v250, s6
  buffer_store_dword v250, off, s[52:55], s13 sc1
  s_mov_b64 exec, -1
L18_sx:
  s_lshl_b32 s16, s2, 7
  s_add_u32 s16, s16, 4096
  v_mov_b32 v6, 0
  s_mov_b32 s7, 262144
L19_poll:
  buffer_load_dword v7, v6, s[52:55], s16 offen sc1
  s_waitcnt vmcnt(0)
  v_cmp_ne_u32 vcc, s6, v7
  s_sub_u32 s7, s7, 1
  s_cmp_eq_u32 s7, 0
  s_cbranch_scc1 L20_pollx
  s_nop 0
  s_cbranch_vccnz L19_poll
L20_pollx:
  s_mov_b32 s16, s60
  s_mov_b32 s17, s61
  s_mov_b32 s18, 5308416
  s_mov_b32 s19, 0x20000
  s_sub_u32 s34, s34, 6
  s_mul_i32 s35, s34, 3
  s_mul_i32 s36, s33, 576
  s_lshl_b32 s37, s3, 10
  v_add_u32 v6, s37, v5
  s_cmp_lt_u32 s3, 2
  s_cselect_b32 s43, 0, 0x40000000
  s_cselect_b32 s44, 0, 1
  s_add_u32 s38, s35, 0
  s_and_b32 s39, s38, 3
  s_mul_i32 s39, s39, 144
  s_lshr_b32 s40, s38, 2
  s_lshl_b32 s40, s40, 5
  s_add_u32 s39, s39, s40
  s_add_u32 s40, s39, 16
  s_cmp_eq_u32 s38, 16
  s_cselect_b32 s39, 128, s39
  s_cselect_b32 s40, 272, s40
  s_cmp_eq_u32 s38, 17
  s_cselect_b32 s39, 416, s39
  s_cselect_b32 s40, 560, s40
  s_add_u32 s41, s36, s39
  s_mul_i32 s41, s41, 1152
  s_add_u32 s42, s37, 0
  s_add_u32 m0, s42, 0
  s_nop 0
  buffer_load_dwordx4 v6, s[16:19], s41 offen lds
  s_add_u32 s41, s41, 4096
  s_add_u32 m0, s42, 4096
  s_nop 0
  buffer_load_dwordx4 v6, s[16:19], s41 offen lds
  s_add_u32 s41, s41, 4096
  s_add_u32 m0, s42, 8192
  s_nop 0
  buffer_load_dwordx4 v6, s[16:19], s41 offen lds
  s_add_u32 s41, s41, 4096
  s_add_u32 m0, s42, 12288
  s_nop 0
  buffer_load_dwordx4 v6, s[16:19], s41 offen lds
  s_add_u32 s41, s41, 4096
  s_add_u32 s41, s41, s43
  s_add_u32 s45, s42, 16384
  s_cmp_eq_u32 s44, 0
  s_cselect_b32 m0, s45, 133120
  s_nop 0
  buffer_load_dwordx4 v6, s[16:19], s41 offen lds
  s_add_u32 s41, s36, s40
  s_mul_i32 s41, s41, 1152
  s_add_u32 s42, s37, 18432
  s_add_u32 m0, s42, 0
  s_nop 0
  buffer_load_dwordx4 v6, s[16:19], s41 offen lds
  s_add_u32 s41, s41, 4096
  s_add_u32 m0, s42, 4096
  s_nop 0
  buffer_load_dwordx4 v6, s[16:19], s41 offen lds
  s_add_u32 s41, s41, 4096
  s_add_u32 m0, s42, 8192
  s_nop 0
  buffer_load_dwordx4 v6, s[16:19], s41 offen lds
  s_add_u32 s41, s41, 4096
  s_add_u32 m0, s42, 12288
  s_nop 0
  buffer_load_dwordx4 v6, s[16:19], s41 offen lds
  s_add_u32 s41, s41, 4096
  s_add_u32 s41, s41, s43
  s_add_u32 s45, s42, 16384
  s_cmp_eq_u32 s44, 0
  s_cselect_b32 m0, s45, 133120
  s_nop 0
  buffer_load_dwordx4 v6, s[16:19], s41 offen lds
  s_add_u32 s38, s35, 1
  s_and_b32 s39, s38, 3
  s_mul_i32 s39, s39, 144
  s_lshr_b32 s40, s38, 2
  s_lshl_b32 s40, s40, 5
  s_add_u32 s39, s39, s40
  s_add_u32 s40, s39, 16
  s_cmp_eq_u32 s38, 16
  s_cselect_b32 s39, 128, s39
  s_cselect_b32 s40, 272, s40
  s_cmp_eq_u32 s38, 17
  s_cselect_b32 s39, 416, s39
  s_cselect_b32 s40, 560, s40
  s_add_u32 s41, s36, s39
  s_mul_i32 s41, s41, 1152
  s_add_u32 s42, s37, 36864
  s_add_u32 m0, s42, 0
  s_nop 0
  buffer_load_dwordx4 v6, s[16:19], s41 offen lds
  s_add_u32 s41, s41, 4096
  s_add_u32 m0, s42, 4096
  s_nop 0
  buffer_load_dwordx4 v6, s[16:19], s41 offen lds
  s_add_u32 s41, s41, 4096
  s_add_u32 m0, s42, 8192
  s_nop 0
  buffer_load_dwordx4 v6, s[16:19], s41 offen lds
  s_add_u32 s41, s41, 4096
  s_add_u32 m0, s42, 12288
  s_nop 0
  buffer_load_dwordx4 v6, s[16:19], s41 offen lds
  s_add_u32 s41, s41, 4096
  s_add_u32 s41, s41, s43
  s_add_u32 s45, s42, 16384
  s_cmp_eq_u32 s44, 0
  s_cselect_b32 m0, s45, 133120
  s_nop 0
  buffer_load_dwordx4 v6, s[16:19], s41 offen lds
  s_add_u32 s41, s36, s40
  s_mul_i32 s41, s41, 1152
  s_add_u32 s42, s37, 55296
  s_add_u32 m0, s42, 0
  s_nop 0
  buffer_load_dwordx4 v6, s[16:19], s41 offen lds
  s_add_u32 s41, s41, 4096
  s_add_u32 m0, s42, 4096
  s_nop 0
  buffer_load_dwordx4 v6, s[16:19], s41 offen lds
  s_add_u32 s41, s41, 4096
  s_add_u32 m0, s42, 8192
  s_nop 0
  buffer_load_dwordx4 v6, s[16:19], s41 offen lds
  s_add_u32 s41, s41, 4096
  s_add_u32 m0, s42, 12288
  s_nop 0
  buffer_load_dwordx4 v6, s[16:19], s41 offen lds
  s_add_u32 s41, s41, 4096
  s_add_u32 s41, s41, s43
  s_add_u32 s45, s42, 16384
  s_cmp_eq_u32 s44, 0
  s_cselect_b32 m0, s45, 133120
  s_nop 0
  buffer_load_dwordx4 v6, s[16:19], s41 offen lds
  s_add_u32 s38, s35, 2
  s_and_b32 s39, s38, 3
  s_mul_i32 s39, s39, 144
  s_lshr_b32 s40, s38, 2
  s_lshl_b32 s40, s40, 5
  s_add_u32 s39, s39, s40
  s_add_u32 s40, s39, 16
  s_cmp_eq_u32 s38, 16
  s_cselect_b32 s39, 128, s39
  s_cselect_b32 s40, 272, s40
  s_cmp_eq_u32 s38, 17
  s_cselect_b32 s39, 416, s39
  s_cselect_b32 s40, 560, s40
  s_add_u32 s41, s36, s39
  s_mul_i32 s41, s41, 1152
  s_add_u32 s42, s37, 73728
  s_add_u32 m0, s42, 0
  s_nop 0
  buffer_load_dwordx4 v6, s[16:19], s41 offen lds
  s_add_u32 s41, s41, 4096
  s_add_u32 m0, s42, 4096
  s_nop 0
  buffer_load_dwordx4 v6, s[16:19], s41 offen lds
  s_add_u32 s41, s41, 4096
  s_add_u32 m0, s42, 8192
  s_nop 0
  buffer_load_dwordx4 v6, s[16:19], s41 offen lds
  s_add_u32 s41, s41, 4096
  s_add_u32 m0, s42, 12288
  s_nop 0
  buffer_load_dwordx4 v6, s[16:19], s41 offen lds
  s_add_u32 s41, s41, 4096
  s_add_u32 s41, s41, s43
  s_add_u32 s45, s42, 16384
  s_cmp_eq_u32 s44, 0
  s_cselect_b32 m0, s45, 133120
  s_nop 0
  buffer_load_dwordx4 v6, s[16:19], s41 offen lds
  s_add_u32 s41, s36, s40
  s_mul_i32 s41, s41, 1152
  s_add_u32 s42, s37, 92160
  s_add_u32 m0, s42, 0
  s_nop 0
  buffer_load_dwordx4 v6, s[16:19], s41 offen lds
  s_add_u32 s41, s41, 4096
  s_add_u32 m0, s42, 4096
  s_nop 0
  buffer_load_dwordx4 v6, s[16:19], s41 offen lds
  s_add_u32 s41, s41, 4096
  s_add_u32 m0, s42, 8192
  s_nop 0
  buffer_load_dwordx4 v6, s[16:19], s41 offen lds
  s_add_u32 s41, s41, 4096
  s_add_u32 m0, s42, 12288
  s_nop 0
  buffer_load_dwordx4 v6, s[16:19], s41 offen lds
  s_add_u32 s41, s41, 4096
  s_add_u32 s41, s41, s43
  s_add_u32 s45, s42, 16384
  s_cmp_eq_u32 s44, 0
  s_cselect_b32 m0, s45, 133120
  s_nop 0
  buffer_load_dwordx4 v6, s[16:19], s41 offen lds
  v_lshrrev_b32 v7, 2, v3
  v_lshl_add_u32 v7, v4, 2, v7
  s_movk_i32 s43, 1152
  v_mul_lo_u32 v7, v7, s43
  s_mul_i32 s43, s3, 288
  v_add_u32 v7, s43, v7
  v_and_b32 v8, 3, v3
  v_lshl_add_u32 v10, v8, 4, v7
  v_lshl_add_u32 v13, v8, 3, v7
  v_add_u32 v13, 256, v13
  v_add_u32 v11, 36864, v10
  v_add_u32 v14, 36864, v13
  v_add_u32 v12, 73728, v10
  v_add_u32 v15, 73728, v13
  s_lshl_b32 s44, s33, 2
  s_add_u32 s44, s44, s3
  s_mul_i32 s44, s44, 9*18432
  s_lshl_b32 s45, s35, 10
  s_add_u32 s44, s44, s45
  s_waitcnt vmcnt(20)
  s_barrier
  ds_read_b64_tr_b16 v[32:33], v10 offset:0
  ds_read_b64_tr_b16 v[34:35], v10 offset:18432
  ds_read_b64_tr_b16 v[36:37], v10 offset:8
  ds_read_b64_tr_b16 v[38:39], v10 offset:18440
  ds_read_b64_tr_b16 v[40:41], v10 offset:64
  ds_read_b64_tr_b16 v[42:43], v10 offset:18496
  ds_read_b64_tr_b16 v[44:45], v10 offset:72
  ds_read_b64_tr_b16 v[46:47], v10 offset:18504
  ds_read_b64_tr_b16 v[48:49], v10 offset:128
  ds_read_b64_tr_b16 v[50:51], v10 offset:18560
  ds_read_b64_tr_b16 v[52:53], v10 offset:136
  ds_read_b64_tr_b16 v[54:55], v10 offset:18568
  ds_read_b64_tr_b16 v[56:57], v10 offset:192
  ds_read_b64_tr_b16 v[58:59], v10 offset:18624
  ds_read_b64_tr_b16 v[60:61], v10 offset:200
  ds_read_b64_tr_b16 v[62:63], v10 offset:18632
  ds_read_b64_tr_b16 v[64:65], v13 offset:0
  ds_read_b64_tr_b16 v[66:67], v13 offset:18432
  s_add_u32 s45, s44, 0
  s_waitcnt lgkmcnt(15)
  buffer_store_dwordx4 v[32:35], v5, s[24:27], s45 offen sc1
  s_add_u32 s45, s45, 18432
  s_waitcnt lgkmcnt(14)
  buffer_store_dwordx4 v[36:39], v5, s[24:27], s45 offen sc1
  s_add_u32 s45, s45, 18432
  s_waitcnt lgkmcnt(12)
  buffer_store_dwordx4 v[40:43], v5, s[24:27], s45 offen sc1
  s_add_u32 s45, s45, 18432
  s_waitcnt lgkmcnt(10)
  buffer_store_dwordx4 v[44:47], v5, s[24:27], s45 offen sc1
  s_add_u32 s45, s45, 18432
  s_waitcnt lgkmcnt(8)
  buffer_store_dwordx4 v[48:51], v5, s[24:27], s45 offen sc1
  s_add_u32 s45, s45, 18432
  s_waitcnt lgkmcnt(6)
  buffer_store_dwordx4 v[52:55], v5, s[24:27], s45 offen sc1
  s_add_u32 s45, s45, 18432
  s_waitcnt lgkmcnt(4)
  buffer_store_dwordx4 v[56:59], v5, s[24:27], s45 offen sc1
  s_add_u32 s45, s45, 18432
  s_waitcnt lgkmcnt(2)
  buffer_store_dwordx4 v[60:63], v5, s[24:27], s45 offen sc1
  s_add_u32 s45, s45, 18432
  s_waitcnt lgkmcnt(0)
  buffer_store_dwordx4 v[64:67], v5, s[24:27], s45 offen sc1
  s_add_u32 s45, s45, 18432
  s_waitcnt vmcnt(19)
  s_barrier
  ds_read_b64_tr_b16 v[68:69], v11 offset:0
  ds_read_b64_tr_b16 v[70:71], v11 offset:18432
  ds_read_b64_tr_b16 v[72:73], v11 offset:8
  ds_read_b64_tr_b16 v[74:75], v11 offset:18440
  ds_read_b64_tr_b16 v[76:77], v11 offset:64
  ds_read_b64_tr_b16 v[78:79], v11 offset:18496
  ds_read_b64_tr_b16 v[80:81], v11 offset:72
  ds_read_b64_tr_b16 v[82:83], v11 offset:18504
  ds_read_b64_tr_b16 v[84:85], v11 offset:128
  ds_read_b64_tr_b16 v[86:87], v11 offset:18560
  ds_read_b64_tr_b16 v[88:89], v11 offset:136
  ds_read_b64_tr_b16 v[90:91], v11 offset:18568
  ds_read_b64_tr_b16 v[92:93], v11 offset:192
  ds_read_b64_tr_b16 v[94:95], v11 offset:18624
  ds_read_b64_tr_b16 v[96:97], v11 offset:200
  ds_read_b64_tr_b16 v[98:99], v11 offset:18632
  ds_read_b64_tr_b16 v[100:101], v14 offset:0
  ds_read_b64_tr_b16 v[102:103], v14 offset:18432
  s_add_u32 s45, s44, 1024
  s_waitcnt lgkmcnt(15)
  buffer_store_dwordx4 v[68:71], v5, s[24:27], s45 offen sc1
  s_add_u32 s45, s45, 18432
  s_waitcnt lgkmcnt(14)
  buffer_store_dwordx4 v[72:75], v5, s[24:27], s45 offen sc1
  s_add_u32 s45, s45, 18432
  s_waitcnt lgkmcnt(12)
  buffer_store_dwordx4 v[76:79], v5, s[24:27], s45 offen sc1
  s_add_u32 s45, s45, 18432
  s_waitcnt lgkmcnt(10)
  buffer_store_dwordx4 v[80:83], v5, s[24:27], s45 offen sc1
  s_add_u32 s45, s45, 18432
  s_waitcnt lgkmcnt(8)
  buffer_store_dwordx4 v[84:87], v5, s[24:27], s45 offen sc1
  s_add_u32 s45, s45, 18432
  s_waitcnt lgkmcnt(6)
  buffer_store_dwordx4 v[88:91], v5, s[24:27], s45 offen sc1
  s_add_u32 s45, s45, 18432
  s_waitcnt lgkmcnt(4)
  buffer_store_dwordx4 v[92:95], v5, s[24:27], s45 offen sc1
  s_add_u32 s45, s45, 18432
  s_waitcnt lgkmcnt(2)
  buffer_store_dwordx4 v[96:99], v5, s[24:27], s45 offen sc1
  s_add_u32 s45, s45, 18432
  s_waitcnt lgkmcnt(0)
  buffer_store_dwordx4 v[100:103], v5, s[24:27], s45 offen sc1
  s_add_u32 s45, s45, 18432
  s_waitcnt vmcnt(18)
  s_barrier
  ds_read_b64_tr_b16 v[104:105], v12 offset:0
  ds_read_b64_tr_b16 v[106:107], v12 offset:18432
  ds_read_b64_tr_b16 v[108:109], v12 offset:8
  ds_read_b64_tr_b16 v[110:111], v12 offset:18440
  ds_read_b64_tr_b16 v[112:113], v12 offset:64
  ds_read_b64_tr_b16 v[114:115], v12 offset:18496
  ds_read_b64_tr_b16 v[116:117], v12 offset:72
  ds_read_b64_tr_b16 v[118:119], v12 offset:18504
  ds_read_b64_tr_b16 v[120:121], v12 offset:128
  ds_read_b64_tr_b16 v[122:123], v12 offset:18560
  ds_read_b64_tr_b16 v[124:125], v12 offset:136
  ds_read_b64_tr_b16 v[126:127], v12 offset:18568
  ds_read_b64_tr_b16 v[128:129], v12 offset:192
  ds_read_b64_tr_b16 v[130:131], v12 offset:18624
  ds_read_b64_tr_b16 v[132:133], v12 offset:200
  ds_read_b64_tr_b16 v[134:135], v12 offset:18632
  ds_read_b64_tr_b16 v[136:137], v15 offset:0
  ds_read_b64_tr_b16 v[138:139], v15 offset:18432
  s_add_u32 s45, s44, 2048
  s_waitcnt lgkmcnt(15)
  buffer_store_dwordx4 v[104:107], v5, s[24:27], s45 offen sc1
  s_add_u32 s45, s45, 18432
  s_waitcnt lgkmcnt(14)
  buffer_store_dwordx4 v[108:111], v5, s[24:27], s45 offen sc1
  s_add_u32 s45, s45, 18432
  s_waitcnt lgkmcnt(12)
  buffer_store_dwordx4 v[112:115], v5, s[24:27], s45 offen sc1
  s_add_u32 s45, s45, 18432
  s_waitcnt lgkmcnt(10)
  buffer_store_dwordx4 v[116:119], v5, s[24:27], s45 offen sc1
  s_add_u32 s45, s45, 18432
  s_waitcnt lgkmcnt(8)
  buffer_store_dwordx4 v[120:123], v5, s[24:27], s45 offen sc1
  s_add_u32 s45, s45, 18432
  s_waitcnt lgkmcnt(6)
  buffer_store_dwordx4 v[124:127], v5, s[24:27], s45 offen sc1
  s_add_u32 s45, s45, 18432
  s_waitcnt lgkmcnt(4)
  buffer_store_dwordx4 v[128:131], v5, s[24:27], s45 offen sc1
  s_add_u32 s45, s45, 18432
  s_waitcnt lgkmcnt(2)
  buffer_store_dwordx4 v[132:135], v5, s[24:27], s45 offen sc1
  s_add_u32 s45, s45, 18432
  s_waitcnt lgkmcnt(0)
  buffer_store_dwordx4 v[136:139], v5, s[24:27], s45 offen sc1
  s_add_u32 s45, s45, 18432
L16_rdone:
  s_lshl_b32 s21, s32, 7
  s_add_u32 s21, s21, 55296
  s_branch L_mlp
L_idle:
  s_waitcnt vmcnt(0)
  s_barrier
  s_cmp_lg_u32 s3, 0
  s_cbranch_scc1 L21_sx
  s_lshl_b32 s13, s2, 7
  s_add_u32 s13, s13, 73728
  s_mov_b64 exec, 1
  v_mov_b32 v250, s6
  buffer_store_dword v250, off, s[52:55], s13 sc1
  s_mov_b64 exec, -1
L21_sx:
  s_mov_b32 s21, 0x40000000
L_mlp:
  v_lshlrev_b32 v1, 4, v0
  s_and_b32 s8, s2, 7
  s_lshr_b32 s9, s2, 3
  s_and_b32 s66, s8, 3
  s_lshl_b32 s66, s66, 1
  s_and_b32 s10, s9, 1
  s_add_u32 s66, s66, s10
  s_lshr_b32 s67, s8, 2
  s_mul_i32 s67, s67, 16
  s_lshr_b32 s10, s9, 1
  s_add_u32 s67, s67, s10
  v_min_u32 v22, 5, v0
  v_lshlrev_b32 v22, 10, v22
  s_lshl_b32 s26, s66, 7
  s_add_u32 s26, s26, 55296
  v_min_u32 v170, 5, v0
  v_lshlrev_b32 v170, 10, v170
  buffer_load_dword v21, v22, s[52:55], s26 offen sc1
  v_lshrrev_b32 v20, 4, v0
  v_and_b32 v20, 1, v20
  v_lshlrev_b32 v20, 1, v20
  v_and_b32 v19, 7, v0
  v_xor_b32 v19, v19, v20
  v_lshlrev_b32 v19, 4, v19
  v_lshrrev_b32 v20, 3, v0
  v_lshl_add_u32 v19, v20, 7, v19
  v_xor_b32 v20, 64, v19
  s_and_b32 s9, s3, 1
  s_lshl_b32 s9, s9, 6
  v_xor_b32 v171, s9, v19
  s_mul_i32 s8, s67, 73728
  s_lshl_b32 s9, s3, 10
  s_add_u32 s8, s8, s9
  s_lshl_b32 s10, s66, 2
  s_add_u32 s10, s10, s3
  s_mul_i32 s10, s10, 9*18432
  s_add_u32 s22, s10, 7344128
  s_add_u32 s22, s4, s22
  s_addc_u32 s23, s5, 0
  s_add_u32 s24, s10, 12652544
  s_add_u32 s24, s4, s24
  s_addc_u32 s25, s5, 0
  s_add_u32 s12, s4, 4718592
  s_addc_u32 s13, s5, 0
  s_mov_b32 s14, 2359296
  s_mov_b32 s15, 0x20000
  s_add_u32 s16, s4, 7143424
  s_addc_u32 s17, s5, 0
  s_mov_b32 s18, 110592
  s_mov_b32 s19, 0x20000
  s_mul_i32 s20, s3, 1152
  s_mul_i32 s11, s66, 6*2304
  s_mul_i32 s26, s3, 576
  s_add_u32 s11, s11, s26
  s_mov_b32 s32, s58
  s_mov_b32 s33, s59
  s_mov_b32 s34, 9216
  s_mov_b32 s35, 0x20000
  v_mov_b32 v25, 2146435072
  v_cmp_gt_u32 vcc, 36, v0
  v_lshlrev_b32 v24, 3, v0
  s_nop 0
  v_cndmask_b32 v24, v25, v24, vcc
  v_cndmask_b32 v167, v25, v1, vcc
  s_mul_i32 s26, s66, 1152
  s_mul_i32 s27, s3, 288
  s_add_u32 s26, s26, s27
  buffer_load_dwordx2 v[168:169], v24, s[32:35], s26 offen
  v_and_b32 v28, 15, v0
  v_lshrrev_b32 v29, 4, v0
  v_lshrrev_b32 v24, 2, v28
  v_lshl_add_u32 v24, v29, 3, v24
  v_lshlrev_b32 v24, 7, v24
  v_and_b32 v25, 1, v28
  v_lshl_add_u32 v24, v25, 3, v24
  v_lshrrev_b32 v25, 3, v28
  v_lshlrev_b32 v25, 1, v25
  v_and_b32 v26, 1, v29
  v_lshl_add_u32 v25, v26, 2, v25
  v_lshrrev_b32 v26, 1, v28
  v_and_b32 v26, 1, v26
  v_xor_b32 v25, v25, v26
  s_add_u32 s26, s3, 0
  s_and_b32 s26, s26, 3
  s_lshl_b32 s28, s26, 10
  s_lshl_b32 s27, s26, 1
  v_xor_b32 v26, s27, v25
  v_lshl_add_u32 v2, v26, 4, v24
  s_add_u32 s27, s28, 73728
  v_add_u32 v10, s27, v1
  s_lshl_b32 s32, s3, 12
  v_add_u32 v6, s32, v10
  s_lshl_b32 s27, s26, 7
  s_add_u32 s27, s27, 147456
  v_lshl_add_u32 v15, v28, 3, s27
  s_add_u32 s26, s3, 1
  s_and_b32 s26, s26, 3
  s_lshl_b32 s29, s26, 10
  s_lshl_b32 s27, s26, 1
  v_xor_b32 v26, s27, v25
  v_lshl_add_u32 v3, v26, 4, v24
  s_add_u32 s27, s29, 73728
  v_add_u32 v11, s27, v1
  s_lshl_b32 s32, s3, 12
  v_add_u32 v7, s32, v11
  s_lshl_b32 s27, s26, 7
  s_add_u32 s27, s27, 147456
  v_lshl_add_u32 v16, v28, 3, s27
  s_add_u32 s26, s3, 2
  s_and_b32 s26, s26, 3
  s_lshl_b32 s30, s26, 10
  s_lshl_b32 s27, s26, 1
  v_xor_b32 v26, s27, v25
  v_lshl_add_u32 v4, v26, 4, v24
  s_add_u32 s27, s30, 73728
  v_add_u32 v12, s27, v1
  s_lshl_b32 s32, s3, 12
  v_add_u32 v8, s32, v12
  s_lshl_b32 s27, s26, 7
  s_add_u32 s27, s27, 147456
  v_lshl_add_u32 v17, v28, 3, s27
  s_add_u32 s26, s3, 3
  s_and_b32 s26, s26, 3
  s_lshl_b32 s31, s26, 10
  s_lshl_b32 s27, s26, 1
  v_xor_b32 v26, s27, v25
  v_lshl_add_u32 v5, v26, 4, v24
  s_add_u32 s27, s31, 73728
  v_add_u32 v13, s27, v1
  s_lshl_b32 s32, s3, 12
  v_add_u32 v9, s32, v13
  s_lshl_b32 s27, s26, 7
  s_add_u32 s27, s27, 147456
  v_lshl_add_u32 v18, v28, 3, s27
  s_add_u32 s27, s20, 147968
  v_lshl_add_u32 v14, v29, 4, s27
  s_add_u32 s40, s4, 18874368
  s_addc_u32 s41, s5, 0
  s_mov_b32 s42, 18874368
  s_mov_b32 s43, 0x20000
  s_mul_i32 s44, s66, 2359296
  s_mul_i32 s45, s67, 73728
  s_add_u32 s44, s44, s45
  s_lshl_b32 s45, s3, 11
  s_add_u32 s45, s45, s44
  s_add_u32 s45, s45, 65536
  s_lshl_b32 s46, s3, 14
  s_add_u32 s44, s44, s46
  s_mov_b32 s47, 0x3f803f80
  s_mov_b32 s48, 0xffff0000
  s_mov_b32 s49, 0x3fb8aa3b
  s_lshr_b32 s50, s3, 1
  s_add_u32 s50, s50, 16
  s_sub_u32 s50, s50, s3
  s_lshl_b32 s50, s50, 12
  s_and_b32 s51, s3, 1
  s_lshl_b32 s51, s51, 3
  s_add_u32 s50, s50, s51
  s_lshr_b32 s33, s66, 1
  s_and_b32 s34, s66, 1
  s_lshl_b32 s34, s34, 1
  s_lshr_b32 s35, s3, 1
  s_add_u32 s34, s34, s35
  s_and_b32 s35, s3, 1
  v_lshlrev_b32 v156, 3, v28
  v_lshl_add_u32 v156, v29, 8, v156
  s_mul_i32 s36, s67, 73728
  s_lshl_b32 s37, s33, 14
  s_add_u32 s37, s37, s36
  s_lshl_b32 s38, s34, 10
  s_add_u32 s37, s37, s38
  s_lshl_b32 s38, s35, 7
  s_add_u32 s37, s37, s38
  v_add_u32 v156, s37, v156
  v_lshlrev_b32 v157, 2, v28
  v_lshl_add_u32 v157, v29, 7, v157
  s_lshl_b32 s37, s33, 11
  s_add_u32 s37, s37, s36
  s_lshl_b32 s38, s34, 9
  s_add_u32 s37, s37, s38
  s_lshl_b32 s38, s35, 6
  s_add_u32 s37, s37, s38
  s_add_u32 s37, s37, 65536
  v_add_u32 v157, s37, v157
  s_lshl_b32 s36, s67, 6
  s_lshl_b32 s37, s34, 4
  s_add_u32 s36, s36, s37
  s_lshl_b32 s37, s35, 3
  s_add_u32 s36, s36, s37
  v_lshrrev_b32 v24, 1, v28
  v_add_u32 v25, s36, v24
  s_movk_i32 s37, 1152
  v_mul_lo_u32 v25, v25, s37
  s_mul_i32 s37, s33, 288
  v_add_u32 v25, s37, v25
  v_and_b32 v26, 1, v28
  v_lshl_add_u32 v27, v29, 1, v26
  v_lshl_add_u32 v158, v27, 3, v25
  v_lshl_add_u32 v159, v27, 2, v25
  v_add_u32 v159, 256, v159
  s_lshl_b32 s36, s34, 1
  s_add_u32 s36, s36, s35
  s_mul_i32 s37, s33, 18432
  v_and_b32 v30, 1, v29
  v_lshlrev_b32 v30, 2, v30
  v_xor_b32 v30, s36, v30
  v_lshlrev_b32 v31, 9, v27
  v_lshl_add_u32 v31, v24, 1, v31
  v_add_u32 v31, s37, v31
  v_lshl_add_u32 v164, v30, 4, v31
  v_xor_b32 v30, 2, v30
  v_lshl_add_u32 v165, v30, 4, v31
  v_lshrrev_b32 v30, 1, v29
  v_lshlrev_b32 v30, 2, v30
  v_lshl_add_u32 v30, v26, 1, v30
  v_xor_b32 v30, s36, v30
  v_lshlrev_b32 v31, 8, v27
  v_lshl_add_u32 v31, v24, 1, v31
  v_add_u32 v31, s37, v31
  v_lshl_add_u32 v23, v30, 4, v31
  v_add_u32 v23, 16384, v23
  v_and_b32 v166, 7, v0
  v_lshlrev_b32 v166, 9, v166
  s_lshl_b32 s36, s67, 14
  s_add_u32 s36, s36, 131072
  s_lshl_b32 s37, s33, 7
  s_add_u32 s37, s37, s36
  s_lshl_b32 s38, s66, 9
  s_add_u32 s36, s36, s38
  s_lshl_b32 s38, s3, 7
  s_add_u32 s36, s36, s38
  s_and_b32 s34, s66, 1
  s_lshl_b32 s34, s34, 1
  s_and_b32 s35, s3, 1
  s_add_u32 s34, s34, s35
  s_lshr_b32 s35, s3, 1
  s_mul_i32 s26, s67, 73728
  s_lshl_b32 s27, s33, 14
  s_add_u32 s26, s26, s27
  s_lshl_b32 s27, s34, 10
  s_add_u32 s26, s26, s27
  s_lshl_b32 s27, s35, 12
  s_add_u32 s26, s26, s27
  v_add_u32 v156, s26, v1
  s_lshl_b32 s26, s67, 6
  s_lshl_b32 s27, s34, 4
  s_add_u32 s26, s26, s27
  v_add_u32 v25, s26, v28
  s_movk_i32 s27, 1152
  v_mul_lo_u32 v25, v25, s27
  s_mul_i32 s26, s33, 288
  s_lshl_b32 s27, s35, 6
  s_add_u32 s26, s26, s27
  v_add_u32 v25, s26, v25
  v_lshl_add_u32 v158, v29, 4, v25
  v_lshrrev_b32 v24, 2, v28
  v_lshl_add_u32 v24, v29, 3, v24
  v_lshlrev_b32 v24, 7, v24
  v_and_b32 v25, 1, v28
  v_lshl_add_u32 v24, v25, 3, v24
  v_lshrrev_b32 v25, 3, v28
  v_lshlrev_b32 v25, 1, v25
  v_and_b32 v26, 1, v29
  v_lshl_add_u32 v25, v26, 2, v25
  v_lshrrev_b32 v26, 1, v28
  v_and_b32 v26, 1, v26
  v_xor_b32 v25, v25, v26
  s_lshl_b32 s27, s34, 1
  v_xor_b32 v26, s27, v25
  v_lshl_add_u32 v24, v26, 4, v24
  s_mul_i32 s26, s33, 18432
  s_lshl_b32 s27, s35, 12
  s_add_u32 s26, s26, s27
  v_add_u32 v164, s26, v24
  s_mov_b32 s56, s62
  s_mov_b32 s57, s63
  s_mov_b32 s58, 2359296
  s_mov_b32 s59, 0x20000
  s_mov_b32 s60, 0x3f317218
  v_mov_b32 v180, 0
  v_mov_b32 v181, 0
  v_mov_b32 v182, 0
  v_mov_b32 v183, 0
  s_lshl_b32 s26, s66, 7
  s_add_u32 s26, s26, 55296
  s_cmp_eq_u32 s3, 0
  s_cselect_b32 s21, s21, 0x40000000
  s_waitcnt vmcnt(0) lgkmcnt(0)
  s_barrier
  s_mov_b64 exec, 1
  v_mov_b32 v24, s6
  buffer_store_dword v24, off, s[52:55], s21 sc1
  s_mov_b64 exec, -1
  v_cmp_ne_u32 vcc, s6, v21
  s_nop 3
  s_cbranch_vccz L22_ok
  s_mov_b32 s7, 262144
L23_poll:
  buffer_load_dword v21, v22, s[52:55], s26 offen sc1
  s_waitcnt vmcnt(0)
  v_cmp_ne_u32 vcc, s6, v21
  s_sub_u32 s7, s7, 1
  s_cmp_eq_u32 s7, 0
  s_cbranch_scc1 L24_pollx
  s_nop 0
  s_cbranch_vccnz L23_poll
L24_pollx:
L22_ok:
  v_min_u32 v22, 35, v0
  v_lshlrev_b32 v22, 7, v22
  s_mul_i32 s26, s3, 4608
  s_add_u32 s26, s26, 36864
  global_load_dwordx4 a[216:219], v1, s[22:23] offset:-4096 sc1
  global_load_dwordx4 a[220:223], v1, s[22:23] offset:-3072 sc1
  global_load_dwordx4 a[224:227], v1, s[22:23] offset:-2048 sc1
  global_load_dwordx4 a[228:231], v1, s[22:23] offset:-1024 sc1
  global_load_dwordx4 a[232:235], v1, s[22:23] offset:0 sc1
  global_load_dwordx4 a[236:239], v1, s[22:23] offset:1024 sc1
  global_load_dwordx4 a[240:243], v1, s[22:23] offset:2048 sc1
  global_load_dwordx4 a[244:247], v1, s[22:23] offset:3072 sc1
  s_add_u32 s22, s22, 8192
  s_addc_u32 s23, s23, 0
  global_load_dwordx4 a[248:251], v1, s[22:23] offset:-4096 sc1
  global_load_dwordx4 a[252:255], v1, s[22:23] offset:-3072 sc1
  global_load_dwordx4 v[108:111], v1, s[22:23] offset:-2048 sc1
  global_load_dwordx4 v[112:115], v1, s[22:23] offset:-1024 sc1
  global_load_dwordx4 v[116:119], v1, s[22:23] offset:0 sc1
  global_load_dwordx4 v[120:123], v1, s[22:23] offset:1024 sc1
  global_load_dwordx4 v[124:127], v1, s[22:23] offset:2048 sc1
  global_load_dwordx4 v[128:131], v1, s[22:23] offset:3072 sc1
  s_add_u32 s22, s22, 8192
  s_addc_u32 s23, s23, 0
  s_cmp_lt_u32 s2, 144
  s_cbranch_scc1 L25_nh
  s_mov_b32 s27, 71680
  v_mov_b32 v25, 0
  s_mov_b32 s7, 262144
L26_poll:
  buffer_load_dword v26, v25, s[52:55], s27 offen sc1
  s_waitcnt vmcnt(0)
  v_cmp_ne_u32 vcc, s6, v26
  s_sub_u32 s7, s7, 1
  s_cmp_eq_u32 s7, 0
  s_cbranch_scc1 L27_pollx
  s_nop 0
  s_cbranch_vccnz L26_poll
L27_pollx:
L25_nh:
  s_mov_b32 s7, 262144
L28_poll:
  buffer_load_dword v21, v22, s[52:55], s26 offen sc1
  s_waitcnt vmcnt(0)
  v_cmp_ne_u32 vcc, s6, v21
  s_sub_u32 s7, s7, 1
  s_cmp_eq_u32 s7, 0
  s_cbranch_scc1 L29_pollx
  s_nop 0
  s_cbranch_vccnz L28_poll
L29_pollx:
  s_barrier
  s_add_u32 m0, s9, 0
  s_nop 0
  buffer_load_dwordx4 v171, s[12:15], s8 offen sc1 lds
  s_add_u32 s8, s8, 4096
  s_add_u32 m0, s9, 4096
  s_nop 0
  buffer_load_dwordx4 v171, s[12:15], s8 offen sc1 lds
  s_add_u32 s8, s8, 4096
  s_add_u32 m0, s9, 8192
  s_nop 0
  buffer_load_dwordx4 v171, s[12:15], s8 offen sc1 lds
  s_add_u32 s8, s8, 4096
  s_add_u32 m0, s9, 12288
  s_nop 0
  buffer_load_dwordx4 v171, s[12:15], s8 offen sc1 lds
  s_add_u32 s8, s8, 4096
  s_add_u32 m0, s9, 16384
  s_nop 0
  buffer_load_dwordx4 v171, s[12:15], s8 offen sc1 lds
  s_add_u32 s8, s8, 4096
  s_add_u32 m0, s9, 20480
  s_nop 0
  buffer_load_dwordx4 v171, s[12:15], s8 offen sc1 lds
  s_add_u32 s8, s8, 4096
  s_add_u32 m0, s9, 24576
  s_nop 0
  buffer_load_dwordx4 v171, s[12:15], s8 offen sc1 lds
  s_add_u32 s8, s8, 4096
  s_add_u32 m0, s9, 28672
  s_nop 0
  buffer_load_dwordx4 v171, s[12:15], s8 offen sc1 lds
  s_add_u32 s8, s8, 4096
  s_add_u32 m0, s9, 32768
  s_nop 0
  buffer_load_dwordx4 v171, s[12:15], s8 offen sc1 lds
  s_add_u32 s8, s8, 4096
  s_or_b32 s26, s2, s3
  s_cmp_lg_u32 s26, 0
  s_cbranch_scc1 L30_ep
  s_mov_b64 exec, 1
  v_mov_b32 v21, s6
  buffer_store_dword v21, off, s[52:55], s26 sc1
  s_mov_b64 exec, -1
L30_ep:
  v_mov_b32 v19, v164
  v_mov_b32 v20, v165
  v_mov_b32 v22, v166
  s_waitcnt vmcnt(6)
  s_barrier
  v_mov_b32 v92, 0x3f803f80
  v_mov_b32 v93, 0x3f803f80
  v_mov_b32 v94, 0x3f803f80
  v_mov_b32 v95, 0x3f803f80
  ds_read_b64_tr_b16 v[184:185], v2 offset:0
  ds_read_b64_tr_b16 v[186:187], v2 offset:512
  ds_read_b64_tr_b16 a[0:1], v3 offset:0
  ds_read_b64_tr_b16 a[2:3], v3 offset:512
  ds_read_b64_tr_b16 a[4:5], v4 offset:0
  ds_read_b64_tr_b16 a[6:7], v4 offset:512
  ds_read_b64_tr_b16 a[8:9], v5 offset:0
  ds_read_b64_tr_b16 a[10:11], v5 offset:512
  ds_read_b64_tr_b16 v[188:189], v2 offset:4096
  ds_read_b64_tr_b16 v[190:191], v2 offset:4608
  ds_read_b64_tr_b16 a[12:13], v3 offset:4096
  ds_read_b64_tr_b16 a[14:15], v3 offset:4608
  ds_read_b64_tr_b16 a[16:17], v4 offset:4096
  ds_read_b64_tr_b16 a[18:19], v4 offset:4608
  ds_read_b64_tr_b16 a[20:21], v5 offset:4096
  ds_read_b64_tr_b16 a[22:23], v5 offset:4608
  s_waitcnt lgkmcnt(14)
  v_mfma_f32_16x16x32_bf16 v[24:27], a[216:219], v[184:187], 0
  s_add_u32 m0, s9, 36864
  s_nop 0
  buffer_load_dwordx4 v171, s[12:15], s8 offen sc1 lds
  s_add_u32 s8, s8, 4096
  ds_read_b64_tr_b16 v[192:193], v2 offset:8192
  ds_read_b64_tr_b16 v[194:195], v2 offset:8704
  s_waitcnt lgkmcnt(14)
  v_mfma_f32_16x16x32_bf16 v[28:31], a[216:219], a[0:3], 0
  ds_read_b64_tr_b16 a[24:25], v3 offset:8192
  ds_read_b64_tr_b16 a[26:27], v3 offset:8704
  v_mfma_f32_16x16x32_bf16 v[84:87], v[92:95], v[184:187], 0
  s_waitcnt lgkmcnt(14)
  v_mfma_f32_16x16x32_bf16 v[32:35], a[216:219], a[4:7], 0
  ds_read_b64_tr_b16 a[28:29], v4 offset:8192
  ds_read_b64_tr_b16 a[30:31], v4 offset:8704
  s_waitcnt lgkmcnt(14)
  v_mfma_f32_16x16x32_bf16 v[36:39], a[216:219], a[8:11], 0
  global_load_dwordx4 v[132:135], v1, s[22:23] offset:-4096 sc1
  ds_read_b64_tr_b16 a[32:33], v5 offset:8192
  ds_read_b64_tr_b16 a[34:35], v5 offset:8704
  v_mfma_f32_16x16x32_bf16 v[88:91], v[184:187], v[184:187], 0
  s_waitcnt lgkmcnt(14)
  v_mfma_f32_16x16x32_bf16 v[24:27], a[220:223], v[188:191], v[24:27]
  s_add_u32 m0, s9, 40960
  s_nop 0
  buffer_load_dwordx4 v171, s[12:15], s8 offen sc1 lds
  s_add_u32 s8, s8, 4096
  s_waitcnt vmcnt(6)
  s_barrier
  ds_read_b64_tr_b16 v[196:197], v2 offset:12288
  ds_read_b64_tr_b16 v[198:199], v2 offset:12800
  s_waitcnt lgkmcnt(14)
  v_mfma_f32_16x16x32_bf16 v[28:31], a[220:223], a[12:15], v[28:31]
  ds_read_b64_tr_b16 a[36:37], v3 offset:12288
  ds_read_b64_tr_b16 a[38:39], v3 offset:12800
  v_mfma_f32_16x16x32_bf16 v[84:87], v[92:95], v[188:191], v[84:87]
  s_waitcnt lgkmcnt(14)
  v_mfma_f32_16x16x32_bf16 v[32:35], a[220:223], a[16:19], v[32:35]
  ds_read_b64_tr_b16 a[40:41], v4 offset:12288
  ds_read_b64_tr_b16 a[42:43], v4 offset:12800
  s_waitcnt lgkmcnt(14)
  v_mfma_f32_16x16x32_bf16 v[36:39], a[220:223], a[20:23], v[36:39]
  global_load_dwordx4 v[136:139], v1, s[22:23] offset:-3072 sc1
  ds_read_b64_tr_b16 a[44:45], v5 offset:12288
  ds_read_b64_tr_b16 a[46:47], v5 offset:12800
  v_mfma_f32_16x16x32_bf16 v[88:91], v[188:191], v[188:191], v[88:91]
  s_waitcnt lgkmcnt(14)
  v_mfma_f32_16x16x32_bf16 v[24:27], a[224:227], v[192:195], v[24:27]
  s_add_u32 m0, s9, 45056
  s_nop 0
  buffer_load_dwordx4 v171, s[12:15], s8 offen sc1 lds
  s_add_u32 s8, s8, 4096
  ds_read_b64_tr_b16 v[200:201], v2 offset:16384
  ds_read_b64_tr_b16 v[202:203], v2 offset:16896
  s_waitcnt lgkmcnt(14)
  v_mfma_f32_16x16x32_bf16 v[28:31], a[224:227], a[24:27], v[28:31]
  ds_read_b64_tr_b16 a[48:49], v3 offset:16384
  ds_read_b64_tr_b16 a[50:51], v3 offset:16896
  v_mfma_f32_16x16x32_bf16 v[84:87], v[92:95], v[192:195], v[84:87]
  s_waitcnt lgkmcnt(14)
  v_mfma_f32_16x16x32_bf16 v[32:35], a[224:227], a[28:31], v[32:35]
  ds_read_b64_tr_b16 a[52:53], v4 offset:16384
  ds_read_b64_tr_b16 a[54:55], v4 offset:16896
  s_waitcnt lgkmcnt(14)
  v_mfma_f32_16x16x32_bf16 v[36:39], a[224:227], a[32:35], v[36:39]
  global_load_dwordx4 v[140:143], v1, s[22:23] offset:-2048 sc1
  ds_read_b64_tr_b16 a[56:57], v5 offset:16384
  ds_read_b64_tr_b16 a[58:59], v5 offset:16896
  v_mfma_f32_16x16x32_bf16 v[88:91], v[192:195], v[192:195], v[88:91]
  s_waitcnt lgkmcnt(14)
  v_mfma_f32_16x16x32_bf16 v[24:27], a[228:231], v[196:199], v[24:27]
  s_add_u32 m0, s9, 49152
  s_nop 0
  buffer_load_dwordx4 v171, s[12:15], s8 offen sc1 lds
  s_add_u32 s8, s8, 4096
  ds_read_b64_tr_b16 v[204:205], v2 offset:20480
  ds_read_b64_tr_b16 v[206:207], v2 offset:20992
  s_waitcnt lgkmcnt(14)
  v_mfma_f32_16x16x32_bf16 v[28:31], a[228:231], a[36:39], v[28:31]
  ds_read_b64_tr_b16 a[60:61], v3 offset:20480
  ds_read_b64_tr_b16 a[62:63], v3 offset:20992
  v_mfma_f32_16x16x32_bf16 v[84:87], v[92:95], v[196:199], v[84:87]
  s_waitcnt lgkmcnt(14)
  v_mfma_f32_16x16x32_bf16 v[32:35], a[228:231], a[40:43], v[32:35]
  ds_read_b64_tr_b16 a[64:65], v4 offset:20480
  ds_read_b64_tr_b16 a[66:67], v4 offset:20992
  s_waitcnt lgkmcnt(14)
  v_mfma_f32_16x16x32_bf16 v[36:39], a[228:231], a[44:47], v[36:39]
  global_load_dwordx4 v[144:147], v1, s[22:23] offset:-1024 sc1
  ds_read_b64_tr_b16 a[68:69], v5 offset:20480
  ds_read_b64_tr_b16 a[70:71], v5 offset:20992
  v_mfma_f32_16x16x32_bf16 v[88:91], v[196:199], v[196:199], v[88:91]
  s_waitcnt lgkmcnt(14)
  v_mfma_f32_16x16x32_bf16 v[24:27], a[232:235], v[200:203], v[24:27]
  s_add_u32 m0, s9, 53248
  s_nop 0
  buffer_load_dwordx4 v171, s[12:15], s8 offen sc1 lds
  s_add_u32 s8, s8, 4096
  s_waitcnt vmcnt(9)
  s_barrier
  ds_read_b64_tr_b16 v[208:209], v2 offset:24576
  ds_read_b64_tr_b16 v[210:211], v2 offset:25088
  s_waitcnt lgkmcnt(14)
  v_mfma_f32_16x16x32_bf16 v[28:31], a[232:235], a[48:51], v[28:31]
  ds_read_b64_tr_b16 a[72:73], v3 offset:24576
  ds_read_b64_tr_b16 a[74:75], v3 offset:25088
  v_mfma_f32_16x16x32_bf16 v[84:87], v[92:95], v[200:203], v[84:87]
  s_waitcnt lgkmcnt(14)
  v_mfma_f32_16x16x32_bf16 v[32:35], a[232:235], a[52:55], v[32:35]
  ds_read_b64_tr_b16 a[76:77], v4 offset:24576
  ds_read_b64_tr_b16 a[78:79], v4 offset:25088
  s_waitcnt lgkmcnt(14)
  v_mfma_f32_16x16x32_bf16 v[36:39], a[232:235], a[56:59], v[36:39]
  global_load_dwordx4 v[148:151], v1, s[22:23] offset:0 sc1
  ds_read_b64_tr_b16 a[80:81], v5 offset:24576
  ds_read_b64_tr_b16 a[82:83], v5 offset:25088
  v_mfma_f32_16x16x32_bf16 v[88:91], v[200:203], v[200:203], v[88:91]
  s_waitcnt lgkmcnt(14)
  v_mfma_f32_16x16x32_bf16 v[24:27], a[236:239], v[204:207], v[24:27]
  s_add_u32 m0, s9, 57344
  s_nop 0
  buffer_load_dwordx4 v171, s[12:15], s8 offen sc1 lds
  s_add_u32 s8, s8, 4096
  ds_read_b64_tr_b16 v[212:213], v2 offset:28672
  ds_read_b64_tr_b16 v[214:215], v2 offset:29184
  s_waitcnt lgkmcnt(14)
  v_mfma_f32_16x16x32_bf16 v[28:31], a[236:239], a[60:63], v[28:31]
  ds_read_b64_tr_b16 a[84:85], v3 offset:28672
  ds_read_b64_tr_b16 a[86:87], v3 offset:29184
  v_mfma_f32_16x16x32_bf16 v[84:87], v[92:95], v[204:207], v[84:87]
  s_waitcnt lgkmcnt(14)
  v_mfma_f32_16x16x32_bf16 v[32:35], a[236:239], a[64:67], v[32:35]
  ds_read_b64_tr_b16 a[88:89], v4 offset:28672
  ds_read_b64_tr_b16 a[90:91], v4 offset:29184
  s_waitcnt lgkmcnt(14)
  v_mfma_f32_16x16x32_bf16 v[36:39], a[236:239], a[68:71], v[36:39]
  global_load_dwordx4 v[152:155], v1, s[22:23] offset:1024 sc1
  ds_read_b64_tr_b16 a[92:93], v5 offset:28672
  ds_read_b64_tr_b16 a[94:95], v5 offset:29184
  v_mfma_f32_16x16x32_bf16 v[88:91], v[204:207], v[204:207], v[88:91]
  s_waitcnt lgkmcnt(14)
  v_mfma_f32_16x16x32_bf16 v[24:27], a[240:243], v[208:211], v[24:27]
  s_add_u32 m0, s9, 61440
  s_nop 0
  buffer_load_dwordx4 v171, s[12:15], s8 offen sc1 lds
  s_add_u32 s8, s8, 4096
  ds_read_b64_tr_b16 v[216:217], v2 offset:32768
  ds_read_b64_tr_b16 v[218:219], v2 offset:33280
  s_waitcnt lgkmcnt(14)
  v_mfma_f32_16x16x32_bf16 v[28:31], a[240:243], a[72:75], v[28:31]
  ds_read_b64_tr_b16 a[96:97], v3 offset:32768
  ds_read_b64_tr_b16 a[98:99], v3 offset:33280
  v_mfma_f32_16x16x32_bf16 v[84:87], v[92:95], v[208:211], v[84:87]
  s_waitcnt lgkmcnt(14)
  v_mfma_f32_16x16x32_bf16 v[32:35], a[240:243], a[76:79], v[32:35]
  ds_read_b64_tr_b16 a[100:101], v4 offset:32768
  ds_read_b64_tr_b16 a[102:103], v4 offset:33280
  s_waitcnt lgkmcnt(14)
  v_mfma_f32_16x16x32_bf16 v[36:39], a[240:243], a[80:83], v[36:39]
  global_load_dwordx4 a[216:219], v1, s[22:23] offset:2048 sc1
  ds_read_b64_tr_b16 a[104:105], v5 offset:32768
  ds_read_b64_tr_b16 a[106:107], v5 offset:33280
  v_mfma_f32_16x16x32_bf16 v[88:91], v[208:211], v[208:211], v[88:91]
  s_waitcnt lgkmcnt(14)
  v_mfma_f32_16x16x32_bf16 v[24:27], a[244:247], v[212:215], v[24:27]
  s_add_u32 m0, s9, 65536
  s_nop 0
  buffer_load_dwordx4 v171, s[12:15], s8 offen sc1 lds
  s_add_u32 s8, s8, 4096
  s_waitcnt vmcnt(10)
  s_barrier
  ds_read_b64_tr_b16 v[220:221], v2 offset:36864
  ds_read_b64_tr_b16 v[222:223], v2 offset:37376
  s_waitcnt lgkmcnt(14)
  v_mfma_f32_16x16x32_bf16 v[28:31], a[244:247], a[84:87], v[28:31]
  ds_read_b64_tr_b16 a[108:109], v3 offset:36864
  ds_read_b64_tr_b16 a[110:111], v3 offset:37376
  v_mfma_f32_16x16x32_bf16 v[84:87], v[92:95], v[212:215], v[84:87]
  s_waitcnt lgkmcnt(14)
  v_mfma_f32_16x16x32_bf16 v[32:35], a[244:247], a[88:91], v[32:35]
  ds_read_b64_tr_b16 a[112:113], v4 offset:36864
  ds_read_b64_tr_b16 a[114:115], v4 offset:37376
  buffer_load_dwordx4 v[40:43], v167, s[16:19], s11 offen sc1
  s_add_u32 s11, s11, 2304
  s_waitcnt lgkmcnt(14)
  v_mfma_f32_16x16x32_bf16 v[36:39], a[244:247], a[92:95], v[36:39]
  global_load_dwordx4 a[220:223], v1, s[22:23] offset:3072 sc1
  s_add_u32 s22, s22, 8192
  s_addc_u32 s23, s23, 0
  ds_read_b64_tr_b16 a[116:117], v5 offset:36864
  ds_read_b64_tr_b16 a[118:119], v5 offset:37376
  v_mfma_f32_16x16x32_bf16 v[88:91], v[212:215], v[212:215], v[88:91]
  buffer_load_dwordx4 v[44:47], v167, s[16:19], s11 offen sc1
  s_add_u32 s11, s11, 2304
  s_waitcnt lgkmcnt(14)
  v_mfma_f32_16x16x32_bf16 v[24:27], a[248:251], v[216:219], v[24:27]
  s_add_u32 m0, s9, 69632
  s_nop 0
  buffer_load_dwordx4 v171, s[12:15], s8 offen sc1 lds
  ds_read_b64_tr_b16 v[224:225], v2 offset:40960
  ds_read_b64_tr_b16 v[226:227], v2 offset:41472
  buffer_load_dwordx4 v[48:51], v167, s[16:19], s11 offen sc1
  s_add_u32 s11, s11, 2304
  s_waitcnt lgkmcnt(14)
  v_mfma_f32_16x16x32_bf16 v[28:31], a[248:251], a[96:99], v[28:31]
  ds_read_b64_tr_b16 a[120:121], v3 offset:40960
  ds_read_b64_tr_b16 a[122:123], v3 offset:41472
  v_mfma_f32_16x16x32_bf16 v[84:87], v[92:95], v[216:219], v[84:87]
  buffer_load_dwordx4 v[52:55], v167, s[16:19], s11 offen sc1
  s_add_u32 s11, s11, 2304
  s_waitcnt lgkmcnt(14)
  v_mfma_f32_16x16x32_bf16 v[32:35], a[248:251], a[100:103], v[32:35]
  ds_read_b64_tr_b16 a[124:125], v4 offset:40960
  ds_read_b64_tr_b16 a[126:127], v4 offset:41472
  buffer_load_dwordx4 v[56:59], v167, s[16:19], s11 offen sc1
  s_add_u32 s11, s11, 2304
  s_waitcnt lgkmcnt(14)
  v_mfma_f32_16x16x32_bf16 v[36:39], a[248:251], a[104:107], v[36:39]
  global_load_dwordx4 a[224:227], v1, s[22:23] offset:-4096 sc1
  ds_read_b64_tr_b16 a[128:129], v5 offset:40960
  ds_read_b64_tr_b16 a[130:131], v5 offset:41472
  v_mfma_f32_16x16x32_bf16 v[88:91], v[216:219], v[216:219], v[88:91]
  buffer_load_dwordx4 v[60:63], v167, s[16:19], s11 offen sc1
  s_waitcnt lgkmcnt(14)
  v_mfma_f32_16x16x32_bf16 v[24:27], a[252:255], v[220:223], v[24:27]
  ds_read_b64_tr_b16 v[228:229], v2 offset:45056
  ds_read_b64_tr_b16 v[230:231], v2 offset:45568
  s_waitcnt lgkmcnt(14)
  v_mfma_f32_16x16x32_bf16 v[28:31], a[252:255], a[108:111], v[28:31]
  ds_read_b64_tr_b16 a[132:133], v3 offset:45056
  ds_read_b64_tr_b16 a[134:135], v3 offset:45568
  v_mfma_f32_16x16x32_bf16 v[84:87], v[92:95], v[220:223], v[84:87]
  s_waitcnt lgkmcnt(14)
  v_mfma_f32_16x16x32_bf16 v[32:35], a[252:255], a[112:115], v[32:35]
  ds_read_b64_tr_b16 a[136:137], v4 offset:45056
  ds_read_b64_tr_b16 a[138:139], v4 offset:45568
  s_waitcnt lgkmcnt(14)
  v_mfma_f32_16x16x32_bf16 v[36:39], a[252:255], a[116:119], v[36:39]
  global_load_dwordx4 a[228:231], v1, s[22:23] offset:-3072 sc1
  global_load_dwordx4 a[232:235], v1, s[22:23] offset:-2048 sc1
  ds_read_b64_tr_b16 a[140:141], v5 offset:45056
  ds_read_b64_tr_b16 a[142:143], v5 offset:45568
  v_mfma_f32_16x16x32_bf16 v[88:91], v[220:223], v[220:223], v[88:91]
  s_waitcnt lgkmcnt(14)
  v_mfma_f32_16x16x32_bf16 v[24:27], v[108:111], v[224:227], v[24:27]
  s_waitcnt vmcnt(15)
  s_barrier
  ds_read_b64_tr_b16 v[232:233], v2 offset:49152
  ds_read_b64_tr_b16 v[234:235], v2 offset:49664
  s_waitcnt lgkmcnt(14)
  v_mfma_f32_16x16x32_bf16 v[28:31], v[108:111], a[120:123], v[28:31]
  ds_read_b64_tr_b16 a[144:145], v3 offset:49152
  ds_read_b64_tr_b16 a[146:147], v3 offset:49664
  v_mfma_f32_16x16x32_bf16 v[84:87], v[92:95], v[224:227], v[84:87]
  s_waitcnt lgkmcnt(14)
  v_mfma_f32_16x16x32_bf16 v[32:35], v[108:111], a[124:127], v[32:35]
  ds_read_b64_tr_b16 a[148:149], v4 offset:49152
  ds_read_b64_tr_b16 a[150:151], v4 offset:49664
  s_waitcnt lgkmcnt(14)
  v_mfma_f32_16x16x32_bf16 v[36:39], v[108:111], a[128:131], v[36:39]
  global_load_dwordx4 a[236:239], v1, s[22:23] offset:-1024 sc1
  global_load_dwordx4 a[240:243], v1, s[22:23] offset:0 sc1
  ds_read_b64_tr_b16 a[152:153], v5 offset:49152
  ds_read_b64_tr_b16 a[154:155], v5 offset:49664
  v_mfma_f32_16x16x32_bf16 v[88:91], v[224:227], v[224:227], v[88:91]
  s_waitcnt lgkmcnt(14)
  v_mfma_f32_16x16x32_bf16 v[24:27], v[112:115], v[228:231], v[24:27]
  ds_read_b64_tr_b16 v[236:237], v2 offset:53248
  ds_read_b64_tr_b16 v[238:239], v2 offset:53760
  s_waitcnt lgkmcnt(14)
  v_mfma_f32_16x16x32_bf16 v[28:31], v[112:115], a[132:135], v[28:31]
  ds_read_b64_tr_b16 a[156:157], v3 offset:53248
  ds_read_b64_tr_b16 a[158:159], v3 offset:53760
  v_mfma_f32_16x16x32_bf16 v[84:87], v[92:95], v[228:231], v[84:87]
  s_waitcnt lgkmcnt(14)
  v_mfma_f32_16x16x32_bf16 v[32:35], v[112:115], a[136:139], v[32:35]
  ds_read_b64_tr_b16 a[160:161], v4 offset:53248
  ds_read_b64_tr_b16 a[162:163], v4 offset:53760
  s_waitcnt lgkmcnt(14)
  v_mfma_f32_16x16x32_bf16 v[36:39], v[112:115], a[140:143], v[36:39]
  global_load_dwordx4 a[244:247], v1, s[22:23] offset:1024 sc1
  global_load_dwordx4 a[248:251], v1, s[22:23] offset:2048 sc1
  ds_read_b64_tr_b16 a[164:165], v5 offset:53248
  ds_read_b64_tr_b16 a[166:167], v5 offset:53760
  v_mfma_f32_16x16x32_bf16 v[88:91], v[228:231], v[228:231], v[88:91]
  s_waitcnt lgkmcnt(14)
  v_mfma_f32_16x16x32_bf16 v[24:27], v[116:119], v[232:235], v[24:27]
  ds_read_b64_tr_b16 v[240:241], v2 offset:57344
  ds_read_b64_tr_b16 v[242:243], v2 offset:57856
  s_waitcnt lgkmcnt(14)
  v_mfma_f32_16x16x32_bf16 v[28:31], v[116:119], a[144:147], v[28:31]
  ds_read_b64_tr_b16 a[168:169], v3 offset:57344
  ds_read_b64_tr_b16 a[170:171], v3 offset:57856
  v_mfma_f32_16x16x32_bf16 v[84:87], v[92:95], v[232:235], v[84:87]
  s_waitcnt lgkmcnt(14)
  v_mfma_f32_16x16x32_bf16 v[32:35], v[116:119], a[148:151], v[32:35]
  ds_read_b64_tr_b16 a[172:173], v4 offset:57344
  ds_read_b64_tr_b16 a[174:175], v4 offset:57856
  s_waitcnt lgkmcnt(14)
  v_mfma_f32_16x16x32_bf16 v[36:39], v[116:119], a[152:155], v[36:39]
  global_load_dwordx4 a[252:255], v1, s[22:23] offset:3072 sc1
  s_add_u32 s22, s22, 8192
  s_addc_u32 s23, s23, 0
  global_load_dwordx4 v[108:111], v1, s[22:23] offset:-4096 sc1
  ds_read_b64_tr_b16 a[176:177], v5 offset:57344
  ds_read_b64_tr_b16 a[178:179], v5 offset:57856
  v_mfma_f32_16x16x32_bf16 v[88:91], v[232:235], v[232:235], v[88:91]
  s_waitcnt lgkmcnt(14)
  v_mfma_f32_16x16x32_bf16 v[24:27], v[120:123], v[236:239], v[24:27]
  s_waitcnt vmcnt(13)
  s_barrier
  ds_read_b64_tr_b16 v[244:245], v2 offset:61440
  ds_read_b64_tr_b16 v[246:247], v2 offset:61952
  v_add_f32 v40, v40, v44
  s_waitcnt vmcnt(11)
  v_add_f32 v48, v48, v52
  s_waitcnt lgkmcnt(14)
  v_mfma_f32_16x16x32_bf16 v[28:31], v[120:123], a[156:159], v[28:31]
  ds_read_b64_tr_b16 a[180:181], v3 offset:61440
  ds_read_b64_tr_b16 a[182:183], v3 offset:61952
  v_mfma_f32_16x16x32_bf16 v[84:87], v[92:95], v[236:239], v[84:87]
  s_waitcnt vmcnt(8)
  v_add_f32 v56, v56, v60
  v_add_f32 v41, v41, v45
  s_waitcnt lgkmcnt(14)
  v_mfma_f32_16x16x32_bf16 v[32:35], v[120:123], a[160:163], v[32:35]
  ds_read_b64_tr_b16 a[184:185], v4 offset:61440
  ds_read_b64_tr_b16 a[186:187], v4 offset:61952
  v_add_f32 v49, v49, v53
  v_add_f32 v57, v57, v61
  s_waitcnt lgkmcnt(14)
  v_mfma_f32_16x16x32_bf16 v[36:39], v[120:123], a[164:167], v[36:39]
  global_load_dwordx4 v[112:115], v1, s[22:23] offset:-3072 sc1
  ds_read_b64_tr_b16 a[188:189], v5 offset:61440
  ds_read_b64_tr_b16 a[190:191], v5 offset:61952
  v_mfma_f32_16x16x32_bf16 v[88:91], v[236:239], v[236:239], v[88:91]
  v_add_f32 v42, v42, v46
  v_add_f32 v50, v50, v54
  s_waitcnt lgkmcnt(14)
  v_mfma_f32_16x16x32_bf16 v[24:27], v[124:127], v[240:243], v[24:27]
  v_add_u32 v2, 65536, v2
  v_add_u32 v3, 65536, v3
  v_add_u32 v4, 65536, v4
  v_add_u32 v5, 65536, v5
  ds_read_b64_tr_b16 v[248:249], v2 offset:0
  ds_read_b64_tr_b16 v[250:251], v2 offset:512
  v_add_f32 v58, v58, v62
  v_add_f32 v43, v43, v47
  s_waitcnt lgkmcnt(14)
  v_mfma_f32_16x16x32_bf16 v[28:31], v[124:127], a[168:171], v[28:31]
  ds_read_b64_tr_b16 a[192:193], v3 offset:0
  ds_read_b64_tr_b16 a[194:195], v3 offset:512
  v_mfma_f32_16x16x32_bf16 v[84:87], v[92:95], v[240:243], v[84:87]
  v_add_f32 v51, v51, v55
  v_add_f32 v59, v59, v63
  s_waitcnt lgkmcnt(14)
  v_mfma_f32_16x16x32_bf16 v[32:35], v[124:127], a[172:175], v[32:35]
  ds_read_b64_tr_b16 a[196:197], v4 offset:0
  ds_read_b64_tr_b16 a[198:199], v4 offset:512
  v_add_f32 v40, v40, v48
  v_add_f32 v41, v41, v49
  s_waitcnt lgkmcnt(14)
  v_mfma_f32_16x16x32_bf16 v[36:39], v[124:127], a[176:179], v[36:39]
  global_load_dwordx4 v[116:119], v1, s[22:23] offset:-2048 sc1
  ds_read_b64_tr_b16 a[200:201], v5 offset:0
  ds_read_b64_tr_b16 a[202:203], v5 offset:512
  v_mfma_f32_16x16x32_bf16 v[88:91], v[240:243], v[240:243], v[88:91]
  v_add_f32 v42, v42, v50
  v_add_f32 v43, v43, v51
  s_waitcnt lgkmcnt(14)
  v_mfma_f32_16x16x32_bf16 v[24:27], v[128:131], v[244:247], v[24:27]
  ds_read_b64_tr_b16 v[252:253], v2 offset:4096
  ds_read_b64_tr_b16 v[254:255], v2 offset:4608
  v_add_f32 v40, v40, v56
  s_waitcnt lgkmcnt(14)
  v_mfma_f32_16x16x32_bf16 v[28:31], v[128:131], a[180:183], v[28:31]
  ds_read_b64_tr_b16 a[204:205], v3 offset:4096
  ds_read_b64_tr_b16 a[206:207], v3 offset:4608
  v_mfma_f32_16x16x32_bf16 v[84:87], v[92:95], v[244:247], v[84:87]
  v_add_f32 v41, v41, v57
  v_add_f32 v42, v42, v58
  s_waitcnt lgkmcnt(14)
  v_mfma_f32_16x16x32_bf16 v[32:35], v[128:131], a[184:187], v[32:35]
  ds_read_b64_tr_b16 a[208:209], v4 offset:4096
  ds_read_b64_tr_b16 a[210:211], v4 offset:4608
  v_add_f32 v43, v43, v59
  v_lshlrev_b32 v44, 16, v168
  s_waitcnt lgkmcnt(14)
  v_mfma_f32_16x16x32_bf16 v[36:39], v[128:131], a[188:191], v[36:39]
  global_load_dwordx4 v[120:123], v1, s[22:23] offset:-1024 sc1
  ds_read_b64_tr_b16 a[212:213], v5 offset:4096
  ds_read_b64_tr_b16 a[214:215], v5 offset:4608
  v_mfma_f32_16x16x32_bf16 v[88:91], v[244:247], v[244:247], v[88:91]
  v_and_b32 v45, s48, v168
  v_lshlrev_b32 v46, 16, v169
  s_waitcnt lgkmcnt(14)
  v_mfma_f32_16x16x32_bf16 v[24:27], v[132:135], v[248:251], v[24:27]
  v_and_b32 v47, s48, v169
  v_mul_f32 v44, s49, v44
  s_waitcnt lgkmcnt(12)
  v_mfma_f32_16x16x32_bf16 v[28:31], v[132:135], a[192:195], v[28:31]
  v_mfma_f32_16x16x32_bf16 v[84:87], v[92:95], v[248:251], v[84:87]
  v_mul_f32 v45, s49, v45
  v_mul_f32 v46, s49, v46
  s_waitcnt lgkmcnt(10)
  v_mfma_f32_16x16x32_bf16 v[32:35], v[132:135], a[196:199], v[32:35]
  v_mul_f32 v47, s49, v47
  v_lshrrev_b32 v48, 2, v0
  s_waitcnt lgkmcnt(8)
  v_mfma_f32_16x16x32_bf16 v[36:39], v[132:135], a[200:203], v[36:39]
  global_load_dwordx4 v[124:127], v1, s[22:23] offset:0 sc1
  v_mfma_f32_16x16x32_bf16 v[88:91], v[248:251], v[248:251], v[88:91]
  v_lshlrev_b32 v48, 7, v48
  v_and_b32 v49, 3, v0
  s_waitcnt lgkmcnt(6)
  v_mfma_f32_16x16x32_bf16 v[24:27], v[136:139], v[252:255], v[24:27]
  v_lshl_add_u32 v48, v49, 4, v48
  s_add_u32 s61, s20, 147968
  v_add_u32 v48, s61, v48
  s_waitcnt lgkmcnt(4)
  v_mfma_f32_16x16x32_bf16 v[28:31], v[136:139], a[204:207], v[28:31]
  v_mfma_f32_16x16x32_bf16 v[84:87], v[92:95], v[252:255], v[84:87]
  s_mov_b32 exec_lo, -1
  s_mov_b32 exec_hi, 15
  ds_write_b128 v48, v[40:43]
  ds_write_b128 v48, v[44:47] offset:64
  s_mov_b64 exec, -1
  s_waitcnt lgkmcnt(4)
  v_mfma_f32_16x16x32_bf16 v[32:35], v[136:139], a[208:211], v[32:35]
  s_waitcnt lgkmcnt(2)
  v_mfma_f32_16x16x32_bf16 v[36:39], v[136:139], a[212:215], v[36:39]
  global_load_dwordx4 v[128:131], v1, s[22:23] offset:1024 sc1
  v_mfma_f32_16x16x32_bf16 v[88:91], v[252:255], v[252:255], v[88:91]
  ds_read_b128 v[56:59], v14 offset:0
  ds_read_b128 v[60:63], v14 offset:64
  v_mfma_f32_16x16x32_bf16 v[40:43], v[140:143], v[184:187], 0
  v_mfma_f32_16x16x32_bf16 v[40:43], v[144:147], v[188:191], v[40:43]
  v_mfma_f32_16x16x32_bf16 v[40:43], v[148:151], v[192:195], v[40:43]
  v_and_b32 v96, 3, v0
  v_cmp_eq_u32 vcc, 1, v96
  s_nop 1
  v_cndmask_b32 v88, v88, v89, vcc
  v_mfma_f32_16x16x32_bf16 v[40:43], v[152:155], v[196:199], v[40:43]
  global_load_dwordx4 v[132:135], v1, s[22:23] offset:2048 sc1
  v_cmp_eq_u32 vcc, 2, v96
  s_nop 1
  v_cndmask_b32 v88, v88, v90, vcc
  v_mfma_f32_16x16x32_bf16 v[40:43], a[216:219], v[200:203], v[40:43]
  v_cmp_eq_u32 vcc, 3, v96
  s_nop 1
  v_cndmask_b32 v88, v88, v91, vcc
  v_mfma_f32_16x16x32_bf16 v[40:43], a[220:223], v[204:207], v[40:43]
  v_mov_b32 v80, v84
  v_mov_b32 v82, v88
  v_mfma_f32_16x16x32_bf16 v[44:47], v[140:143], a[0:3], 0
  v_lshrrev_b32 v96, 2, v0
  v_and_b32 v96, 3, v96
  v_mfma_f32_16x16x32_bf16 v[44:47], v[144:147], a[12:15], v[44:47]
  global_load_dwordx4 v[136:139], v1, s[22:23] offset:3072 sc1
  s_add_u32 s22, s22, 8192
  s_addc_u32 s23, s23, 0
  v_lshrrev_b32 v97, 4, v0
  s_mov_b32 s26, 0x3ae38e39
  v_mul_f32 v80, s26, v80
  v_mfma_f32_16x16x32_bf16 v[44:47], v[148:151], a[24:27], v[44:47]
  v_mul_f32 v82, s26, v82
  v_fma_f32 v82, -v80, v80, v82
  v_mfma_f32_16x16x32_bf16 v[44:47], v[152:155], a[36:39], v[44:47]
  v_max_f32 v82, 0, v82
  v_cvt_pk_bf16_f32 v80, v80, v82
  v_mfma_f32_16x16x32_bf16 v[44:47], a[216:219], a[48:51], v[44:47]
  v_lshlrev_b32 v84, 16, v80
  v_and_b32 v82, 0xffff0000, v80
  v_mfma_f32_16x16x32_bf16 v[44:47], a[220:223], a[60:63], v[44:47]
  v_add_f32 v82, 0x3727c5ac, v82
  v_cvt_pk_bf16_f32 v82, v82, v82
  v_mfma_f32_16x16x32_bf16 v[48:51], v[140:143], a[4:7], 0
  v_and_b32 v82, 0xffff0000, v82
  v_sqrt_f32 v82, v82
  s_nop 0
  v_cvt_pk_bf16_f32 v82, v82, v82
  v_mfma_f32_16x16x32_bf16 v[48:51], v[144:147], a[16:19], v[48:51]
  v_and_b32 v85, 0xffff0000, v82
  v_rcp_f32 v85, v85
  v_mfma_f32_16x16x32_bf16 v[48:51], v[148:151], a[28:31], v[48:51]
  v_mul_f32 v86, s49, v85
  v_mul_f32_e64 v87, -v84, v86
  v_mfma_f32_16x16x32_bf16 v[48:51], v[152:155], a[40:43], v[48:51]
  v_cmp_eq_u32 vcc, v96, v97
  s_nop 3
  s_mov_b64 exec, vcc
  ds_write_b64 v15, v[86:87]
  s_mov_b64 exec, -1
  s_waitcnt lgkmcnt(0)
  v_mfma_f32_16x16x32_bf16 v[48:51], a[216:219], a[52:55], v[48:51]
  s_barrier
  ds_read2_b32 v[92:93], v15 offset0:0 offset1:1
  v_mfma_f32_16x16x32_bf16 v[48:51], a[220:223], a[64:67], v[48:51]
  ds_read2_b32 v[94:95], v16 offset0:0 offset1:1
  ds_read2_b32 v[96:97], v17 offset0:0 offset1:1
  ds_read2_b32 v[98:99], v18 offset0:0 offset1:1
  v_mfma_f32_16x16x32_bf16 v[52:55], v[140:143], a[8:11], 0
  s_waitcnt lgkmcnt(3)
  v_mov_b32 v72, v92
  v_mov_b32 v76, v93
  v_mfma_f32_16x16x32_bf16 v[52:55], v[144:147], a[20:23], v[52:55]
  global_load_dwordx4 v[140:143], v1, s[22:23] offset:-4096 sc1
  global_load_dwordx4 v[144:147], v1, s[22:23] offset:-3072 sc1
  s_waitcnt lgkmcnt(2)
  v_mov_b32 v73, v94
  v_mov_b32 v77, v95
  v_mfma_f32_16x16x32_bf16 v[52:55], v[148:151], a[32:35], v[52:55]
  s_waitcnt lgkmcnt(1)
  v_mov_b32 v74, v96
  v_mov_b32 v78, v97
  v_mfma_f32_16x16x32_bf16 v[52:55], v[152:155], a[44:47], v[52:55]
  s_waitcnt lgkmcnt(0)
  v_mov_b32 v75, v98
  v_mov_b32 v79, v99
  v_mfma_f32_16x16x32_bf16 v[52:55], a[216:219], a[56:59], v[52:55]
  v_fma_f32 v80, v76, v56, v60
  v_fma_f32 v81, v76, v57, v61
  v_fma_f32 v82, v76, v58, v62
  v_mfma_f32_16x16x32_bf16 v[52:55], a[220:223], a[68:71], v[52:55]
  global_load_dwordx4 v[148:151], v1, s[22:23] offset:-2048 sc1
  global_load_dwordx4 v[152:155], v1, s[22:23] offset:-1024 sc1
  v_fma_f32 v83, v76, v59, v63
  v_fma_f32 v80, v24, v72, v80
  v_fma_f32 v81, v25, v72, v81
  s_waitcnt vmcnt(14)
  v_mfma_f32_16x16x32_bf16 v[40:43], a[224:227], v[208:211], v[40:43]
  v_fma_f32 v82, v26, v72, v82
  v_fma_f32 v83, v27, v72, v83
  v_mfma_f32_16x16x32_bf16 v[40:43], a[228:231], v[212:215], v[40:43]
  v_exp_f32 v84, v80
  v_exp_f32 v85, v81
  v_exp_f32 v86, v82
  v_mfma_f32_16x16x32_bf16 v[40:43], a[232:235], v[216:219], v[40:43]
  v_exp_f32 v87, v83
  v_fma_f32 v88, v84, 0.5, 1.0
  v_mfma_f32_16x16x32_bf16 v[40:43], a[236:239], v[220:223], v[40:43]
  global_load_dwordx4 a[216:219], v1, s[22:23] offset:0 sc1
  v_fma_f32 v89, v85, 0.5, 1.0
  v_fma_f32 v90, v86, 0.5, 1.0
  v_fma_f32 v91, v87, 0.5, 1.0
  v_mfma_f32_16x16x32_bf16 v[40:43], a[240:243], v[224:227], v[40:43]
  v_fma_f32 v88, v88, v84, 1.0
  v_fma_f32 v89, v89, v85, 1.0
  v_fma_f32 v90, v90, v86, 1.0
  v_mfma_f32_16x16x32_bf16 v[40:43], a[244:247], v[228:231], v[40:43]
  v_fma_f32 v91, v91, v87, 1.0
  v_rcp_f32 v88, v88
  v_mfma_f32_16x16x32_bf16 v[44:47], a[224:227], a[72:75], v[44:47]
  v_rcp_f32 v89, v89
  v_rcp_f32 v90, v90
  v_rcp_f32 v91, v91
  v_mfma_f32_16x16x32_bf16 v[44:47], a[228:231], a[84:87], v[44:47]
  global_load_dwordx4 a[220:223], v1, s[22:23] offset:1024 sc1
  v_fma_f32 v80, -v80, v88, v80
  v_fma_f32 v81, -v81, v89, v81
  v_mfma_f32_16x16x32_bf16 v[44:47], a[232:235], a[96:99], v[44:47]
  v_fma_f32 v82, -v82, v90, v82
  v_fma_f32 v83, -v83, v91, v83
  v_cvt_pk_bf16_f32 v104, v80, v81
  v_mfma_f32_16x16x32_bf16 v[44:47], a[236:239], a[108:111], v[44:47]
  v_cvt_pk_bf16_f32 v105, v82, v83
  ds_write_b64 v6, v[104:105] offset:0
  v_mfma_f32_16x16x32_bf16 v[44:47], a[240:243], a[120:123], v[44:47]
  v_fma_f32 v92, v77, v56, v60
  v_fma_f32 v93, v77, v57, v61
  v_fma_f32 v94, v77, v58, v62
  v_mfma_f32_16x16x32_bf16 v[44:47], a[244:247], a[132:135], v[44:47]
  v_fma_f32 v95, v77, v59, v63
  v_fma_f32 v92, v28, v73, v92
  v_fma_f32 v93, v29, v73, v93
  v_mfma_f32_16x16x32_bf16 v[48:51], a[224:227], a[76:79], v[48:51]
  v_fma_f32 v94, v30, v73, v94
  v_fma_f32 v95, v31, v73, v95
  v_mfma_f32_16x16x32_bf16 v[48:51], a[228:231], a[88:91], v[48:51]
  v_exp_f32 v96, v92
  v_exp_f32 v97, v93
  v_exp_f32 v98, v94
  v_mfma_f32_16x16x32_bf16 v[48:51], a[232:235], a[100:103], v[48:51]
  v_exp_f32 v99, v95
  v_fma_f32 v100, v96, 0.5, 1.0
  v_mfma_f32_16x16x32_bf16 v[48:51], a[236:239], a[112:115], v[48:51]
  v_fma_f32 v101, v97, 0.5, 1.0
  v_fma_f32 v102, v98, 0.5, 1.0
  v_fma_f32 v103, v99, 0.5, 1.0
  v_mfma_f32_16x16x32_bf16 v[48:51], a[240:243], a[124:127], v[48:51]
  v_fma_f32 v100, v100, v96, 1.0
  v_fma_f32 v101, v101, v97, 1.0
  v_fma_f32 v102, v102, v98, 1.0
  v_mfma_f32_16x16x32_bf16 v[48:51], a[244:247], a[136:139], v[48:51]
  v_fma_f32 v103, v103, v99, 1.0
  v_rcp_f32 v100, v100
  v_mfma_f32_16x16x32_bf16 v[52:55], a[224:227], a[80:83], v[52:55]
  v_rcp_f32 v101, v101
  v_rcp_f32 v102, v102
  v_rcp_f32 v103, v103
  v_mfma_f32_16x16x32_bf16 v[52:55], a[228:231], a[92:95], v[52:55]
  global_load_dwordx4 a[224:227], v1, s[22:23] offset:2048 sc1
  global_load_dwordx4 a[228:231], v1, s[22:23] offset:3072 sc1
  s_add_u32 s22, s22, 8192
  s_addc_u32 s23, s23, 0
  v_fma_f32 v92, -v92, v100, v92
  v_fma_f32 v93, -v93, v101, v93
  v_mfma_f32_16x16x32_bf16 v[52:55], a[232:235], a[104:107], v[52:55]
  v_fma_f32 v94, -v94, v102, v94
  v_fma_f32 v95, -v95, v103, v95
  v_cvt_pk_bf16_f32 v106, v92, v93
  v_mfma_f32_16x16x32_bf16 v[52:55], a[236:239], a[116:119], v[52:55]
  v_cvt_pk_bf16_f32 v107, v94, v95
  ds_write_b64 v7, v[106:107] offset:0
  v_mfma_f32_16x16x32_bf16 v[52:55], a[240:243], a[128:131], v[52:55]
  v_fma_f32 v80, v78, v56, v60
  v_fma_f32 v81, v78, v57, v61
  v_fma_f32 v82, v78, v58, v62
  v_mfma_f32_16x16x32_bf16 v[52:55], a[244:247], a[140:143], v[52:55]
  global_load_dwordx4 a[232:235], v1, s[22:23] offset:-4096 sc1
  global_load_dwordx4 a[236:239], v1, s[22:23] offset:-3072 sc1
  v_fma_f32 v83, v78, v59, v63
  v_fma_f32 v80, v32, v74, v80
  v_fma_f32 v81, v33, v74, v81
  s_waitcnt vmcnt(14)
  v_mfma_f32_16x16x32_bf16 v[40:43], a[248:251], v[232:235], v[40:43]
  v_fma_f32 v82, v34, v74, v82
  v_fma_f32 v83, v35, v74, v83
  v_mfma_f32_16x16x32_bf16 v[40:43], a[252:255], v[236:239], v[40:43]
  v_exp_f32 v84, v80
  v_exp_f32 v85, v81
  v_exp_f32 v86, v82
  v_mfma_f32_16x16x32_bf16 v[40:43], v[108:111], v[240:243], v[40:43]
  v_exp_f32 v87, v83
  v_fma_f32 v88, v84, 0.5, 1.0
  v_mfma_f32_16x16x32_bf16 v[40:43], v[112:115], v[244:247], v[40:43]
  global_load_dwordx4 a[240:243], v1, s[22:23] offset:-2048 sc1
  v_fma_f32 v89, v85, 0.5, 1.0
  v_fma_f32 v90, v86, 0.5, 1.0
  v_fma_f32 v91, v87, 0.5, 1.0
  v_mfma_f32_16x16x32_bf16 v[40:43], v[116:119], v[248:251], v[40:43]
  v_fma_f32 v88, v88, v84, 1.0
  v_fma_f32 v89, v89, v85, 1.0
  v_fma_f32 v90, v90, v86, 1.0
  v_mfma_f32_16x16x32_bf16 v[40:43], v[120:123], v[252:255], v[40:43]
  v_fma_f32 v91, v91, v87, 1.0
  v_rcp_f32 v88, v88
  v_mfma_f32_16x16x32_bf16 v[44:47], a[248:251], a[144:147], v[44:47]
  v_rcp_f32 v89, v89
  v_rcp_f32 v90, v90
  v_rcp_f32 v91, v91
  v_mfma_f32_16x16x32_bf16 v[44:47], a[252:255], a[156:159], v[44:47]
  global_load_dwordx4 a[244:247], v1, s[22:23] offset:-1024 sc1
  v_fma_f32 v80, -v80, v88, v80
  v_fma_f32 v81, -v81, v89, v81
  v_mfma_f32_16x16x32_bf16 v[44:47], v[108:111], a[168:171], v[44:47]
  v_fma_f32 v82, -v82, v90, v82
  v_fma_f32 v83, -v83, v91, v83
  v_cvt_pk_bf16_f32 v104, v80, v81
  v_mfma_f32_16x16x32_bf16 v[44:47], v[112:115], a[180:183], v[44:47]
  v_cvt_pk_bf16_f32 v105, v82, v83
  ds_write_b64 v8, v[104:105] offset:0
  v_mfma_f32_16x16x32_bf16 v[44:47], v[116:119], a[192:195], v[44:47]
  v_fma_f32 v92, v79, v56, v60
  v_fma_f32 v93, v79, v57, v61
  v_fma_f32 v94, v79, v58, v62
  v_mfma_f32_16x16x32_bf16 v[44:47], v[120:123], a[204:207], v[44:47]
  v_fma_f32 v95, v79, v59, v63
  v_fma_f32 v92, v36, v75, v92
  v_fma_f32 v93, v37, v75, v93
  v_mfma_f32_16x16x32_bf16 v[48:51], a[248:251], a[148:151], v[48:51]
  v_fma_f32 v94, v38, v75, v94
  v_fma_f32 v95, v39, v75, v95
  v_mfma_f32_16x16x32_bf16 v[48:51], a[252:255], a[160:163], v[48:51]
  v_exp_f32 v96, v92
  v_exp_f32 v97, v93
  v_exp_f32 v98, v94
  v_mfma_f32_16x16x32_bf16 v[48:51], v[108:111], a[172:175], v[48:51]
  v_exp_f32 v99, v95
  v_fma_f32 v100, v96, 0.5, 1.0
  v_mfma_f32_16x16x32_bf16 v[48:51], v[112:115], a[184:187], v[48:51]
  v_fma_f32 v101, v97, 0.5, 1.0
  v_fma_f32 v102, v98, 0.5, 1.0
  v_fma_f32 v103, v99, 0.5, 1.0
  v_mfma_f32_16x16x32_bf16 v[48:51], v[116:119], a[196:199], v[48:51]
  v_fma_f32 v100, v100, v96, 1.0
  v_fma_f32 v101, v101, v97, 1.0
  v_fma_f32 v102, v102, v98, 1.0
  v_mfma_f32_16x16x32_bf16 v[48:51], v[120:123], a[208:211], v[48:51]
  v_fma_f32 v103, v103, v99, 1.0
  v_rcp_f32 v100, v100
  v_mfma_f32_16x16x32_bf16 v[52:55], a[248:251], a[152:155], v[52:55]
  v_rcp_f32 v101, v101
  v_rcp_f32 v102, v102
  v_rcp_f32 v103, v103
  ds_read_b128 v[64:67], v14 offset:128
  ds_read_b128 v[68:71], v14 offset:192
  v_mfma_f32_16x16x32_bf16 v[52:55], a[252:255], a[164:167], v[52:55]
  global_load_dwordx4 a[248:251], v1, s[22:23] offset:0 sc1
  global_load_dwordx4 a[252:255], v1, s[22:23] offset:1024 sc1
  v_fma_f32 v92, -v92, v100, v92
  v_fma_f32 v93, -v93, v101, v93
  v_mfma_f32_16x16x32_bf16 v[52:55], v[108:111], a[176:179], v[52:55]
  v_fma_f32 v94, -v94, v102, v94
  v_fma_f32 v95, -v95, v103, v95
  v_cvt_pk_bf16_f32 v106, v92, v93
  v_mfma_f32_16x16x32_bf16 v[52:55], v[112:115], a[188:191], v[52:55]
  v_cvt_pk_bf16_f32 v107, v94, v95
  ds_write_b64 v9, v[106:107] offset:0
  v_mfma_f32_16x16x32_bf16 v[52:55], v[116:119], a[200:203], v[52:55]
  v_mfma_f32_16x16x32_bf16 v[52:55], v[120:123], a[212:215], v[52:55]
  global_load_dwordx4 v[108:111], v1, s[22:23] offset:2048 sc1
  global_load_dwordx4 v[112:115], v1, s[22:23] offset:3072 sc1
  s_add_u32 s22, s22, 8192
  s_addc_u32 s23, s23, 0
  s_waitcnt vmcnt(14)
  v_mfma_f32_16x16x32_bf16 v[24:27], v[124:127], v[184:187], 0
  v_mfma_f32_16x16x32_bf16 v[24:27], v[128:131], v[188:191], v[24:27]
  v_mfma_f32_16x16x32_bf16 v[24:27], v[132:135], v[192:195], v[24:27]
  s_waitcnt lgkmcnt(1)
  v_fma_f32 v80, v76, v64, v68
  v_fma_f32 v81, v76, v65, v69
  v_mfma_f32_16x16x32_bf16 v[24:27], v[136:139], v[196:199], v[24:27]
  global_load_dwordx4 v[116:119], v1, s[22:23] offset:-4096 sc1
  v_fma_f32 v82, v76, v66, v70
  v_fma_f32 v83, v76, v67, v71
  v_mfma_f32_16x16x32_bf16 v[24:27], v[140:143], v[200:203], v[24:27]
  v_fma_f32 v80, v40, v72, v80
  v_fma_f32 v81, v41, v72, v81
  v_mfma_f32_16x16x32_bf16 v[24:27], v[144:147], v[204:207], v[24:27]
  v_fma_f32 v82, v42, v72, v82
  v_fma_f32 v83, v43, v72, v83
  v_mfma_f32_16x16x32_bf16 v[28:31], v[124:127], a[0:3], 0
  v_exp_f32 v84, v80
  v_exp_f32 v85, v81
  v_mfma_f32_16x16x32_bf16 v[28:31], v[128:131], a[12:15], v[28:31]
  global_load_dwordx4 v[120:123], v1, s[22:23] offset:-3072 sc1
  v_exp_f32 v86, v82
  v_mfma_f32_16x16x32_bf16 v[28:31], v[132:135], a[24:27], v[28:31]
  v_exp_f32 v87, v83
  v_fma_f32 v88, v84, 0.5, 1.0
  v_mfma_f32_16x16x32_bf16 v[28:31], v[136:139], a[36:39], v[28:31]
  v_fma_f32 v89, v85, 0.5, 1.0
  v_fma_f32 v90, v86, 0.5, 1.0
  v_mfma_f32_16x16x32_bf16 v[28:31], v[140:143], a[48:51], v[28:31]
  v_fma_f32 v91, v87, 0.5, 1.0
  v_fma_f32 v88, v88, v84, 1.0
  v_mfma_f32_16x16x32_bf16 v[28:31], v[144:147], a[60:63], v[28:31]
  v_fma_f32 v89, v89, v85, 1.0
  v_fma_f32 v90, v90, v86, 1.0
  v_mfma_f32_16x16x32_bf16 v[32:35], v[124:127], a[4:7], 0
  v_fma_f32 v91, v91, v87, 1.0
  v_rcp_f32 v88, v88
  v_mfma_f32_16x16x32_bf16 v[32:35], v[128:131], a[16:19], v[32:35]
  v_rcp_f32 v89, v89
  v_mfma_f32_16x16x32_bf16 v[32:35], v[132:135], a[28:31], v[32:35]
  v_rcp_f32 v90, v90
  v_rcp_f32 v91, v91
  v_mfma_f32_16x16x32_bf16 v[32:35], v[136:139], a[40:43], v[32:35]
  v_fma_f32 v80, -v80, v88, v80
  v_fma_f32 v81, -v81, v89, v81
  v_mfma_f32_16x16x32_bf16 v[32:35], v[140:143], a[52:55], v[32:35]
  v_fma_f32 v82, -v82, v90, v82
  v_fma_f32 v83, -v83, v91, v83
  v_mfma_f32_16x16x32_bf16 v[32:35], v[144:147], a[64:67], v[32:35]
  v_cvt_pk_bf16_f32 v104, v80, v81
  v_cvt_pk_bf16_f32 v105, v82, v83
  v_mfma_f32_16x16x32_bf16 v[36:39], v[124:127], a[8:11], 0
  ds_write_b64 v6, v[104:105] offset:8
  v_mfma_f32_16x16x32_bf16 v[36:39], v[128:131], a[20:23], v[36:39]
  global_load_dwordx4 v[124:127], v1, s[22:23] offset:-2048 sc1
  global_load_dwordx4 v[128:131], v1, s[22:23] offset:-1024 sc1
  v_fma_f32 v92, v77, v64, v68
  v_fma_f32 v93, v77, v65, v69
  v_mfma_f32_16x16x32_bf16 v[36:39], v[132:135], a[32:35], v[36:39]
  v_fma_f32 v94, v77, v66, v70
  v_fma_f32 v95, v77, v67, v71
  v_mfma_f32_16x16x32_bf16 v[36:39], v[136:139], a[44:47], v[36:39]
  v_fma_f32 v92, v44, v73, v92
  v_fma_f32 v93, v45, v73, v93
  v_mfma_f32_16x16x32_bf16 v[36:39], v[140:143], a[56:59], v[36:39]
  v_fma_f32 v94, v46, v73, v94
  v_fma_f32 v95, v47, v73, v95
  v_mfma_f32_16x16x32_bf16 v[36:39], v[144:147], a[68:71], v[36:39]
  global_load_dwordx4 v[132:135], v1, s[22:23] offset:0 sc1
  global_load_dwordx4 v[136:139], v1, s[22:23] offset:1024 sc1
  v_exp_f32 v96, v92
  v_exp_f32 v97, v93
  s_waitcnt vmcnt(14)
  v_mfma_f32_16x16x32_bf16 v[24:27], v[148:151], v[208:211], v[24:27]
  v_exp_f32 v98, v94
  v_mfma_f32_16x16x32_bf16 v[24:27], v[152:155], v[212:215], v[24:27]
  v_exp_f32 v99, v95
  v_fma_f32 v100, v96, 0.5, 1.0
  v_mfma_f32_16x16x32_bf16 v[24:27], a[216:219], v[216:219], v[24:27]
  v_fma_f32 v101, v97, 0.5, 1.0
  v_fma_f32 v102, v98, 0.5, 1.0
  v_mfma_f32_16x16x32_bf16 v[24:27], a[220:223], v[220:223], v[24:27]
  global_load_dwordx4 v[140:143], v1, s[22:23] offset:2048 sc1
  v_fma_f32 v103, v99, 0.5, 1.0
  v_fma_f32 v100, v100, v96, 1.0
  v_mfma_f32_16x16x32_bf16 v[24:27], a[224:227], v[224:227], v[24:27]
  v_fma_f32 v101, v101, v97, 1.0
  v_fma_f32 v102, v102, v98, 1.0
  v_mfma_f32_16x16x32_bf16 v[24:27], a[228:231], v[228:231], v[24:27]
  v_fma_f32 v103, v103, v99, 1.0
  v_rcp_f32 v100, v100
  v_mfma_f32_16x16x32_bf16 v[28:31], v[148:151], a[72:75], v[28:31]
  v_rcp_f32 v101, v101
  v_mfma_f32_16x16x32_bf16 v[28:31], v[152:155], a[84:87], v[28:31]
  global_load_dwordx4 v[144:147], v1, s[22:23] offset:3072 sc1
  s_add_u32 s22, s22, 8192
  s_addc_u32 s23, s23, 0
  v_rcp_f32 v102, v102
  v_rcp_f32 v103, v103
  v_mfma_f32_16x16x32_bf16 v[28:31], a[216:219], a[96:99], v[28:31]
  v_fma_f32 v92, -v92, v100, v92
  v_fma_f32 v93, -v93, v101, v93
  v_mfma_f32_16x16x32_bf16 v[28:31], a[220:223], a[108:111], v[28:31]
  v_fma_f32 v94, -v94, v102, v94
  v_fma_f32 v95, -v95, v103, v95
  v_mfma_f32_16x16x32_bf16 v[28:31], a[224:227], a[120:123], v[28:31]
  v_cvt_pk_bf16_f32 v106, v92, v93
  v_cvt_pk_bf16_f32 v107, v94, v95
  v_mfma_f32_16x16x32_bf16 v[28:31], a[228:231], a[132:135], v[28:31]
  ds_write_b64 v7, v[106:107] offset:8
  v_mfma_f32_16x16x32_bf16 v[32:35], v[148:151], a[76:79], v[32:35]
  v_fma_f32 v80, v78, v64, v68
  v_fma_f32 v81, v78, v65, v69
  v_mfma_f32_16x16x32_bf16 v[32:35], v[152:155], a[88:91], v[32:35]
  v_fma_f32 v82, v78, v66, v70
  v_fma_f32 v83, v78, v67, v71
  v_mfma_f32_16x16x32_bf16 v[32:35], a[216:219], a[100:103], v[32:35]
  v_fma_f32 v80, v48, v74, v80
  v_fma_f32 v81, v49, v74, v81
  v_mfma_f32_16x16x32_bf16 v[32:35], a[220:223], a[112:115], v[32:35]
  v_fma_f32 v82, v50, v74, v82
  v_fma_f32 v83, v51, v74, v83
  v_mfma_f32_16x16x32_bf16 v[32:35], a[224:227], a[124:127], v[32:35]
  v_exp_f32 v84, v80
  v_exp_f32 v85, v81
  v_mfma_f32_16x16x32_bf16 v[32:35], a[228:231], a[136:139], v[32:35]
  v_exp_f32 v86, v82
  v_mfma_f32_16x16x32_bf16 v[36:39], v[148:151], a[80:83], v[36:39]
  v_exp_f32 v87, v83
  v_fma_f32 v88, v84, 0.5, 1.0
  v_mfma_f32_16x16x32_bf16 v[36:39], v[152:155], a[92:95], v[36:39]
  global_load_dwordx4 v[148:151], v1, s[22:23] offset:-4096 sc1
  global_load_dwordx4 v[152:155], v1, s[22:23] offset:-3072 sc1
  v_fma_f32 v89, v85, 0.5, 1.0
  v_fma_f32 v90, v86, 0.5, 1.0
  v_mfma_f32_16x16x32_bf16 v[36:39], a[216:219], a[104:107], v[36:39]
  v_fma_f32 v91, v87, 0.5, 1.0
  v_fma_f32 v88, v88, v84, 1.0
  v_mfma_f32_16x16x32_bf16 v[36:39], a[220:223], a[116:119], v[36:39]
  v_fma_f32 v89, v89, v85, 1.0
  v_fma_f32 v90, v90, v86, 1.0
  v_mfma_f32_16x16x32_bf16 v[36:39], a[224:227], a[128:131], v[36:39]
  v_fma_f32 v91, v91, v87, 1.0
  v_rcp_f32 v88, v88
  v_mfma_f32_16x16x32_bf16 v[36:39], a[228:231], a[140:143], v[36:39]
  global_load_dwordx4 a[216:219], v1, s[22:23] offset:-2048 sc1
  global_load_dwordx4 a[220:223], v1, s[22:23] offset:-1024 sc1
  v_rcp_f32 v89, v89
  s_waitcnt vmcnt(14)
  v_mfma_f32_16x16x32_bf16 v[24:27], a[232:235], v[232:235], v[24:27]
  v_rcp_f32 v90, v90
  v_rcp_f32 v91, v91
  v_mfma_f32_16x16x32_bf16 v[24:27], a[236:239], v[236:239], v[24:27]
  v_fma_f32 v80, -v80, v88, v80
  v_fma_f32 v81, -v81, v89, v81
  v_mfma_f32_16x16x32_bf16 v[24:27], a[240:243], v[240:243], v[24:27]
  v_fma_f32 v82, -v82, v90, v82
  v_fma_f32 v83, -v83, v91, v83
  v_mfma_f32_16x16x32_bf16 v[24:27], a[244:247], v[244:247], v[24:27]
  global_load_dwordx4 a[224:227], v1, s[22:23] offset:0 sc1
  v_cvt_pk_bf16_f32 v104, v80, v81
  v_cvt_pk_bf16_f32 v105, v82, v83
  v_mfma_f32_16x16x32_bf16 v[24:27], a[248:251], v[248:251], v[24:27]
  ds_write_b64 v8, v[104:105] offset:8
  v_mfma_f32_16x16x32_bf16 v[24:27], a[252:255], v[252:255], v[24:27]
  v_fma_f32 v92, v79, v64, v68
  v_fma_f32 v93, v79, v65, v69
  v_mfma_f32_16x16x32_bf16 v[28:31], a[232:235], a[144:147], v[28:31]
  v_fma_f32 v94, v79, v66, v70
  v_fma_f32 v95, v79, v67, v71
  v_mfma_f32_16x16x32_bf16 v[28:31], a[236:239], a[156:159], v[28:31]
  global_load_dwordx4 a[228:231], v1, s[22:23] offset:1024 sc1
  v_fma_f32 v92, v52, v75, v92
  v_fma_f32 v93, v53, v75, v93
  v_mfma_f32_16x16x32_bf16 v[28:31], a[240:243], a[168:171], v[28:31]
  v_fma_f32 v94, v54, v75, v94
  v_fma_f32 v95, v55, v75, v95
  v_mfma_f32_16x16x32_bf16 v[28:31], a[244:247], a[180:183], v[28:31]
  v_exp_f32 v96, v92
  v_exp_f32 v97, v93
  v_mfma_f32_16x16x32_bf16 v[28:31], a[248:251], a[192:195], v[28:31]
  v_exp_f32 v98, v94
  v_mfma_f32_16x16x32_bf16 v[28:31], a[252:255], a[204:207], v[28:31]
  v_exp_f32 v99, v95
  v_fma_f32 v100, v96, 0.5, 1.0
  v_mfma_f32_16x16x32_bf16 v[32:35], a[232:235], a[148:151], v[32:35]
  v_fma_f32 v101, v97, 0.5, 1.0
  v_fma_f32 v102, v98, 0.5, 1.0
  v_mfma_f32_16x16x32_bf16 v[32:35], a[236:239], a[160:163], v[32:35]
  v_fma_f32 v103, v99, 0.5, 1.0
  v_fma_f32 v100, v100, v96, 1.0
  v_mfma_f32_16x16x32_bf16 v[32:35], a[240:243], a[172:175], v[32:35]
  v_fma_f32 v101, v101, v97, 1.0
  v_fma_f32 v102, v102, v98, 1.0
  v_mfma_f32_16x16x32_bf16 v[32:35], a[244:247], a[184:187], v[32:35]
  v_fma_f32 v103, v103, v99, 1.0
  v_rcp_f32 v100, v100
  v_mfma_f32_16x16x32_bf16 v[32:35], a[248:251], a[196:199], v[32:35]
  v_rcp_f32 v101, v101
  v_mfma_f32_16x16x32_bf16 v[32:35], a[252:255], a[208:211], v[32:35]
  v_rcp_f32 v102, v102
  v_rcp_f32 v103, v103
  v_mfma_f32_16x16x32_bf16 v[36:39], a[232:235], a[152:155], v[36:39]
  v_fma_f32 v92, -v92, v100, v92
  v_fma_f32 v93, -v93, v101, v93
  ds_read_b128 v[56:59], v14 offset:256
  ds_read_b128 v[60:63], v14 offset:320
  v_mfma_f32_16x16x32_bf16 v[36:39], a[236:239], a[164:167], v[36:39]
  global_load_dwordx4 a[232:235], v1, s[22:23] offset:2048 sc1
  global_load_dwordx4 a[236:239], v1, s[22:23] offset:3072 sc1
  s_add_u32 s22, s22, 8192
  s_addc_u32 s23, s23, 0
  v_fma_f32 v94, -v94, v102, v94
  v_fma_f32 v95, -v95, v103, v95
  v_mfma_f32_16x16x32_bf16 v[36:39], a[240:243], a[176:179], v[36:39]
  v_cvt_pk_bf16_f32 v106, v92, v93
  v_cvt_pk_bf16_f32 v107, v94, v95
  v_mfma_f32_16x16x32_bf16 v[36:39], a[244:247], a[188:191], v[36:39]
  ds_write_b64 v9, v[106:107] offset:8
  v_mfma_f32_16x16x32_bf16 v[36:39], a[248:251], a[200:203], v[36:39]
  v_mfma_f32_16x16x32_bf16 v[36:39], a[252:255], a[212:215], v[36:39]
  global_load_dwordx4 a[240:243], v1, s[22:23] offset:-4096 sc1
  global_load_dwordx4 a[244:247], v1, s[22:23] offset:-3072 sc1
  s_waitcnt vmcnt(14)
  v_mfma_f32_16x16x32_bf16 v[40:43], v[108:111], v[184:187], 0
  v_mfma_f32_16x16x32_bf16 v[40:43], v[112:115], v[188:191], v[40:43]
  v_mfma_f32_16x16x32_bf16 v[40:43], v[116:119], v[192:195], v[40:43]
  s_waitcnt lgkmcnt(1)
  v_fma_f32 v80, v76, v56, v60
  v_fma_f32 v81, v76, v57, v61
  v_mfma_f32_16x16x32_bf16 v[40:43], v[120:123], v[196:199], v[40:43]
  global_load_dwordx4 a[248:251], v1, s[22:23] offset:-2048 sc1
  v_fma_f32 v82, v76, v58, v62
  v_fma_f32 v83, v76, v59, v63
  v_mfma_f32_16x16x32_bf16 v[40:43], v[124:127], v[200:203], v[40:43]
  v_fma_f32 v80, v24, v72, v80
  v_fma_f32 v81, v25, v72, v81
  v_mfma_f32_16x16x32_bf16 v[40:43], v[128:131], v[204:207], v[40:43]
  v_fma_f32 v82, v26, v72, v82
  v_fma_f32 v83, v27, v72, v83
  v_mfma_f32_16x16x32_bf16 v[44:47], v[108:111], a[0:3], 0
  v_exp_f32 v84, v80
  v_exp_f32 v85, v81
  v_mfma_f32_16x16x32_bf16 v[44:47], v[112:115], a[12:15], v[44:47]
  global_load_dwordx4 a[252:255], v1, s[22:23] offset:-1024 sc1
  v_exp_f32 v86, v82
  v_mfma_f32_16x16x32_bf16 v[44:47], v[116:119], a[24:27], v[44:47]
  v_exp_f32 v87, v83
  v_fma_f32 v88, v84, 0.5, 1.0
  v_mfma_f32_16x16x32_bf16 v[44:47], v[120:123], a[36:39], v[44:47]
  v_fma_f32 v89, v85, 0.5, 1.0
  v_fma_f32 v90, v86, 0.5, 1.0
  v_mfma_f32_16x16x32_bf16 v[44:47], v[124:127], a[48:51], v[44:47]
  v_fma_f32 v91, v87, 0.5, 1.0
  v_fma_f32 v88, v88, v84, 1.0
  v_mfma_f32_16x16x32_bf16 v[44:47], v[128:131], a[60:63], v[44:47]
  v_fma_f32 v89, v89, v85, 1.0
  v_fma_f32 v90, v90, v86, 1.0
  v_mfma_f32_16x16x32_bf16 v[48:51], v[108:111], a[4:7], 0
  v_fma_f32 v91, v91, v87, 1.0
  v_rcp_f32 v88, v88
  v_mfma_f32_16x16x32_bf16 v[48:51], v[112:115], a[16:19], v[48:51]
  v_rcp_f32 v89, v89
  v_mfma_f32_16x16x32_bf16 v[48:51], v[116:119], a[28:31], v[48:51]
  v_rcp_f32 v90, v90
  v_rcp_f32 v91, v91
  v_mfma_f32_16x16x32_bf16 v[48:51], v[120:123], a[40:43], v[48:51]
  v_fma_f32 v80, -v80, v88, v80
  v_fma_f32 v81, -v81, v89, v81
  v_mfma_f32_16x16x32_bf16 v[48:51], v[124:127], a[52:55], v[48:51]
  v_fma_f32 v82, -v82, v90, v82
  v_fma_f32 v83, -v83, v91, v83
  v_mfma_f32_16x16x32_bf16 v[48:51], v[128:131], a[64:67], v[48:51]
  v_cvt_pk_bf16_f32 v104, v80, v81
  v_cvt_pk_bf16_f32 v105, v82, v83
  v_mfma_f32_16x16x32_bf16 v[52:55], v[108:111], a[8:11], 0
  ds_write_b64 v6, v[104:105] offset:16384
  v_mfma_f32_16x16x32_bf16 v[52:55], v[112:115], a[20:23], v[52:55]
  global_load_dwordx4 v[108:111], v1, s[22:23] offset:0 sc1
  global_load_dwordx4 v[112:115], v1, s[22:23] offset:1024 sc1
  v_fma_f32 v92, v77, v56, v60
  v_fma_f32 v93, v77, v57, v61
  v_mfma_f32_16x16x32_bf16 v[52:55], v[116:119], a[32:35], v[52:55]
  v_fma_f32 v94, v77, v58, v62
  v_fma_f32 v95, v77, v59, v63
  v_mfma_f32_16x16x32_bf16 v[52:55], v[120:123], a[44:47], v[52:55]
  v_fma_f32 v92, v28, v73, v92
  v_fma_f32 v93, v29, v73, v93
  v_mfma_f32_16x16x32_bf16 v[52:55], v[124:127], a[56:59], v[52:55]
  v_fma_f32 v94, v30, v73, v94
  v_fma_f32 v95, v31, v73, v95
  v_mfma_f32_16x16x32_bf16 v[52:55], v[128:131], a[68:71], v[52:55]
  global_load_dwordx4 v[116:119], v1, s[22:23] offset:2048 sc1
  global_load_dwordx4 v[120:123], v1, s[22:23] offset:3072 sc1
  s_add_u32 s22, s22, 8192
  s_addc_u32 s23, s23, 0
  v_exp_f32 v96, v92
  v_exp_f32 v97, v93
  s_waitcnt vmcnt(14)
  v_mfma_f32_16x16x32_bf16 v[40:43], v[132:135], v[208:211], v[40:43]
  v_exp_f32 v98, v94
  v_mfma_f32_16x16x32_bf16 v[40:43], v[136:139], v[212:215], v[40:43]
  v_exp_f32 v99, v95
  v_fma_f32 v100, v96, 0.5, 1.0
  v_mfma_f32_16x16x32_bf16 v[40:43], v[140:143], v[216:219], v[40:43]
  v_fma_f32 v101, v97, 0.5, 1.0
  v_fma_f32 v102, v98, 0.5, 1.0
  v_mfma_f32_16x16x32_bf16 v[40:43], v[144:147], v[220:223], v[40:43]
  global_load_dwordx4 v[124:127], v1, s[22:23] offset:-4096 sc1
  v_fma_f32 v103, v99, 0.5, 1.0
  v_fma_f32 v100, v100, v96, 1.0
  v_mfma_f32_16x16x32_bf16 v[40:43], v[148:151], v[224:227], v[40:43]
  v_fma_f32 v101, v101, v97, 1.0
  v_fma_f32 v102, v102, v98, 1.0
  v_mfma_f32_16x16x32_bf16 v[40:43], v[152:155], v[228:231], v[40:43]
  v_fma_f32 v103, v103, v99, 1.0
  v_rcp_f32 v100, v100
  v_mfma_f32_16x16x32_bf16 v[44:47], v[132:135], a[72:75], v[44:47]
  v_rcp_f32 v101, v101
  v_mfma_f32_16x16x32_bf16 v[44:47], v[136:139], a[84:87], v[44:47]
  global_load_dwordx4 v[128:131], v1, s[22:23] offset:-3072 sc1
  v_rcp_f32 v102, v102
  v_rcp_f32 v103, v103
  v_mfma_f32_16x16x32_bf16 v[44:47], v[140:143], a[96:99], v[44:47]
  v_fma_f32 v92, -v92, v100, v92
  v_fma_f32 v93, -v93, v101, v93
  v_mfma_f32_16x16x32_bf16 v[44:47], v[144:147], a[108:111], v[44:47]
  v_fma_f32 v94, -v94, v102, v94
  v_fma_f32 v95, -v95, v103, v95
  v_mfma_f32_16x16x32_bf16 v[44:47], v[148:151], a[120:123], v[44:47]
  v_cvt_pk_bf16_f32 v106, v92, v93
  v_cvt_pk_bf16_f32 v107, v94, v95
  v_mfma_f32_16x16x32_bf16 v[44:47], v[152:155], a[132:135], v[44:47]
  ds_write_b64 v7, v[106:107] offset:16384
  v_mfma_f32_16x16x32_bf16 v[48:51], v[132:135], a[76:79], v[48:51]
  v_fma_f32 v80, v78, v56, v60
  v_fma_f32 v81, v78, v57, v61
  v_mfma_f32_16x16x32_bf16 v[48:51], v[136:139], a[88:91], v[48:51]
  v_fma_f32 v82, v78, v58, v62
  v_fma_f32 v83, v78, v59, v63
  v_mfma_f32_16x16x32_bf16 v[48:51], v[140:143], a[100:103], v[48:51]
  v_fma_f32 v80, v32, v74, v80
  v_fma_f32 v81, v33, v74, v81
  v_mfma_f32_16x16x32_bf16 v[48:51], v[144:147], a[112:115], v[48:51]
  v_fma_f32 v82, v34, v74, v82
  v_fma_f32 v83, v35, v74, v83
  v_mfma_f32_16x16x32_bf16 v[48:51], v[148:151], a[124:127], v[48:51]
  v_exp_f32 v84, v80
  v_exp_f32 v85, v81
  v_mfma_f32_16x16x32_bf16 v[48:51], v[152:155], a[136:139], v[48:51]
  v_exp_f32 v86, v82
  v_mfma_f32_16x16x32_bf16 v[52:55], v[132:135], a[80:83], v[52:55]
  v_exp_f32 v87, v83
  v_fma_f32 v88, v84, 0.5, 1.0
  v_mfma_f32_16x16x32_bf16 v[52:55], v[136:139], a[92:95], v[52:55]
  global_load_dwordx4 v[132:135], v1, s[22:23] offset:-2048 sc1
  global_load_dwordx4 v[136:139], v1, s[22:23] offset:-1024 sc1
  v_fma_f32 v89, v85, 0.5, 1.0
  v_fma_f32 v90, v86, 0.5, 1.0
  v_mfma_f32_16x16x32_bf16 v[52:55], v[140:143], a[104:107], v[52:55]
  v_fma_f32 v91, v87, 0.5, 1.0
  v_fma_f32 v88, v88, v84, 1.0
  v_mfma_f32_16x16x32_bf16 v[52:55], v[144:147], a[116:119], v[52:55]
  v_fma_f32 v89, v89, v85, 1.0
  v_fma_f32 v90, v90, v86, 1.0
  v_mfma_f32_16x16x32_bf16 v[52:55], v[148:151], a[128:131], v[52:55]
  v_fma_f32 v91, v91, v87, 1.0
  v_rcp_f32 v88, v88
  v_mfma_f32_16x16x32_bf16 v[52:55], v[152:155], a[140:143], v[52:55]
  global_load_dwordx4 v[140:143], v1, s[22:23] offset:0 sc1
  global_load_dwordx4 v[144:147], v1, s[22:23] offset:1024 sc1
  v_rcp_f32 v89, v89
  s_waitcnt vmcnt(14)
  v_mfma_f32_16x16x32_bf16 v[40:43], a[216:219], v[232:235], v[40:43]
  v_rcp_f32 v90, v90
  v_rcp_f32 v91, v91
  v_mfma_f32_16x16x32_bf16 v[40:43], a[220:223], v[236:239], v[40:43]
  v_fma_f32 v80, -v80, v88, v80
  v_fma_f32 v81, -v81, v89, v81
  v_mfma_f32_16x16x32_bf16 v[40:43], a[224:227], v[240:243], v[40:43]
  v_fma_f32 v82, -v82, v90, v82
  v_fma_f32 v83, -v83, v91, v83
  v_mfma_f32_16x16x32_bf16 v[40:43], a[228:231], v[244:247], v[40:43]
  global_load_dwordx4 v[148:151], v1, s[22:23] offset:2048 sc1
  v_cvt_pk_bf16_f32 v104, v80, v81
  v_cvt_pk_bf16_f32 v105, v82, v83
  v_mfma_f32_16x16x32_bf16 v[40:43], a[232:235], v[248:251], v[40:43]
  ds_write_b64 v8, v[104:105] offset:16384
  v_mfma_f32_16x16x32_bf16 v[40:43], a[236:239], v[252:255], v[40:43]
  v_fma_f32 v92, v79, v56, v60
  v_fma_f32 v93, v79, v57, v61
  v_mfma_f32_16x16x32_bf16 v[44:47], a[216:219], a[144:147], v[44:47]
  v_fma_f32 v94, v79, v58, v62
  v_fma_f32 v95, v79, v59, v63
  v_mfma_f32_16x16x32_bf16 v[44:47], a[220:223], a[156:159], v[44:47]
  global_load_dwordx4 v[152:155], v1, s[22:23] offset:3072 sc1
  s_add_u32 s22, s22, 8192
  s_addc_u32 s23, s23, 0
  v_fma_f32 v92, v36, v75, v92
  v_fma_f32 v93, v37, v75, v93
  v_mfma_f32_16x16x32_bf16 v[44:47], a[224:227], a[168:171], v[44:47]
  v_fma_f32 v94, v38, v75, v94
  v_fma_f32 v95, v39, v75, v95
  v_mfma_f32_16x16x32_bf16 v[44:47], a[228:231], a[180:183], v[44:47]
  v_exp_f32 v96, v92
  v_exp_f32 v97, v93
  v_mfma_f32_16x16x32_bf16 v[44:47], a[232:235], a[192:195], v[44:47]
  v_exp_f32 v98, v94
  v_mfma_f32_16x16x32_bf16 v[44:47], a[236:239], a[204:207], v[44:47]
  v_exp_f32 v99, v95
  v_fma_f32 v100, v96, 0.5, 1.0
  v_mfma_f32_16x16x32_bf16 v[48:51], a[216:219], a[148:151], v[48:51]
  v_fma_f32 v101, v97, 0.5, 1.0
  v_fma_f32 v102, v98, 0.5, 1.0
  v_mfma_f32_16x16x32_bf16 v[48:51], a[220:223], a[160:163], v[48:51]
  v_fma_f32 v103, v99, 0.5, 1.0
  v_fma_f32 v100, v100, v96, 1.0
  v_mfma_f32_16x16x32_bf16 v[48:51], a[224:227], a[172:175], v[48:51]
  v_fma_f32 v101, v101, v97, 1.0
  v_fma_f32 v102, v102, v98, 1.0
  v_mfma_f32_16x16x32_bf16 v[48:51], a[228:231], a[184:187], v[48:51]
  v_fma_f32 v103, v103, v99, 1.0
  v_rcp_f32 v100, v100
  v_mfma_f32_16x16x32_bf16 v[48:51], a[232:235], a[196:199], v[48:51]
  v_rcp_f32 v101, v101
  v_mfma_f32_16x16x32_bf16 v[48:51], a[236:239], a[208:211], v[48:51]
  v_rcp_f32 v102, v102
  v_rcp_f32 v103, v103
  v_mfma_f32_16x16x32_bf16 v[52:55], a[216:219], a[152:155], v[52:55]
  v_fma_f32 v92, -v92, v100, v92
  v_fma_f32 v93, -v93, v101, v93
  ds_read_b128 v[64:67], v14 offset:384
  ds_read_b128 v[68:71], v14 offset:448
  v_mfma_f32_16x16x32_bf16 v[52:55], a[220:223], a[164:167], v[52:55]
  global_load_dwordx4 a[216:219], v1, s[22:23] offset:-4096 sc1
  global_load_dwordx4 a[220:223], v1, s[22:23] offset:-3072 sc1
  v_fma_f32 v94, -v94, v102, v94
  v_fma_f32 v95, -v95, v103, v95
  v_mfma_f32_16x16x32_bf16 v[52:55], a[224:227], a[176:179], v[52:55]
  v_cvt_pk_bf16_f32 v106, v92, v93
  v_cvt_pk_bf16_f32 v107, v94, v95
  v_mfma_f32_16x16x32_bf16 v[52:55], a[228:231], a[188:191], v[52:55]
  ds_write_b64 v9, v[106:107] offset:16384
  v_mfma_f32_16x16x32_bf16 v[52:55], a[232:235], a[200:203], v[52:55]
  v_mfma_f32_16x16x32_bf16 v[52:55], a[236:239], a[212:215], v[52:55]
  global_load_dwordx4 a[224:227], v1, s[22:23] offset:-2048 sc1
  global_load_dwordx4 a[228:231], v1, s[22:23] offset:-1024 sc1
  s_waitcnt vmcnt(14)
  v_mfma_f32_16x16x32_bf16 v[24:27], a[240:243], v[184:187], 0
  v_mfma_f32_16x16x32_bf16 v[24:27], a[244:247], v[188:191], v[24:27]
  v_mfma_f32_16x16x32_bf16 v[24:27], a[248:251], v[192:195], v[24:27]
  s_waitcnt lgkmcnt(1)
  v_fma_f32 v80, v76, v64, v68
  v_fma_f32 v81, v76, v65, v69
  v_mfma_f32_16x16x32_bf16 v[24:27], a[252:255], v[196:199], v[24:27]
  global_load_dwordx4 a[232:235], v1, s[22:23] offset:0 sc1
  v_fma_f32 v82, v76, v66, v70
  v_fma_f32 v83, v76, v67, v71
  v_mfma_f32_16x16x32_bf16 v[24:27], v[108:111], v[200:203], v[24:27]
  v_fma_f32 v80, v40, v72, v80
  v_fma_f32 v81, v41, v72, v81
  v_mfma_f32_16x16x32_bf16 v[24:27], v[112:115], v[204:207], v[24:27]
  v_fma_f32 v82, v42, v72, v82
  v_fma_f32 v83, v43, v72, v83
  v_mfma_f32_16x16x32_bf16 v[28:31], a[240:243], a[0:3], 0
  v_exp_f32 v84, v80
  v_exp_f32 v85, v81
  v_mfma_f32_16x16x32_bf16 v[28:31], a[244:247], a[12:15], v[28:31]
  global_load_dwordx4 a[236:239], v1, s[22:23] offset:1024 sc1
  v_exp_f32 v86, v82
  v_mfma_f32_16x16x32_bf16 v[28:31], a[248:251], a[24:27], v[28:31]
  v_exp_f32 v87, v83
  v_fma_f32 v88, v84, 0.5, 1.0
  v_mfma_f32_16x16x32_bf16 v[28:31], a[252:255], a[36:39], v[28:31]
  v_fma_f32 v89, v85, 0.5, 1.0
  v_fma_f32 v90, v86, 0.5, 1.0
  v_mfma_f32_16x16x32_bf16 v[28:31], v[108:111], a[48:51], v[28:31]
  v_fma_f32 v91, v87, 0.5, 1.0
  v_fma_f32 v88, v88, v84, 1.0
  v_mfma_f32_16x16x32_bf16 v[28:31], v[112:115], a[60:63], v[28:31]
  v_fma_f32 v89, v89, v85, 1.0
  v_fma_f32 v90, v90, v86, 1.0
  v_mfma_f32_16x16x32_bf16 v[32:35], a[240:243], a[4:7], 0
  v_fma_f32 v91, v91, v87, 1.0
  v_rcp_f32 v88, v88
  v_mfma_f32_16x16x32_bf16 v[32:35], a[244:247], a[16:19], v[32:35]
  v_rcp_f32 v89, v89
  v_mfma_f32_16x16x32_bf16 v[32:35], a[248:251], a[28:31], v[32:35]
  v_rcp_f32 v90, v90
  v_rcp_f32 v91, v91
  v_mfma_f32_16x16x32_bf16 v[32:35], a[252:255], a[40:43], v[32:35]
  v_fma_f32 v80, -v80, v88, v80
  v_fma_f32 v81, -v81, v89, v81
  v_mfma_f32_16x16x32_bf16 v[32:35], v[108:111], a[52:55], v[32:35]
  v_fma_f32 v82, -v82, v90, v82
  v_fma_f32 v83, -v83, v91, v83
  v_mfma_f32_16x16x32_bf16 v[32:35], v[112:115], a[64:67], v[32:35]
  v_cvt_pk_bf16_f32 v104, v80, v81
  v_cvt_pk_bf16_f32 v105, v82, v83
  v_mfma_f32_16x16x32_bf16 v[36:39], a[240:243], a[8:11], 0
  ds_write_b64 v6, v[104:105] offset:16392
  v_mfma_f32_16x16x32_bf16 v[36:39], a[244:247], a[20:23], v[36:39]
  global_load_dwordx4 a[240:243], v1, s[22:23] offset:2048 sc1
  global_load_dwordx4 a[244:247], v1, s[22:23] offset:3072 sc1
  s_add_u32 s22, s22, 8192
  s_addc_u32 s23, s23, 0
  v_fma_f32 v92, v77, v64, v68
  v_fma_f32 v93, v77, v65, v69
  v_mfma_f32_16x16x32_bf16 v[36:39], a[248:251], a[32:35], v[36:39]
  v_fma_f32 v94, v77, v66, v70
  v_fma_f32 v95, v77, v67, v71
  v_mfma_f32_16x16x32_bf16 v[36:39], a[252:255], a[44:47], v[36:39]
  v_fma_f32 v92, v44, v73, v92
  v_fma_f32 v93, v45, v73, v93
  v_mfma_f32_16x16x32_bf16 v[36:39], v[108:111], a[56:59], v[36:39]
  v_fma_f32 v94, v46, v73, v94
  v_fma_f32 v95, v47, v73, v95
  v_mfma_f32_16x16x32_bf16 v[36:39], v[112:115], a[68:71], v[36:39]
  global_load_dwordx4 a[248:251], v1, s[22:23] offset:-4096 sc1
  global_load_dwordx4 a[252:255], v1, s[22:23] offset:-3072 sc1
  v_exp_f32 v96, v92
  v_exp_f32 v97, v93
  s_waitcnt vmcnt(14)
  v_mfma_f32_16x16x32_bf16 v[24:27], v[116:119], v[208:211], v[24:27]
  v_exp_f32 v98, v94
  v_mfma_f32_16x16x32_bf16 v[24:27], v[120:123], v[212:215], v[24:27]
  v_exp_f32 v99, v95
  v_fma_f32 v100, v96, 0.5, 1.0
  v_mfma_f32_16x16x32_bf16 v[24:27], v[124:127], v[216:219], v[24:27]
  v_fma_f32 v101, v97, 0.5, 1.0
  v_fma_f32 v102, v98, 0.5, 1.0
  v_mfma_f32_16x16x32_bf16 v[24:27], v[128:131], v[220:223], v[24:27]
  global_load_dwordx4 v[108:111], v1, s[22:23] offset:-2048 sc1
  v_fma_f32 v103, v99, 0.5, 1.0
  v_fma_f32 v100, v100, v96, 1.0
  v_mfma_f32_16x16x32_bf16 v[24:27], v[132:135], v[224:227], v[24:27]
  v_fma_f32 v101, v101, v97, 1.0
  v_fma_f32 v102, v102, v98, 1.0
  v_mfma_f32_16x16x32_bf16 v[24:27], v[136:139], v[228:231], v[24:27]
  v_fma_f32 v103, v103, v99, 1.0
  v_rcp_f32 v100, v100
  v_mfma_f32_16x16x32_bf16 v[28:31], v[116:119], a[72:75], v[28:31]
  v_rcp_f32 v101, v101
  v_mfma_f32_16x16x32_bf16 v[28:31], v[120:123], a[84:87], v[28:31]
  global_load_dwordx4 v[112:115], v1, s[22:23] offset:-1024 sc1
  v_rcp_f32 v102, v102
  v_rcp_f32 v103, v103
  v_mfma_f32_16x16x32_bf16 v[28:31], v[124:127], a[96:99], v[28:31]
  v_fma_f32 v92, -v92, v100, v92
  v_fma_f32 v93, -v93, v101, v93
  v_mfma_f32_16x16x32_bf16 v[28:31], v[128:131], a[108:111], v[28:31]
  v_fma_f32 v94, -v94, v102, v94
  v_fma_f32 v95, -v95, v103, v95
  v_mfma_f32_16x16x32_bf16 v[28:31], v[132:135], a[120:123], v[28:31]
  v_cvt_pk_bf16_f32 v106, v92, v93
  v_cvt_pk_bf16_f32 v107, v94, v95
  v_mfma_f32_16x16x32_bf16 v[28:31], v[136:139], a[132:135], v[28:31]
  ds_write_b64 v7, v[106:107] offset:16392
  v_mfma_f32_16x16x32_bf16 v[32:35], v[116:119], a[76:79], v[32:35]
  v_fma_f32 v80, v78, v64, v68
  v_fma_f32 v81, v78, v65, v69
  v_mfma_f32_16x16x32_bf16 v[32:35], v[120:123], a[88:91], v[32:35]
  v_fma_f32 v82, v78, v66, v70
  v_fma_f32 v83, v78, v67, v71
  v_mfma_f32_16x16x32_bf16 v[32:35], v[124:127], a[100:103], v[32:35]
  v_fma_f32 v80, v48, v74, v80
  v_fma_f32 v81, v49, v74, v81
  v_mfma_f32_16x16x32_bf16 v[32:35], v[128:131], a[112:115], v[32:35]
  v_fma_f32 v82, v50, v74, v82
  v_fma_f32 v83, v51, v74, v83
  v_mfma_f32_16x16x32_bf16 v[32:35], v[132:135], a[124:127], v[32:35]
  v_exp_f32 v84, v80
  v_exp_f32 v85, v81
  v_mfma_f32_16x16x32_bf16 v[32:35], v[136:139], a[136:139], v[32:35]
  v_exp_f32 v86, v82
  v_mfma_f32_16x16x32_bf16 v[36:39], v[116:119], a[80:83], v[36:39]
  v_exp_f32 v87, v83
  v_fma_f32 v88, v84, 0.5, 1.0
  v_mfma_f32_16x16x32_bf16 v[36:39], v[120:123], a[92:95], v[36:39]
  global_load_dwordx4 v[116:119], v1, s[22:23] offset:0 sc1
  global_load_dwordx4 v[120:123], v1, s[22:23] offset:1024 sc1
  v_fma_f32 v89, v85, 0.5, 1.0
  v_fma_f32 v90, v86, 0.5, 1.0
  v_mfma_f32_16x16x32_bf16 v[36:39], v[124:127], a[104:107], v[36:39]
  v_fma_f32 v91, v87, 0.5, 1.0
  v_fma_f32 v88, v88, v84, 1.0
  v_mfma_f32_16x16x32_bf16 v[36:39], v[128:131], a[116:119], v[36:39]
  v_fma_f32 v89, v89, v85, 1.0
  v_fma_f32 v90, v90, v86, 1.0
  v_mfma_f32_16x16x32_bf16 v[36:39], v[132:135], a[128:131], v[36:39]
  v_fma_f32 v91, v91, v87, 1.0
  v_rcp_f32 v88, v88
  v_mfma_f32_16x16x32_bf16 v[36:39], v[136:139], a[140:143], v[36:39]
  global_load_dwordx4 v[124:127], v1, s[22:23] offset:2048 sc1
  global_load_dwordx4 v[128:131], v1, s[22:23] offset:3072 sc1
  s_add_u32 s22, s22, 8192
  s_addc_u32 s23, s23, 0
  v_rcp_f32 v89, v89
  s_waitcnt vmcnt(14)
  v_mfma_f32_16x16x32_bf16 v[24:27], v[140:143], v[232:235], v[24:27]
  v_rcp_f32 v90, v90
  v_rcp_f32 v91, v91
  v_mfma_f32_16x16x32_bf16 v[24:27], v[144:147], v[236:239], v[24:27]
  v_fma_f32 v80, -v80, v88, v80
  v_fma_f32 v81, -v81, v89, v81
  v_mfma_f32_16x16x32_bf16 v[24:27], v[148:151], v[240:243], v[24:27]
  v_fma_f32 v82, -v82, v90, v82
  v_fma_f32 v83, -v83, v91, v83
  v_mfma_f32_16x16x32_bf16 v[24:27], v[152:155], v[244:247], v[24:27]
  global_load_dwordx4 v[132:135], v1, s[22:23] offset:-4096 sc1
  v_cvt_pk_bf16_f32 v104, v80, v81
  v_cvt_pk_bf16_f32 v105, v82, v83
  v_mfma_f32_16x16x32_bf16 v[24:27], a[216:219], v[248:251], v[24:27]
  ds_write_b64 v8, v[104:105] offset:16392
  v_mfma_f32_16x16x32_bf16 v[24:27], a[220:223], v[252:255], v[24:27]
  v_fma_f32 v92, v79, v64, v68
  v_fma_f32 v93, v79, v65, v69
  v_mfma_f32_16x16x32_bf16 v[28:31], v[140:143], a[144:147], v[28:31]
  v_fma_f32 v94, v79, v66, v70
  v_fma_f32 v95, v79, v67, v71
  v_mfma_f32_16x16x32_bf16 v[28:31], v[144:147], a[156:159], v[28:31]
  global_load_dwordx4 v[136:139], v1, s[22:23] offset:-3072 sc1
  v_fma_f32 v92, v52, v75, v92
  v_fma_f32 v93, v53, v75, v93
  v_mfma_f32_16x16x32_bf16 v[28:31], v[148:151], a[168:171], v[28:31]
  v_fma_f32 v94, v54, v75, v94
  v_fma_f32 v95, v55, v75, v95
  v_mfma_f32_16x16x32_bf16 v[28:31], v[152:155], a[180:183], v[28:31]
  v_exp_f32 v96, v92
  v_exp_f32 v97, v93
  v_mfma_f32_16x16x32_bf16 v[28:31], a[216:219], a[192:195], v[28:31]
  v_exp_f32 v98, v94
  v_mfma_f32_16x16x32_bf16 v[28:31], a[220:223], a[204:207], v[28:31]
  v_exp_f32 v99, v95
  v_fma_f32 v100, v96, 0.5, 1.0
  v_mfma_f32_16x16x32_bf16 v[32:35], v[140:143], a[148:151], v[32:35]
  v_fma_f32 v101, v97, 0.5, 1.0
  v_fma_f32 v102, v98, 0.5, 1.0
  v_mfma_f32_16x16x32_bf16 v[32:35], v[144:147], a[160:163], v[32:35]
  v_fma_f32 v103, v99, 0.5, 1.0
  v_fma_f32 v100, v100, v96, 1.0
  v_mfma_f32_16x16x32_bf16 v[32:35], v[148:151], a[172:175], v[32:35]
  v_fma_f32 v101, v101, v97, 1.0
  v_fma_f32 v102, v102, v98, 1.0
  v_mfma_f32_16x16x32_bf16 v[32:35], v[152:155], a[184:187], v[32:35]
  v_fma_f32 v103, v103, v99, 1.0
  v_rcp_f32 v100, v100
  v_mfma_f32_16x16x32_bf16 v[32:35], a[216:219], a[196:199], v[32:35]
  v_rcp_f32 v101, v101
  v_mfma_f32_16x16x32_bf16 v[32:35], a[220:223], a[208:211], v[32:35]
  v_rcp_f32 v102, v102
  v_rcp_f32 v103, v103
  v_mfma_f32_16x16x32_bf16 v[36:39], v[140:143], a[152:155], v[36:39]
  v_fma_f32 v92, -v92, v100, v92
  v_fma_f32 v93, -v93, v101, v93
  ds_read_b128 v[56:59], v14 offset:512
  ds_read_b128 v[60:63], v14 offset:576
  v_mfma_f32_16x16x32_bf16 v[36:39], v[144:147], a[164:167], v[36:39]
  global_load_dwordx4 v[140:143], v1, s[22:23] offset:-2048 sc1
  global_load_dwordx4 v[144:147], v1, s[22:23] offset:-1024 sc1
  v_fma_f32 v94, -v94, v102, v94
  v_fma_f32 v95, -v95, v103, v95
  v_mfma_f32_16x16x32_bf16 v[36:39], v[148:151], a[176:179], v[36:39]
  v_cvt_pk_bf16_f32 v106, v92, v93
  v_cvt_pk_bf16_f32 v107, v94, v95
  v_mfma_f32_16x16x32_bf16 v[36:39], v[152:155], a[188:191], v[36:39]
  ds_write_b64 v9, v[106:107] offset:16392
  v_mfma_f32_16x16x32_bf16 v[36:39], a[216:219], a[200:203], v[36:39]
  v_mfma_f32_16x16x32_bf16 v[36:39], a[220:223], a[212:215], v[36:39]
  global_load_dwordx4 v[148:151], v1, s[22:23] offset:0 sc1
  global_load_dwordx4 v[152:155], v1, s[22:23] offset:1024 sc1
  s_waitcnt vmcnt(14)
  v_mfma_f32_16x16x32_bf16 v[40:43], a[224:227], v[184:187], 0
  v_mfma_f32_16x16x32_bf16 v[40:43], a[228:231], v[188:191], v[40:43]
  v_mfma_f32_16x16x32_bf16 v[40:43], a[232:235], v[192:195], v[40:43]
  s_waitcnt lgkmcnt(1)
  v_fma_f32 v80, v76, v56, v60
  v_fma_f32 v81, v76, v57, v61
  v_mfma_f32_16x16x32_bf16 v[40:43], a[236:239], v[196:199], v[40:43]
  global_load_dwordx4 a[216:219], v1, s[22:23] offset:2048 sc1
  v_fma_f32 v82, v76, v58, v62
  v_fma_f32 v83, v76, v59, v63
  v_mfma_f32_16x16x32_bf16 v[40:43], a[240:243], v[200:203], v[40:43]
  v_fma_f32 v80, v24, v72, v80
  v_fma_f32 v81, v25, v72, v81
  v_mfma_f32_16x16x32_bf16 v[40:43], a[244:247], v[204:207], v[40:43]
  v_fma_f32 v82, v26, v72, v82
  v_fma_f32 v83, v27, v72, v83
  v_mfma_f32_16x16x32_bf16 v[44:47], a[224:227], a[0:3], 0
  v_exp_f32 v84, v80
  v_exp_f32 v85, v81
  v_mfma_f32_16x16x32_bf16 v[44:47], a[228:231], a[12:15], v[44:47]
  global_load_dwordx4 a[220:223], v1, s[22:23] offset:3072 sc1
  s_add_u32 s22, s22, 8192
  s_addc_u32 s23, s23, 0
  v_exp_f32 v86, v82
  v_mfma_f32_16x16x32_bf16 v[44:47], a[232:235], a[24:27], v[44:47]
  v_exp_f32 v87, v83
  v_fma_f32 v88, v84, 0.5, 1.0
  v_mfma_f32_16x16x32_bf16 v[44:47], a[236:239], a[36:39], v[44:47]
  v_fma_f32 v89, v85, 0.5, 1.0
  v_fma_f32 v90, v86, 0.5, 1.0
  v_mfma_f32_16x16x32_bf16 v[44:47], a[240:243], a[48:51], v[44:47]
  v_fma_f32 v91, v87, 0.5, 1.0
  v_fma_f32 v88, v88, v84, 1.0
  v_mfma_f32_16x16x32_bf16 v[44:47], a[244:247], a[60:63], v[44:47]
  v_fma_f32 v89, v89, v85, 1.0
  v_fma_f32 v90, v90, v86, 1.0
  v_mfma_f32_16x16x32_bf16 v[48:51], a[224:227], a[4:7], 0
  v_fma_f32 v91, v91, v87, 1.0
  v_rcp_f32 v88, v88
  v_mfma_f32_16x16x32_bf16 v[48:51], a[228:231], a[16:19], v[48:51]
  v_rcp_f32 v89, v89
  v_mfma_f32_16x16x32_bf16 v[48:51], a[232:235], a[28:31], v[48:51]
  v_rcp_f32 v90, v90
  v_rcp_f32 v91, v91
  v_mfma_f32_16x16x32_bf16 v[48:51], a[236:239], a[40:43], v[48:51]
  v_fma_f32 v80, -v80, v88, v80
  v_fma_f32 v81, -v81, v89, v81
  v_mfma_f32_16x16x32_bf16 v[48:51], a[240:243], a[52:55], v[48:51]
  v_fma_f32 v82, -v82, v90, v82
  v_fma_f32 v83, -v83, v91, v83
  v_mfma_f32_16x16x32_bf16 v[48:51], a[244:247], a[64:67], v[48:51]
  v_cvt_pk_bf16_f32 v104, v80, v81
  v_cvt_pk_bf16_f32 v105, v82, v83
  v_mfma_f32_16x16x32_bf16 v[52:55], a[224:227], a[8:11], 0
  ds_write_b64 v6, v[104:105] offset:32768
  v_mfma_f32_16x16x32_bf16 v[52:55], a[228:231], a[20:23], v[52:55]
  global_load_dwordx4 a[224:227], v1, s[22:23] offset:-4096 sc1
  global_load_dwordx4 a[228:231], v1, s[22:23] offset:-3072 sc1
  v_fma_f32 v92, v77, v56, v60
  v_fma_f32 v93, v77, v57, v61
  v_mfma_f32_16x16x32_bf16 v[52:55], a[232:235], a[32:35], v[52:55]
  v_fma_f32 v94, v77, v58, v62
  v_fma_f32 v95, v77, v59, v63
  v_mfma_f32_16x16x32_bf16 v[52:55], a[236:239], a[44:47], v[52:55]
  v_fma_f32 v92, v28, v73, v92
  v_fma_f32 v93, v29, v73, v93
  v_mfma_f32_16x16x32_bf16 v[52:55], a[240:243], a[56:59], v[52:55]
  v_fma_f32 v94, v30, v73, v94
  v_fma_f32 v95, v31, v73, v95
  v_mfma_f32_16x16x32_bf16 v[52:55], a[244:247], a[68:71], v[52:55]
  global_load_dwordx4 a[232:235], v1, s[22:23] offset:-2048 sc1
  global_load_dwordx4 a[236:239], v1, s[22:23] offset:-1024 sc1
  v_exp_f32 v96, v92
  v_exp_f32 v97, v93
  s_waitcnt vmcnt(14)
  v_mfma_f32_16x16x32_bf16 v[40:43], a[248:251], v[208:211], v[40:43]
  v_exp_f32 v98, v94
  v_mfma_f32_16x16x32_bf16 v[40:43], a[252:255], v[212:215], v[40:43]
  v_exp_f32 v99, v95
  v_fma_f32 v100, v96, 0.5, 1.0
  v_mfma_f32_16x16x32_bf16 v[40:43], v[108:111], v[216:219], v[40:43]
  v_fma_f32 v101, v97, 0.5, 1.0
  v_fma_f32 v102, v98, 0.5, 1.0
  v_mfma_f32_16x16x32_bf16 v[40:43], v[112:115], v[220:223], v[40:43]
  global_load_dwordx4 a[240:243], v1, s[22:23] offset:0 sc1
  v_fma_f32 v103, v99, 0.5, 1.0
  v_fma_f32 v100, v100, v96, 1.0
  v_mfma_f32_16x16x32_bf16 v[40:43], v[116:119], v[224:227], v[40:43]
  v_fma_f32 v101, v101, v97, 1.0
  v_fma_f32 v102, v102, v98, 1.0
  v_mfma_f32_16x16x32_bf16 v[40:43], v[120:123], v[228:231], v[40:43]
  v_fma_f32 v103, v103, v99, 1.0
  v_rcp_f32 v100, v100
  v_mfma_f32_16x16x32_bf16 v[44:47], a[248:251], a[72:75], v[44:47]
  v_rcp_f32 v101, v101
  v_mfma_f32_16x16x32_bf16 v[44:47], a[252:255], a[84:87], v[44:47]
  global_load_dwordx4 a[244:247], v1, s[22:23] offset:1024 sc1
  v_rcp_f32 v102, v102
  v_rcp_f32 v103, v103
  v_mfma_f32_16x16x32_bf16 v[44:47], v[108:111], a[96:99], v[44:47]
  v_fma_f32 v92, -v92, v100, v92
  v_fma_f32 v93, -v93, v101, v93
  v_mfma_f32_16x16x32_bf16 v[44:47], v[112:115], a[108:111], v[44:47]
  v_fma_f32 v94, -v94, v102, v94
  v_fma_f32 v95, -v95, v103, v95
  v_mfma_f32_16x16x32_bf16 v[44:47], v[116:119], a[120:123], v[44:47]
  v_cvt_pk_bf16_f32 v106, v92, v93
  v_cvt_pk_bf16_f32 v107, v94, v95
  v_mfma_f32_16x16x32_bf16 v[44:47], v[120:123], a[132:135], v[44:47]
  ds_write_b64 v7, v[106:107] offset:32768
  v_mfma_f32_16x16x32_bf16 v[48:51], a[248:251], a[76:79], v[48:51]
  v_fma_f32 v80, v78, v56, v60
  v_fma_f32 v81, v78, v57, v61
  v_mfma_f32_16x16x32_bf16 v[48:51], a[252:255], a[88:91], v[48:51]
  v_fma_f32 v82, v78, v58, v62
  v_fma_f32 v83, v78, v59, v63
  v_mfma_f32_16x16x32_bf16 v[48:51], v[108:111], a[100:103], v[48:51]
  v_fma_f32 v80, v32, v74, v80
  v_fma_f32 v81, v33, v74, v81
  v_mfma_f32_16x16x32_bf16 v[48:51], v[112:115], a[112:115], v[48:51]
  v_fma_f32 v82, v34, v74, v82
  v_fma_f32 v83, v35, v74, v83
  v_mfma_f32_16x16x32_bf16 v[48:51], v[116:119], a[124:127], v[48:51]
  v_exp_f32 v84, v80
  v_exp_f32 v85, v81
  v_mfma_f32_16x16x32_bf16 v[48:51], v[120:123], a[136:139], v[48:51]
  v_exp_f32 v86, v82
  v_mfma_f32_16x16x32_bf16 v[52:55], a[248:251], a[80:83], v[52:55]
  v_exp_f32 v87, v83
  v_fma_f32 v88, v84, 0.5, 1.0
  v_mfma_f32_16x16x32_bf16 v[52:55], a[252:255], a[92:95], v[52:55]
  global_load_dwordx4 a[248:251], v1, s[22:23] offset:2048 sc1
  global_load_dwordx4 a[252:255], v1, s[22:23] offset:3072 sc1
  s_add_u32 s22, s22, 8192
  s_addc_u32 s23, s23, 0
  v_fma_f32 v89, v85, 0.5, 1.0
  v_fma_f32 v90, v86, 0.5, 1.0
  v_mfma_f32_16x16x32_bf16 v[52:55], v[108:111], a[104:107], v[52:55]
  v_fma_f32 v91, v87, 0.5, 1.0
  v_fma_f32 v88, v88, v84, 1.0
  v_mfma_f32_16x16x32_bf16 v[52:55], v[112:115], a[116:119], v[52:55]
  v_fma_f32 v89, v89, v85, 1.0
  v_fma_f32 v90, v90, v86, 1.0
  v_mfma_f32_16x16x32_bf16 v[52:55], v[116:119], a[128:131], v[52:55]
  v_fma_f32 v91, v91, v87, 1.0
  v_rcp_f32 v88, v88
  v_mfma_f32_16x16x32_bf16 v[52:55], v[120:123], a[140:143], v[52:55]
  global_load_dwordx4 v[108:111], v1, s[22:23] offset:-4096 sc1
  global_load_dwordx4 v[112:115], v1, s[22:23] offset:-3072 sc1
  v_rcp_f32 v89, v89
  s_waitcnt vmcnt(14)
  v_mfma_f32_16x16x32_bf16 v[40:43], v[124:127], v[232:235], v[40:43]
  v_rcp_f32 v90, v90
  v_rcp_f32 v91, v91
  v_mfma_f32_16x16x32_bf16 v[40:43], v[128:131], v[236:239], v[40:43]
  v_fma_f32 v80, -v80, v88, v80
  v_fma_f32 v81, -v81, v89, v81
  v_mfma_f32_16x16x32_bf16 v[40:43], v[132:135], v[240:243], v[40:43]
  v_fma_f32 v82, -v82, v90, v82
  v_fma_f32 v83, -v83, v91, v83
  v_mfma_f32_16x16x32_bf16 v[40:43], v[136:139], v[244:247], v[40:43]
  global_load_dwordx4 v[116:119], v1, s[22:23] offset:-2048 sc1
  v_cvt_pk_bf16_f32 v104, v80, v81
  v_cvt_pk_bf16_f32 v105, v82, v83
  v_mfma_f32_16x16x32_bf16 v[40:43], v[140:143], v[248:251], v[40:43]
  ds_write_b64 v8, v[104:105] offset:32768
  v_mfma_f32_16x16x32_bf16 v[40:43], v[144:147], v[252:255], v[40:43]
  v_fma_f32 v92, v79, v56, v60
  v_fma_f32 v93, v79, v57, v61
  v_mfma_f32_16x16x32_bf16 v[44:47], v[124:127], a[144:147], v[44:47]
  v_fma_f32 v94, v79, v58, v62
  v_fma_f32 v95, v79, v59, v63
  v_mfma_f32_16x16x32_bf16 v[44:47], v[128:131], a[156:159], v[44:47]
  global_load_dwordx4 v[120:123], v1, s[22:23] offset:-1024 sc1
  v_fma_f32 v92, v36, v75, v92
  v_fma_f32 v93, v37, v75, v93
  v_mfma_f32_16x16x32_bf16 v[44:47], v[132:135], a[168:171], v[44:47]
  v_fma_f32 v94, v38, v75, v94
  v_fma_f32 v95, v39, v75, v95
  v_mfma_f32_16x16x32_bf16 v[44:47], v[136:139], a[180:183], v[44:47]
  v_exp_f32 v96, v92
  v_exp_f32 v97, v93
  v_mfma_f32_16x16x32_bf16 v[44:47], v[140:143], a[192:195], v[44:47]
  v_exp_f32 v98, v94
  v_mfma_f32_16x16x32_bf16 v[44:47], v[144:147], a[204:207], v[44:47]
  v_exp_f32 v99, v95
  v_fma_f32 v100, v96, 0.5, 1.0
  v_mfma_f32_16x16x32_bf16 v[48:51], v[124:127], a[148:151], v[48:51]
  v_fma_f32 v101, v97, 0.5, 1.0
  v_fma_f32 v102, v98, 0.5, 1.0
  v_mfma_f32_16x16x32_bf16 v[48:51], v[128:131], a[160:163], v[48:51]
  v_fma_f32 v103, v99, 0.5, 1.0
  v_fma_f32 v100, v100, v96, 1.0
  v_mfma_f32_16x16x32_bf16 v[48:51], v[132:135], a[172:175], v[48:51]
  v_fma_f32 v101, v101, v97, 1.0
  v_fma_f32 v102, v102, v98, 1.0
  v_mfma_f32_16x16x32_bf16 v[48:51], v[136:139], a[184:187], v[48:51]
  v_fma_f32 v103, v103, v99, 1.0
  v_rcp_f32 v100, v100
  v_mfma_f32_16x16x32_bf16 v[48:51], v[140:143], a[196:199], v[48:51]
  v_rcp_f32 v101, v101
  v_mfma_f32_16x16x32_bf16 v[48:51], v[144:147], a[208:211], v[48:51]
  v_rcp_f32 v102, v102
  v_rcp_f32 v103, v103
  v_mfma_f32_16x16x32_bf16 v[52:55], v[124:127], a[152:155], v[52:55]
  v_fma_f32 v92, -v92, v100, v92
  v_fma_f32 v93, -v93, v101, v93
  ds_read_b128 v[64:67], v14 offset:640
  ds_read_b128 v[68:71], v14 offset:704
  v_mfma_f32_16x16x32_bf16 v[52:55], v[128:131], a[164:167], v[52:55]
  global_load_dwordx4 v[124:127], v1, s[22:23] offset:0 sc1
  global_load_dwordx4 v[128:131], v1, s[22:23] offset:1024 sc1
  v_fma_f32 v94, -v94, v102, v94
  v_fma_f32 v95, -v95, v103, v95
  v_mfma_f32_16x16x32_bf16 v[52:55], v[132:135], a[176:179], v[52:55]
  v_cvt_pk_bf16_f32 v106, v92, v93
  v_cvt_pk_bf16_f32 v107, v94, v95
  v_mfma_f32_16x16x32_bf16 v[52:55], v[136:139], a[188:191], v[52:55]
  ds_write_b64 v9, v[106:107] offset:32768
  v_mfma_f32_16x16x32_bf16 v[52:55], v[140:143], a[200:203], v[52:55]
  v_mfma_f32_16x16x32_bf16 v[52:55], v[144:147], a[212:215], v[52:55]
  global_load_dwordx4 v[132:135], v1, s[22:23] offset:2048 sc1
  global_load_dwordx4 v[136:139], v1, s[22:23] offset:3072 sc1
  s_add_u32 s22, s22, 8192
  s_addc_u32 s23, s23, 0
  s_waitcnt vmcnt(14)
  v_mfma_f32_16x16x32_bf16 v[24:27], v[148:151], v[184:187], 0
  v_mfma_f32_16x16x32_bf16 v[24:27], v[152:155], v[188:191], v[24:27]
  v_mfma_f32_16x16x32_bf16 v[24:27], a[216:219], v[192:195], v[24:27]
  s_waitcnt lgkmcnt(1)
  v_fma_f32 v80, v76, v64, v68
  v_fma_f32 v81, v76, v65, v69
  v_mfma_f32_16x16x32_bf16 v[24:27], a[220:223], v[196:199], v[24:27]
  global_load_dwordx4 v[140:143], v1, s[22:23] offset:-4096 sc1
  v_fma_f32 v82, v76, v66, v70
  v_fma_f32 v83, v76, v67, v71
  v_mfma_f32_16x16x32_bf16 v[24:27], a[224:227], v[200:203], v[24:27]
  v_fma_f32 v80, v40, v72, v80
  v_fma_f32 v81, v41, v72, v81
  s_lshl_b32 s61, s66, 7
  s_add_u32 s61, s61, 61440
  buffer_load_dword v21, v170, s[52:55], s61 offen sc1
  v_mfma_f32_16x16x32_bf16 v[24:27], a[228:231], v[204:207], v[24:27]
  v_fma_f32 v82, v42, v72, v82
  v_fma_f32 v83, v43, v72, v83
  v_mfma_f32_16x16x32_bf16 v[28:31], v[148:151], a[0:3], 0
  v_exp_f32 v84, v80
  v_exp_f32 v85, v81
  v_mfma_f32_16x16x32_bf16 v[28:31], v[152:155], a[12:15], v[28:31]
  global_load_dwordx4 v[144:147], v1, s[22:23] offset:-3072 sc1
  v_exp_f32 v86, v82
  v_mfma_f32_16x16x32_bf16 v[28:31], a[216:219], a[24:27], v[28:31]
  v_exp_f32 v87, v83
  v_fma_f32 v88, v84, 0.5, 1.0
  v_mfma_f32_16x16x32_bf16 v[28:31], a[220:223], a[36:39], v[28:31]
  v_fma_f32 v89, v85, 0.5, 1.0
  v_fma_f32 v90, v86, 0.5, 1.0
  v_mfma_f32_16x16x32_bf16 v[28:31], a[224:227], a[48:51], v[28:31]
  v_fma_f32 v91, v87, 0.5, 1.0
  v_fma_f32 v88, v88, v84, 1.0
  v_mfma_f32_16x16x32_bf16 v[28:31], a[228:231], a[60:63], v[28:31]
  v_fma_f32 v89, v89, v85, 1.0
  v_fma_f32 v90, v90, v86, 1.0
  v_mfma_f32_16x16x32_bf16 v[32:35], v[148:151], a[4:7], 0
  v_fma_f32 v91, v91, v87, 1.0
  v_rcp_f32 v88, v88
  v_mfma_f32_16x16x32_bf16 v[32:35], v[152:155], a[16:19], v[32:35]
  v_rcp_f32 v89, v89
  v_mfma_f32_16x16x32_bf16 v[32:35], a[216:219], a[28:31], v[32:35]
  v_rcp_f32 v90, v90
  v_rcp_f32 v91, v91
  v_mfma_f32_16x16x32_bf16 v[32:35], a[220:223], a[40:43], v[32:35]
  v_fma_f32 v80, -v80, v88, v80
  v_fma_f32 v81, -v81, v89, v81
  v_mfma_f32_16x16x32_bf16 v[32:35], a[224:227], a[52:55], v[32:35]
  v_fma_f32 v82, -v82, v90, v82
  v_fma_f32 v83, -v83, v91, v83
  v_mfma_f32_16x16x32_bf16 v[32:35], a[228:231], a[64:67], v[32:35]
  v_cvt_pk_bf16_f32 v104, v80, v81
  v_cvt_pk_bf16_f32 v105, v82, v83
  v_mfma_f32_16x16x32_bf16 v[36:39], v[148:151], a[8:11], 0
  ds_write_b64 v6, v[104:105] offset:32776
  v_mfma_f32_16x16x32_bf16 v[36:39], v[152:155], a[20:23], v[36:39]
  global_load_dwordx4 v[148:151], v1, s[22:23] offset:-2048 sc1
  global_load_dwordx4 v[152:155], v1, s[22:23] offset:-1024 sc1
  v_fma_f32 v92, v77, v64, v68
  v_fma_f32 v93, v77, v65, v69
  v_mfma_f32_16x16x32_bf16 v[36:39], a[216:219], a[32:35], v[36:39]
  v_fma_f32 v94, v77, v66, v70
  v_fma_f32 v95, v77, v67, v71
  v_mfma_f32_16x16x32_bf16 v[36:39], a[220:223], a[44:47], v[36:39]
  v_fma_f32 v92, v44, v73, v92
  v_fma_f32 v93, v45, v73, v93
  v_mfma_f32_16x16x32_bf16 v[36:39], a[224:227], a[56:59], v[36:39]
  v_fma_f32 v94, v46, v73, v94
  v_fma_f32 v95, v47, v73, v95
  v_mfma_f32_16x16x32_bf16 v[36:39], a[228:231], a[68:71], v[36:39]
  global_load_dwordx4 a[216:219], v1, s[22:23] offset:0 sc1
  global_load_dwordx4 a[220:223], v1, s[22:23] offset:1024 sc1
  v_exp_f32 v96, v92
  v_exp_f32 v97, v93
  s_waitcnt vmcnt(15)
  v_mfma_f32_16x16x32_bf16 v[24:27], a[232:235], v[208:211], v[24:27]
  v_exp_f32 v98, v94
  v_mfma_f32_16x16x32_bf16 v[24:27], a[236:239], v[212:215], v[24:27]
  v_exp_f32 v99, v95
  v_fma_f32 v100, v96, 0.5, 1.0
  v_mfma_f32_16x16x32_bf16 v[24:27], a[240:243], v[216:219], v[24:27]
  v_fma_f32 v101, v97, 0.5, 1.0
  v_fma_f32 v102, v98, 0.5, 1.0
  v_mfma_f32_16x16x32_bf16 v[24:27], a[244:247], v[220:223], v[24:27]
  global_load_dwordx4 a[224:227], v1, s[22:23] offset:2048 sc1
  v_fma_f32 v103, v99, 0.5, 1.0
  v_fma_f32 v100, v100, v96, 1.0
  v_mfma_f32_16x16x32_bf16 v[24:27], a[248:251], v[224:227], v[24:27]
  v_fma_f32 v101, v101, v97, 1.0
  v_fma_f32 v102, v102, v98, 1.0
  v_mfma_f32_16x16x32_bf16 v[24:27], a[252:255], v[228:231], v[24:27]
  v_fma_f32 v103, v103, v99, 1.0
  v_rcp_f32 v100, v100
  v_mfma_f32_16x16x32_bf16 v[28:31], a[232:235], a[72:75], v[28:31]
  v_rcp_f32 v101, v101
  v_mfma_f32_16x16x32_bf16 v[28:31], a[236:239], a[84:87], v[28:31]
  global_load_dwordx4 a[228:231], v1, s[22:23] offset:3072 sc1
  s_add_u32 s22, s22, 8192
  s_addc_u32 s23, s23, 0
  v_rcp_f32 v102, v102
  v_rcp_f32 v103, v103
  v_mfma_f32_16x16x32_bf16 v[28:31], a[240:243], a[96:99], v[28:31]
  v_fma_f32 v92, -v92, v100, v92
  v_fma_f32 v93, -v93, v101, v93
  v_mfma_f32_16x16x32_bf16 v[28:31], a[244:247], a[108:111], v[28:31]
  v_fma_f32 v94, -v94, v102, v94
  v_fma_f32 v95, -v95, v103, v95
  v_mfma_f32_16x16x32_bf16 v[28:31], a[248:251], a[120:123], v[28:31]
  v_cvt_pk_bf16_f32 v106, v92, v93
  v_cvt_pk_bf16_f32 v107, v94, v95
  v_mfma_f32_16x16x32_bf16 v[28:31], a[252:255], a[132:135], v[28:31]
  ds_write_b64 v7, v[106:107] offset:32776
  v_mfma_f32_16x16x32_bf16 v[32:35], a[232:235], a[76:79], v[32:35]
  v_fma_f32 v80, v78, v64, v68
  v_fma_f32 v81, v78, v65, v69
  v_mfma_f32_16x16x32_bf16 v[32:35], a[236:239], a[88:91], v[32:35]
  v_fma_f32 v82, v78, v66, v70
  v_fma_f32 v83, v78, v67, v71
  v_mfma_f32_16x16x32_bf16 v[32:35], a[240:243], a[100:103], v[32:35]
  v_fma_f32 v80, v48, v74, v80
  v_fma_f32 v81, v49, v74, v81
  v_mfma_f32_16x16x32_bf16 v[32:35], a[244:247], a[112:115], v[32:35]
  v_fma_f32 v82, v50, v74, v82
  v_fma_f32 v83, v51, v74, v83
  v_mfma_f32_16x16x32_bf16 v[32:35], a[248:251], a[124:127], v[32:35]
  v_exp_f32 v84, v80
  v_exp_f32 v85, v81
  v_mfma_f32_16x16x32_bf16 v[32:35], a[252:255], a[136:139], v[32:35]
  v_exp_f32 v86, v82
  v_mfma_f32_16x16x32_bf16 v[36:39], a[232:235], a[80:83], v[36:39]
  v_exp_f32 v87, v83
  v_fma_f32 v88, v84, 0.5, 1.0
  v_mfma_f32_16x16x32_bf16 v[36:39], a[236:239], a[92:95], v[36:39]
  global_load_dwordx4 a[232:235], v1, s[22:23] offset:-4096 sc1
  global_load_dwordx4 a[236:239], v1, s[22:23] offset:-3072 sc1
  v_fma_f32 v89, v85, 0.5, 1.0
  v_fma_f32 v90, v86, 0.5, 1.0
  v_mfma_f32_16x16x32_bf16 v[36:39], a[240:243], a[104:107], v[36:39]
  v_fma_f32 v91, v87, 0.5, 1.0
  v_fma_f32 v88, v88, v84, 1.0
  v_mfma_f32_16x16x32_bf16 v[36:39], a[244:247], a[116:119], v[36:39]
  v_fma_f32 v89, v89, v85, 1.0
  v_fma_f32 v90, v90, v86, 1.0
  v_mfma_f32_16x16x32_bf16 v[36:39], a[248:251], a[128:131], v[36:39]
  v_fma_f32 v91, v91, v87, 1.0
  v_rcp_f32 v88, v88
  v_mfma_f32_16x16x32_bf16 v[36:39], a[252:255], a[140:143], v[36:39]
  global_load_dwordx4 a[240:243], v1, s[22:23] offset:-2048 sc1
  global_load_dwordx4 a[244:247], v1, s[22:23] offset:-1024 sc1
  v_rcp_f32 v89, v89
  s_waitcnt vmcnt(15)
  v_mfma_f32_16x16x32_bf16 v[24:27], v[108:111], v[232:235], v[24:27]
  v_rcp_f32 v90, v90
  v_rcp_f32 v91, v91
  v_mfma_f32_16x16x32_bf16 v[24:27], v[112:115], v[236:239], v[24:27]
  v_fma_f32 v80, -v80, v88, v80
  v_fma_f32 v81, -v81, v89, v81
  v_mfma_f32_16x16x32_bf16 v[24:27], v[116:119], v[240:243], v[24:27]
  v_fma_f32 v82, -v82, v90, v82
  v_fma_f32 v83, -v83, v91, v83
  v_mfma_f32_16x16x32_bf16 v[24:27], v[120:123], v[244:247], v[24:27]
  global_load_dwordx4 a[248:251], v1, s[22:23] offset:0 sc1
  v_cvt_pk_bf16_f32 v104, v80, v81
  v_cvt_pk_bf16_f32 v105, v82, v83
  v_mfma_f32_16x16x32_bf16 v[24:27], v[124:127], v[248:251], v[24:27]
  ds_write_b64 v8, v[104:105] offset:32776
  v_mfma_f32_16x16x32_bf16 v[24:27], v[128:131], v[252:255], v[24:27]
  v_fma_f32 v92, v79, v64, v68
  v_fma_f32 v93, v79, v65, v69
  v_mfma_f32_16x16x32_bf16 v[28:31], v[108:111], a[144:147], v[28:31]
  v_fma_f32 v94, v79, v66, v70
  v_fma_f32 v95, v79, v67, v71
  v_mfma_f32_16x16x32_bf16 v[28:31], v[112:115], a[156:159], v[28:31]
  global_load_dwordx4 a[252:255], v1, s[22:23] offset:1024 sc1
  v_fma_f32 v92, v52, v75, v92
  v_fma_f32 v93, v53, v75, v93
  v_mfma_f32_16x16x32_bf16 v[28:31], v[116:119], a[168:171], v[28:31]
  v_fma_f32 v94, v54, v75, v94
  v_fma_f32 v95, v55, v75, v95
  v_mfma_f32_16x16x32_bf16 v[28:31], v[120:123], a[180:183], v[28:31]
  v_exp_f32 v96, v92
  v_exp_f32 v97, v93
  v_mfma_f32_16x16x32_bf16 v[28:31], v[124:127], a[192:195], v[28:31]
  v_exp_f32 v98, v94
  v_mfma_f32_16x16x32_bf16 v[28:31], v[128:131], a[204:207], v[28:31]
  v_exp_f32 v99, v95
  v_fma_f32 v100, v96, 0.5, 1.0
  v_mfma_f32_16x16x32_bf16 v[32:35], v[108:111], a[148:151], v[32:35]
  v_fma_f32 v101, v97, 0.5, 1.0
  v_fma_f32 v102, v98, 0.5, 1.0
  v_mfma_f32_16x16x32_bf16 v[32:35], v[112:115], a[160:163], v[32:35]
  v_fma_f32 v103, v99, 0.5, 1.0
  v_fma_f32 v100, v100, v96, 1.0
  v_mfma_f32_16x16x32_bf16 v[32:35], v[116:119], a[172:175], v[32:35]
  v_fma_f32 v101, v101, v97, 1.0
  v_fma_f32 v102, v102, v98, 1.0
  v_mfma_f32_16x16x32_bf16 v[32:35], v[120:123], a[184:187], v[32:35]
  v_fma_f32 v103, v103, v99, 1.0
  v_rcp_f32 v100, v100
  v_mfma_f32_16x16x32_bf16 v[32:35], v[124:127], a[196:199], v[32:35]
  v_rcp_f32 v101, v101
  v_mfma_f32_16x16x32_bf16 v[32:35], v[128:131], a[208:211], v[32:35]
  v_rcp_f32 v102, v102
  v_rcp_f32 v103, v103
  v_mfma_f32_16x16x32_bf16 v[36:39], v[108:111], a[152:155], v[36:39]
  v_fma_f32 v92, -v92, v100, v92
  v_fma_f32 v93, -v93, v101, v93
  ds_read_b128 v[56:59], v14 offset:768
  ds_read_b128 v[60:63], v14 offset:832
  v_mfma_f32_16x16x32_bf16 v[36:39], v[112:115], a[164:167], v[36:39]
  global_load_dwordx4 v[108:111], v1, s[22:23] offset:2048 sc1
  global_load_dwordx4 v[112:115], v1, s[22:23] offset:3072 sc1
  s_add_u32 s22, s22, 8192
  s_addc_u32 s23, s23, 0
  v_fma_f32 v94, -v94, v102, v94
  v_fma_f32 v95, -v95, v103, v95
  v_mfma_f32_16x16x32_bf16 v[36:39], v[116:119], a[176:179], v[36:39]
  v_cvt_pk_bf16_f32 v106, v92, v93
  v_cvt_pk_bf16_f32 v107, v94, v95
  v_mfma_f32_16x16x32_bf16 v[36:39], v[120:123], a[188:191], v[36:39]
  ds_write_b64 v9, v[106:107] offset:32776
  v_mfma_f32_16x16x32_bf16 v[36:39], v[124:127], a[200:203], v[36:39]
  v_mfma_f32_16x16x32_bf16 v[36:39], v[128:131], a[212:215], v[36:39]
  global_load_dwordx4 v[116:119], v1, s[22:23] offset:-4096 sc1
  global_load_dwordx4 v[120:123], v1, s[22:23] offset:-3072 sc1
  s_waitcnt vmcnt(14)
  v_mfma_f32_16x16x32_bf16 v[40:43], v[132:135], v[184:187], 0
  v_mfma_f32_16x16x32_bf16 v[40:43], v[136:139], v[188:191], v[40:43]
  v_cmp_ne_u32 vcc, s6, v21
  s_nop 3
  s_cbranch_vccz L31_ok
  s_mov_b32 s7, 262144
L32_poll:
  buffer_load_dword v21, v170, s[52:55], s61 offen sc1
  s_waitcnt vmcnt(0)
  v_cmp_ne_u32 vcc, s6, v21
  s_sub_u32 s7, s7, 1
  s_cmp_eq_u32 s7, 0
  s_cbranch_scc1 L33_pollx
  s_nop 0
  s_cbranch_vccnz L32_poll
L33_pollx:
L31_ok:
  v_mfma_f32_16x16x32_bf16 v[40:43], v[140:143], v[192:195], v[40:43]
  s_waitcnt lgkmcnt(1)
  v_fma_f32 v80, v76, v56, v60
  v_fma_f32 v81, v76, v57, v61
  v_mfma_f32_16x16x32_bf16 v[40:43], v[144:147], v[196:199], v[40:43]
  global_load_dwordx4 v[124:127], v1, s[22:23] offset:-2048 sc1
  v_fma_f32 v82, v76, v58, v62
  v_fma_f32 v83, v76, v59, v63
  v_mfma_f32_16x16x32_bf16 v[40:43], v[148:151], v[200:203], v[40:43]
  v_fma_f32 v80, v24, v72, v80
  v_fma_f32 v81, v25, v72, v81
  v_mfma_f32_16x16x32_bf16 v[40:43], v[152:155], v[204:207], v[40:43]
  v_fma_f32 v82, v26, v72, v82
  v_fma_f32 v83, v27, v72, v83
  v_mfma_f32_16x16x32_bf16 v[44:47], v[132:135], a[0:3], 0
  v_exp_f32 v84, v80
  v_exp_f32 v85, v81
  v_mfma_f32_16x16x32_bf16 v[44:47], v[136:139], a[12:15], v[44:47]
  global_load_dwordx4 v[128:131], v1, s[22:23] offset:-1024 sc1
  v_exp_f32 v86, v82
  v_mfma_f32_16x16x32_bf16 v[44:47], v[140:143], a[24:27], v[44:47]
  v_exp_f32 v87, v83
  v_fma_f32 v88, v84, 0.5, 1.0
  v_mfma_f32_16x16x32_bf16 v[44:47], v[144:147], a[36:39], v[44:47]
  v_fma_f32 v89, v85, 0.5, 1.0
  v_fma_f32 v90, v86, 0.5, 1.0
  v_mfma_f32_16x16x32_bf16 v[44:47], v[148:151], a[48:51], v[44:47]
  v_fma_f32 v91, v87, 0.5, 1.0
  v_fma_f32 v88, v88, v84, 1.0
  v_mfma_f32_16x16x32_bf16 v[44:47], v[152:155], a[60:63], v[44:47]
  v_fma_f32 v89, v89, v85, 1.0
  v_fma_f32 v90, v90, v86, 1.0
  v_mfma_f32_16x16x32_bf16 v[48:51], v[132:135], a[4:7], 0
  v_fma_f32 v91, v91, v87, 1.0
  v_rcp_f32 v88, v88
  v_mfma_f32_16x16x32_bf16 v[48:51], v[136:139], a[16:19], v[48:51]
  v_rcp_f32 v89, v89
  v_mfma_f32_16x16x32_bf16 v[48:51], v[140:143], a[28:31], v[48:51]
  v_rcp_f32 v90, v90
  v_rcp_f32 v91, v91
  v_mfma_f32_16x16x32_bf16 v[48:51], v[144:147], a[40:43], v[48:51]
  v_fma_f32 v80, -v80, v88, v80
  v_fma_f32 v81, -v81, v89, v81
  v_mfma_f32_16x16x32_bf16 v[48:51], v[148:151], a[52:55], v[48:51]
  v_fma_f32 v82, -v82, v90, v82
  v_fma_f32 v83, -v83, v91, v83
  v_mfma_f32_16x16x32_bf16 v[48:51], v[152:155], a[64:67], v[48:51]
  v_cvt_pk_bf16_f32 v104, v80, v81
  v_cvt_pk_bf16_f32 v105, v82, v83
  v_mfma_f32_16x16x32_bf16 v[52:55], v[132:135], a[8:11], 0
  ds_write_b64 v6, v[104:105] offset:49152
  v_mfma_f32_16x16x32_bf16 v[52:55], v[136:139], a[20:23], v[52:55]
  global_load_dwordx4 v[132:135], v1, s[22:23] offset:0 sc1
  global_load_dwordx4 v[136:139], v1, s[22:23] offset:1024 sc1
  v_fma_f32 v92, v77, v56, v60
  v_fma_f32 v93, v77, v57, v61
  v_mfma_f32_16x16x32_bf16 v[52:55], v[140:143], a[32:35], v[52:55]
  v_fma_f32 v94, v77, v58, v62
  v_fma_f32 v95, v77, v59, v63
  v_mfma_f32_16x16x32_bf16 v[52:55], v[144:147], a[44:47], v[52:55]
  v_fma_f32 v92, v28, v73, v92
  v_fma_f32 v93, v29, v73, v93
  v_mfma_f32_16x16x32_bf16 v[52:55], v[148:151], a[56:59], v[52:55]
  v_fma_f32 v94, v30, v73, v94
  v_fma_f32 v95, v31, v73, v95
  v_mfma_f32_16x16x32_bf16 v[52:55], v[152:155], a[68:71], v[52:55]
  global_load_dwordx4 v[140:143], v1, s[22:23] offset:2048 sc1
  global_load_dwordx4 v[144:147], v1, s[22:23] offset:3072 sc1
  s_add_u32 s22, s22, 8192
  s_addc_u32 s23, s23, 0
  v_exp_f32 v96, v92
  v_exp_f32 v97, v93
  s_waitcnt vmcnt(14)
  v_mfma_f32_16x16x32_bf16 v[40:43], a[216:219], v[208:211], v[40:43]
  v_exp_f32 v98, v94
  v_mfma_f32_16x16x32_bf16 v[40:43], a[220:223], v[212:215], v[40:43]
  v_exp_f32 v99, v95
  v_fma_f32 v100, v96, 0.5, 1.0
  v_mfma_f32_16x16x32_bf16 v[40:43], a[224:227], v[216:219], v[40:43]
  v_fma_f32 v101, v97, 0.5, 1.0
  v_fma_f32 v102, v98, 0.5, 1.0
  v_mfma_f32_16x16x32_bf16 v[40:43], a[228:231], v[220:223], v[40:43]
  global_load_dwordx4 v[148:151], v1, s[22:23] offset:-4096 sc1
  v_fma_f32 v103, v99, 0.5, 1.0
  v_fma_f32 v100, v100, v96, 1.0
  v_mfma_f32_16x16x32_bf16 v[40:43], a[232:235], v[224:227], v[40:43]
  v_fma_f32 v101, v101, v97, 1.0
  v_fma_f32 v102, v102, v98, 1.0
  v_mfma_f32_16x16x32_bf16 v[40:43], a[236:239], v[228:231], v[40:43]
  v_fma_f32 v103, v103, v99, 1.0
  v_rcp_f32 v100, v100
  v_mfma_f32_16x16x32_bf16 v[44:47], a[216:219], a[72:75], v[44:47]
  v_rcp_f32 v101, v101
  v_mfma_f32_16x16x32_bf16 v[44:47], a[220:223], a[84:87], v[44:47]
  global_load_dwordx4 v[152:155], v1, s[22:23] offset:-3072 sc1
  v_rcp_f32 v102, v102
  v_rcp_f32 v103, v103
  v_mfma_f32_16x16x32_bf16 v[44:47], a[224:227], a[96:99], v[44:47]
  v_fma_f32 v92, -v92, v100, v92
  v_fma_f32 v93, -v93, v101, v93
  v_mfma_f32_16x16x32_bf16 v[44:47], a[228:231], a[108:111], v[44:47]
  v_fma_f32 v94, -v94, v102, v94
  v_fma_f32 v95, -v95, v103, v95
  v_mfma_f32_16x16x32_bf16 v[44:47], a[232:235], a[120:123], v[44:47]
  v_cvt_pk_bf16_f32 v106, v92, v93
  v_cvt_pk_bf16_f32 v107, v94, v95
  v_mfma_f32_16x16x32_bf16 v[44:47], a[236:239], a[132:135], v[44:47]
  ds_write_b64 v7, v[106:107] offset:49152
  v_mfma_f32_16x16x32_bf16 v[48:51], a[216:219], a[76:79], v[48:51]
  v_fma_f32 v80, v78, v56, v60
  v_fma_f32 v81, v78, v57, v61
  v_mfma_f32_16x16x32_bf16 v[48:51], a[220:223], a[88:91], v[48:51]
  v_fma_f32 v82, v78, v58, v62
  v_fma_f32 v83, v78, v59, v63
  v_mfma_f32_16x16x32_bf16 v[48:51], a[224:227], a[100:103], v[48:51]
  v_fma_f32 v80, v32, v74, v80
  v_fma_f32 v81, v33, v74, v81
  v_mfma_f32_16x16x32_bf16 v[48:51], a[228:231], a[112:115], v[48:51]
  v_fma_f32 v82, v34, v74, v82
  v_fma_f32 v83, v35, v74, v83
  v_mfma_f32_16x16x32_bf16 v[48:51], a[232:235], a[124:127], v[48:51]
  v_exp_f32 v84, v80
  v_exp_f32 v85, v81
  v_mfma_f32_16x16x32_bf16 v[48:51], a[236:239], a[136:139], v[48:51]
  v_exp_f32 v86, v82
  v_mfma_f32_16x16x32_bf16 v[52:55], a[216:219], a[80:83], v[52:55]
  v_exp_f32 v87, v83
  v_fma_f32 v88, v84, 0.5, 1.0
  v_mfma_f32_16x16x32_bf16 v[52:55], a[220:223], a[92:95], v[52:55]
  global_load_dwordx4 a[216:219], v1, s[22:23] offset:-2048 sc1
  global_load_dwordx4 a[220:223], v1, s[22:23] offset:-1024 sc1
  v_fma_f32 v89, v85, 0.5, 1.0
  v_fma_f32 v90, v86, 0.5, 1.0
  v_mfma_f32_16x16x32_bf16 v[52:55], a[224:227], a[104:107], v[52:55]
  v_fma_f32 v91, v87, 0.5, 1.0
  v_fma_f32 v88, v88, v84, 1.0
  v_mfma_f32_16x16x32_bf16 v[52:55], a[228:231], a[116:119], v[52:55]
  v_fma_f32 v89, v89, v85, 1.0
  v_fma_f32 v90, v90, v86, 1.0
  v_mfma_f32_16x16x32_bf16 v[52:55], a[232:235], a[128:131], v[52:55]
  v_fma_f32 v91, v91, v87, 1.0
  v_rcp_f32 v88, v88
  v_mfma_f32_16x16x32_bf16 v[52:55], a[236:239], a[140:143], v[52:55]
  global_load_dwordx4 a[224:227], v1, s[22:23] offset:0 sc1
  global_load_dwordx4 a[228:231], v1, s[22:23] offset:1024 sc1
  v_rcp_f32 v89, v89
  s_waitcnt vmcnt(14)
  v_mfma_f32_16x16x32_bf16 v[40:43], a[240:243], v[232:235], v[40:43]
  v_rcp_f32 v90, v90
  v_rcp_f32 v91, v91
  v_mfma_f32_16x16x32_bf16 v[40:43], a[244:247], v[236:239], v[40:43]
  v_fma_f32 v80, -v80, v88, v80
  v_fma_f32 v81, -v81, v89, v81
  v_mfma_f32_16x16x32_bf16 v[40:43], a[248:251], v[240:243], v[40:43]
  v_fma_f32 v82, -v82, v90, v82
  v_fma_f32 v83, -v83, v91, v83
  v_mfma_f32_16x16x32_bf16 v[40:43], a[252:255], v[244:247], v[40:43]
  global_load_dwordx4 a[232:235], v1, s[22:23] offset:2048 sc1
  v_cvt_pk_bf16_f32 v104, v80, v81
  v_cvt_pk_bf16_f32 v105, v82, v83
  v_mfma_f32_16x16x32_bf16 v[40:43], v[108:111], v[248:251], v[40:43]
  ds_write_b64 v8, v[104:105] offset:49152
  v_mfma_f32_16x16x32_bf16 v[40:43], v[112:115], v[252:255], v[40:43]
  v_fma_f32 v92, v79, v56, v60
  v_fma_f32 v93, v79, v57, v61
  v_mfma_f32_16x16x32_bf16 v[44:47], a[240:243], a[144:147], v[44:47]
  v_fma_f32 v94, v79, v58, v62
  v_fma_f32 v95, v79, v59, v63
  v_mfma_f32_16x16x32_bf16 v[44:47], a[244:247], a[156:159], v[44:47]
  global_load_dwordx4 a[236:239], v1, s[22:23] offset:3072 sc1
  s_add_u32 s22, s22, 8192
  s_addc_u32 s23, s23, 0
  v_fma_f32 v92, v36, v75, v92
  v_fma_f32 v93, v37, v75, v93
  v_mfma_f32_16x16x32_bf16 v[44:47], a[248:251], a[168:171], v[44:47]
  v_fma_f32 v94, v38, v75, v94
  v_fma_f32 v95, v39, v75, v95
  v_mfma_f32_16x16x32_bf16 v[44:47], a[252:255], a[180:183], v[44:47]
  v_exp_f32 v96, v92
  v_exp_f32 v97, v93
  v_mfma_f32_16x16x32_bf16 v[44:47], v[108:111], a[192:195], v[44:47]
  v_exp_f32 v98, v94
  v_mfma_f32_16x16x32_bf16 v[44:47], v[112:115], a[204:207], v[44:47]
  v_exp_f32 v99, v95
  v_fma_f32 v100, v96, 0.5, 1.0
  v_mfma_f32_16x16x32_bf16 v[48:51], a[240:243], a[148:151], v[48:51]
  v_fma_f32 v101, v97, 0.5, 1.0
  v_fma_f32 v102, v98, 0.5, 1.0
  v_mfma_f32_16x16x32_bf16 v[48:51], a[244:247], a[160:163], v[48:51]
  v_fma_f32 v103, v99, 0.5, 1.0
  v_fma_f32 v100, v100, v96, 1.0
  v_mfma_f32_16x16x32_bf16 v[48:51], a[248:251], a[172:175], v[48:51]
  v_fma_f32 v101, v101, v97, 1.0
  v_fma_f32 v102, v102, v98, 1.0
  v_mfma_f32_16x16x32_bf16 v[48:51], a[252:255], a[184:187], v[48:51]
  v_fma_f32 v103, v103, v99, 1.0
  v_rcp_f32 v100, v100
  v_mfma_f32_16x16x32_bf16 v[48:51], v[108:111], a[196:199], v[48:51]
  v_rcp_f32 v101, v101
  v_mfma_f32_16x16x32_bf16 v[48:51], v[112:115], a[208:211], v[48:51]
  v_rcp_f32 v102, v102
  v_rcp_f32 v103, v103
  v_mfma_f32_16x16x32_bf16 v[52:55], a[240:243], a[152:155], v[52:55]
  v_fma_f32 v92, -v92, v100, v92
  v_fma_f32 v93, -v93, v101, v93
  ds_read_b128 v[64:67], v14 offset:896
  ds_read_b128 v[68:71], v14 offset:960
  v_mfma_f32_16x16x32_bf16 v[52:55], a[244:247], a[164:167], v[52:55]
  global_load_dwordx4 a[240:243], v1, s[22:23] offset:-4096 sc1
  global_load_dwordx4 a[244:247], v1, s[22:23] offset:-3072 sc1
  v_fma_f32 v94, -v94, v102, v94
  v_fma_f32 v95, -v95, v103, v95
  v_mfma_f32_16x16x32_bf16 v[52:55], a[248:251], a[176:179], v[52:55]
  v_cvt_pk_bf16_f32 v106, v92, v93
  v_cvt_pk_bf16_f32 v107, v94, v95
  v_mfma_f32_16x16x32_bf16 v[52:55], a[252:255], a[188:191], v[52:55]
  ds_write_b64 v9, v[106:107] offset:49152
  v_mfma_f32_16x16x32_bf16 v[52:55], v[108:111], a[200:203], v[52:55]
  v_mfma_f32_16x16x32_bf16 v[52:55], v[112:115], a[212:215], v[52:55]
  global_load_dwordx4 a[248:251], v1, s[24:25] offset:-4096 sc1
  global_load_dwordx4 a[252:255], v1, s[24:25] offset:-3072 sc1
  s_waitcnt vmcnt(14)
  v_mfma_f32_16x16x32_bf16 v[24:27], v[116:119], v[184:187], 0
  ds_read_b128 v[184:187], v10 offset:0
  s_waitcnt lgkmcnt(0)
  s_barrier
  v_mfma_f32_16x16x32_bf16 v[24:27], v[120:123], v[188:191], v[24:27]
  ds_read_b128 v[188:191], v10 offset:4096
  v_mfma_f32_16x16x32_bf16 v[24:27], v[124:127], v[192:195], v[24:27]
  ds_read_b128 v[192:195], v10 offset:8192
  v_fma_f32 v80, v76, v64, v68
  v_fma_f32 v81, v76, v65, v69
  v_mfma_f32_16x16x32_bf16 v[24:27], v[128:131], v[196:199], v[24:27]
  global_load_dwordx4 v[108:111], v1, s[24:25] offset:-2048 sc1
  ds_read_b128 v[196:199], v10 offset:12288
  v_fma_f32 v82, v76, v66, v70
  v_fma_f32 v83, v76, v67, v71
  v_mfma_f32_16x16x32_bf16 v[24:27], v[132:135], v[200:203], v[24:27]
  ds_read_b128 v[200:203], v10 offset:16384
  v_fma_f32 v80, v40, v72, v80
  v_fma_f32 v81, v41, v72, v81
  v_mfma_f32_16x16x32_bf16 v[24:27], v[136:139], v[204:207], v[24:27]
  ds_read_b128 v[204:207], v10 offset:20480
  v_fma_f32 v82, v42, v72, v82
  v_fma_f32 v83, v43, v72, v83
  v_mfma_f32_16x16x32_bf16 v[28:31], v[116:119], a[0:3], 0
  ds_read_b128 a[0:3], v11 offset:0
  v_exp_f32 v84, v80
  v_exp_f32 v85, v81
  v_mfma_f32_16x16x32_bf16 v[28:31], v[120:123], a[12:15], v[28:31]
  global_load_dwordx4 v[112:115], v1, s[24:25] offset:-1024 sc1
  ds_read_b128 a[12:15], v11 offset:4096
  v_exp_f32 v86, v82
  v_mfma_f32_16x16x32_bf16 v[28:31], v[124:127], a[24:27], v[28:31]
  ds_read_b128 a[24:27], v11 offset:8192
  v_exp_f32 v87, v83
  v_fma_f32 v88, v84, 0.5, 1.0
  v_mfma_f32_16x16x32_bf16 v[28:31], v[128:131], a[36:39], v[28:31]
  ds_read_b128 a[36:39], v11 offset:12288
  v_fma_f32 v89, v85, 0.5, 1.0
  v_fma_f32 v90, v86, 0.5, 1.0
  v_mfma_f32_16x16x32_bf16 v[28:31], v[132:135], a[48:51], v[28:31]
  ds_read_b128 a[48:51], v11 offset:16384
  v_fma_f32 v91, v87, 0.5, 1.0
  v_fma_f32 v88, v88, v84, 1.0
  v_mfma_f32_16x16x32_bf16 v[28:31], v[136:139], a[60:63], v[28:31]
  ds_read_b128 a[60:63], v11 offset:20480
  v_fma_f32 v89, v89, v85, 1.0
  v_fma_f32 v90, v90, v86, 1.0
  v_mfma_f32_16x16x32_bf16 v[32:35], v[116:119], a[4:7], 0
  ds_read_b128 a[4:7], v12 offset:0
  v_fma_f32 v91, v91, v87, 1.0
  v_rcp_f32 v88, v88
  v_mfma_f32_16x16x32_bf16 v[32:35], v[120:123], a[16:19], v[32:35]
  ds_read_b128 a[16:19], v12 offset:4096
  v_rcp_f32 v89, v89
  v_mfma_f32_16x16x32_bf16 v[32:35], v[124:127], a[28:31], v[32:35]
  ds_read_b128 a[28:31], v12 offset:8192
  v_rcp_f32 v90, v90
  v_rcp_f32 v91, v91
  v_mfma_f32_16x16x32_bf16 v[32:35], v[128:131], a[40:43], v[32:35]
  ds_read_b128 a[40:43], v12 offset:12288
  v_fma_f32 v80, -v80, v88, v80
  v_fma_f32 v81, -v81, v89, v81
  v_mfma_f32_16x16x32_bf16 v[32:35], v[132:135], a[52:55], v[32:35]
  ds_read_b128 a[52:55], v12 offset:16384
  v_fma_f32 v82, -v82, v90, v82
  v_fma_f32 v83, -v83, v91, v83
  v_mfma_f32_16x16x32_bf16 v[32:35], v[136:139], a[64:67], v[32:35]
  ds_read_b128 a[64:67], v12 offset:20480
  v_cvt_pk_bf16_f32 v104, v80, v81
  v_cvt_pk_bf16_f32 v105, v82, v83
  v_mfma_f32_16x16x32_bf16 v[36:39], v[116:119], a[8:11], 0
  ds_read_b128 a[8:11], v13 offset:0
  ds_write_b64 v6, v[104:105] offset:49160
  v_mfma_f32_16x16x32_bf16 v[36:39], v[120:123], a[20:23], v[36:39]
  global_load_dwordx4 v[116:119], v1, s[24:25] offset:0 sc1
  global_load_dwordx4 v[120:123], v1, s[24:25] offset:1024 sc1
  ds_read_b128 a[20:23], v13 offset:4096
  v_fma_f32 v92, v77, v64, v68
  v_fma_f32 v93, v77, v65, v69
  v_mfma_f32_16x16x32_bf16 v[36:39], v[124:127], a[32:35], v[36:39]
  ds_read_b128 a[32:35], v13 offset:8192
  v_fma_f32 v94, v77, v66, v70
  v_fma_f32 v95, v77, v67, v71
  v_mfma_f32_16x16x32_bf16 v[36:39], v[128:131], a[44:47], v[36:39]
  ds_read_b128 a[44:47], v13 offset:12288
  v_fma_f32 v92, v44, v73, v92
  v_fma_f32 v93, v45, v73, v93
  v_mfma_f32_16x16x32_bf16 v[36:39], v[132:135], a[56:59], v[36:39]
  ds_read_b128 a[56:59], v13 offset:16384
  v_fma_f32 v94, v46, v73, v94
  v_fma_f32 v95, v47, v73, v95
  v_mfma_f32_16x16x32_bf16 v[36:39], v[136:139], a[68:71], v[36:39]
  global_load_dwordx4 v[124:127], v1, s[24:25] offset:2048 sc1
  global_load_dwordx4 v[128:131], v1, s[24:25] offset:3072 sc1
  s_add_u32 s24, s24, 8192
  s_addc_u32 s25, s25, 0
  ds_read_b128 a[68:71], v13 offset:20480
  v_exp_f32 v96, v92
  v_exp_f32 v97, v93
  s_waitcnt vmcnt(14)
  v_mfma_f32_16x16x32_bf16 v[24:27], v[140:143], v[208:211], v[24:27]
  ds_read_b128 v[208:211], v10 offset:24576
  v_exp_f32 v98, v94
  v_mfma_f32_16x16x32_bf16 v[24:27], v[144:147], v[212:215], v[24:27]
  ds_read_b128 v[212:215], v10 offset:28672
  v_exp_f32 v99, v95
  v_fma_f32 v100, v96, 0.5, 1.0
  v_mfma_f32_16x16x32_bf16 v[24:27], v[148:151], v[216:219], v[24:27]
  ds_read_b128 v[216:219], v10 offset:32768
  v_fma_f32 v101, v97, 0.5, 1.0
  v_fma_f32 v102, v98, 0.5, 1.0
  v_mfma_f32_16x16x32_bf16 v[24:27], v[152:155], v[220:223], v[24:27]
  global_load_dwordx4 v[132:135], v1, s[24:25] offset:-4096 sc1
  ds_read_b128 v[220:223], v10 offset:36864
  v_fma_f32 v103, v99, 0.5, 1.0
  v_fma_f32 v100, v100, v96, 1.0
  v_mfma_f32_16x16x32_bf16 v[24:27], a[216:219], v[224:227], v[24:27]
  ds_read_b128 v[224:227], v10 offset:40960
  v_fma_f32 v101, v101, v97, 1.0
  v_fma_f32 v102, v102, v98, 1.0
  v_mfma_f32_16x16x32_bf16 v[24:27], a[220:223], v[228:231], v[24:27]
  ds_read_b128 v[228:231], v10 offset:45056
  v_fma_f32 v103, v103, v99, 1.0
  v_rcp_f32 v100, v100
  v_mfma_f32_16x16x32_bf16 v[28:31], v[140:143], a[72:75], v[28:31]
  ds_read_b128 a[72:75], v11 offset:24576
  v_rcp_f32 v101, v101
  v_mfma_f32_16x16x32_bf16 v[28:31], v[144:147], a[84:87], v[28:31]
  global_load_dwordx4 v[136:139], v1, s[24:25] offset:-3072 sc1
  ds_read_b128 a[84:87], v11 offset:28672
  v_rcp_f32 v102, v102
  v_rcp_f32 v103, v103
  v_mfma_f32_16x16x32_bf16 v[28:31], v[148:151], a[96:99], v[28:31]
  ds_read_b128 a[96:99], v11 offset:32768
  v_fma_f32 v92, -v92, v100, v92
  v_fma_f32 v93, -v93, v101, v93
  v_mfma_f32_16x16x32_bf16 v[28:31], v[152:155], a[108:111], v[28:31]
  ds_read_b128 a[108:111], v11 offset:36864
  v_fma_f32 v94, -v94, v102, v94
  v_fma_f32 v95, -v95, v103, v95
  v_mfma_f32_16x16x32_bf16 v[28:31], a[216:219], a[120:123], v[28:31]
  ds_read_b128 a[120:123], v11 offset:40960
  v_cvt_pk_bf16_f32 v106, v92, v93
  v_cvt_pk_bf16_f32 v107, v94, v95
  v_mfma_f32_16x16x32_bf16 v[28:31], a[220:223], a[132:135], v[28:31]
  ds_read_b128 a[132:135], v11 offset:45056
  ds_write_b64 v7, v[106:107] offset:49160
  v_mfma_f32_16x16x32_bf16 v[32:35], v[140:143], a[76:79], v[32:35]
  ds_read_b128 a[76:79], v12 offset:24576
  v_fma_f32 v80, v78, v64, v68
  v_fma_f32 v81, v78, v65, v69
  v_mfma_f32_16x16x32_bf16 v[32:35], v[144:147], a[88:91], v[32:35]
  ds_read_b128 a[88:91], v12 offset:28672
  v_fma_f32 v82, v78, v66, v70
  v_fma_f32 v83, v78, v67, v71
  v_mfma_f32_16x16x32_bf16 v[32:35], v[148:151], a[100:103], v[32:35]
  ds_read_b128 a[100:103], v12 offset:32768
  v_fma_f32 v80, v48, v74, v80
  v_fma_f32 v81, v49, v74, v81
  v_mfma_f32_16x16x32_bf16 v[32:35], v[152:155], a[112:115], v[32:35]
  ds_read_b128 a[112:115], v12 offset:36864
  v_fma_f32 v82, v50, v74, v82
  v_fma_f32 v83, v51, v74, v83
  v_mfma_f32_16x16x32_bf16 v[32:35], a[216:219], a[124:127], v[32:35]
  ds_read_b128 a[124:127], v12 offset:40960
  v_exp_f32 v84, v80
  v_exp_f32 v85, v81
  v_mfma_f32_16x16x32_bf16 v[32:35], a[220:223], a[136:139], v[32:35]
  ds_read_b128 a[136:139], v12 offset:45056
  v_exp_f32 v86, v82
  v_mfma_f32_16x16x32_bf16 v[36:39], v[140:143], a[80:83], v[36:39]
  ds_read_b128 a[80:83], v13 offset:24576
  v_exp_f32 v87, v83
  v_fma_f32 v88, v84, 0.5, 1.0
  v_mfma_f32_16x16x32_bf16 v[36:39], v[144:147], a[92:95], v[36:39]
  global_load_dwordx4 v[140:143], v1, s[24:25] offset:-2048 sc1
  global_load_dwordx4 v[144:147], v1, s[24:25] offset:-1024 sc1
  ds_read_b128 a[92:95], v13 offset:28672
  v_fma_f32 v89, v85, 0.5, 1.0
  v_fma_f32 v90, v86, 0.5, 1.0
  v_mfma_f32_16x16x32_bf16 v[36:39], v[148:151], a[104:107], v[36:39]
  ds_read_b128 a[104:107], v13 offset:32768
  v_fma_f32 v91, v87, 0.5, 1.0
  v_fma_f32 v88, v88, v84, 1.0
  v_mfma_f32_16x16x32_bf16 v[36:39], v[152:155], a[116:119], v[36:39]
  ds_read_b128 a[116:119], v13 offset:36864
  v_fma_f32 v89, v89, v85, 1.0
  v_fma_f32 v90, v90, v86, 1.0
  v_mfma_f32_16x16x32_bf16 v[36:39], a[216:219], a[128:131], v[36:39]
  ds_read_b128 a[128:131], v13 offset:40960
  v_fma_f32 v91, v91, v87, 1.0
  v_rcp_f32 v88, v88
  v_mfma_f32_16x16x32_bf16 v[36:39], a[220:223], a[140:143], v[36:39]
  global_load_dwordx4 v[148:151], v1, s[24:25] offset:0 sc1
  global_load_dwordx4 v[152:155], v1, s[24:25] offset:1024 sc1
  ds_read_b128 a[140:143], v13 offset:45056
  v_rcp_f32 v89, v89
  s_waitcnt vmcnt(14)
  v_mfma_f32_16x16x32_bf16 v[24:27], a[224:227], v[232:235], v[24:27]
  v_rcp_f32 v90, v90
  v_rcp_f32 v91, v91
  v_mfma_f32_16x16x32_bf16 v[24:27], a[228:231], v[236:239], v[24:27]
  v_fma_f32 v80, -v80, v88, v80
  v_fma_f32 v81, -v81, v89, v81
  v_mfma_f32_16x16x32_bf16 v[24:27], a[232:235], v[240:243], v[24:27]
  v_fma_f32 v82, -v82, v90, v82
  v_fma_f32 v83, -v83, v91, v83
  v_mfma_f32_16x16x32_bf16 v[24:27], a[236:239], v[244:247], v[24:27]
  global_load_dwordx4 a[216:219], v1, s[24:25] offset:2048 sc1
  v_cvt_pk_bf16_f32 v104, v80, v81
  v_cvt_pk_bf16_f32 v105, v82, v83
  v_mfma_f32_16x16x32_bf16 v[24:27], a[240:243], v[248:251], v[24:27]
  ds_write_b64 v8, v[104:105] offset:49160
  v_mfma_f32_16x16x32_bf16 v[24:27], a[244:247], v[252:255], v[24:27]
  v_fma_f32 v92, v79, v64, v68
  v_fma_f32 v93, v79, v65, v69
  v_mfma_f32_16x16x32_bf16 v[28:31], a[224:227], a[144:147], v[28:31]
  v_fma_f32 v94, v79, v66, v70
  v_fma_f32 v95, v79, v67, v71
  v_mfma_f32_16x16x32_bf16 v[28:31], a[228:231], a[156:159], v[28:31]
  global_load_dwordx4 a[220:223], v1, s[24:25] offset:3072 sc1
  s_add_u32 s24, s24, 8192
  s_addc_u32 s25, s25, 0
  v_fma_f32 v92, v52, v75, v92
  v_fma_f32 v93, v53, v75, v93
  v_mfma_f32_16x16x32_bf16 v[28:31], a[232:235], a[168:171], v[28:31]
  v_fma_f32 v94, v54, v75, v94
  v_fma_f32 v95, v55, v75, v95
  v_mfma_f32_16x16x32_bf16 v[28:31], a[236:239], a[180:183], v[28:31]
  v_exp_f32 v96, v92
  v_exp_f32 v97, v93
  v_mfma_f32_16x16x32_bf16 v[28:31], a[240:243], a[192:195], v[28:31]
  v_exp_f32 v98, v94
  v_mfma_f32_16x16x32_bf16 v[28:31], a[244:247], a[204:207], v[28:31]
  v_exp_f32 v99, v95
  v_fma_f32 v100, v96, 0.5, 1.0
  v_mfma_f32_16x16x32_bf16 v[32:35], a[224:227], a[148:151], v[32:35]
  v_fma_f32 v101, v97, 0.5, 1.0
  v_fma_f32 v102, v98, 0.5, 1.0
  v_mfma_f32_16x16x32_bf16 v[32:35], a[228:231], a[160:163], v[32:35]
  v_fma_f32 v103, v99, 0.5, 1.0
  v_fma_f32 v100, v100, v96, 1.0
  v_mfma_f32_16x16x32_bf16 v[32:35], a[232:235], a[172:175], v[32:35]
  v_fma_f32 v101, v101, v97, 1.0
  v_fma_f32 v102, v102, v98, 1.0
  v_mfma_f32_16x16x32_bf16 v[32:35], a[236:239], a[184:187], v[32:35]
  v_fma_f32 v103, v103, v99, 1.0
  v_rcp_f32 v100, v100
  v_mfma_f32_16x16x32_bf16 v[32:35], a[240:243], a[196:199], v[32:35]
  v_rcp_f32 v101, v101
  v_mfma_f32_16x16x32_bf16 v[32:35], a[244:247], a[208:211], v[32:35]
  v_rcp_f32 v102, v102
  v_rcp_f32 v103, v103
  v_mfma_f32_16x16x32_bf16 v[36:39], a[224:227], a[152:155], v[36:39]
  v_fma_f32 v92, -v92, v100, v92
  v_fma_f32 v93, -v93, v101, v93
  ds_read_b128 v[56:59], v14 offset:1024
  ds_read_b128 v[60:63], v14 offset:1088
  v_mfma_f32_16x16x32_bf16 v[36:39], a[228:231], a[164:167], v[36:39]
  global_load_dwordx4 a[224:227], v1, s[24:25] offset:-4096 sc1
  global_load_dwordx4 a[228:231], v1, s[24:25] offset:-3072 sc1
  v_fma_f32 v94, -v94, v102, v94
  v_fma_f32 v95, -v95, v103, v95
  v_mfma_f32_16x16x32_bf16 v[36:39], a[232:235], a[176:179], v[36:39]
  v_cvt_pk_bf16_f32 v106, v92, v93
  v_cvt_pk_bf16_f32 v107, v94, v95
  v_mfma_f32_16x16x32_bf16 v[36:39], a[236:239], a[188:191], v[36:39]
  ds_write_b64 v9, v[106:107] offset:49160
  v_mfma_f32_16x16x32_bf16 v[36:39], a[240:243], a[200:203], v[36:39]
  v_mfma_f32_16x16x32_bf16 v[36:39], a[244:247], a[212:215], v[36:39]
  global_load_dwordx4 a[232:235], v1, s[24:25] offset:-2048 sc1
  global_load_dwordx4 a[236:239], v1, s[24:25] offset:-1024 sc1
  s_waitcnt vmcnt(19)
  v_mfma_f32_16x16x32_bf16 v[40:43], a[248:251], v[184:187], 0
  s_waitcnt lgkmcnt(0)
  s_barrier
  v_mfma_f32_16x16x32_bf16 v[44:47], a[248:251], a[0:3], 0
  ds_read_b128 v[232:235], v10 offset:49152
  v_mfma_f32_16x16x32_bf16 v[48:51], a[248:251], a[4:7], 0
  ds_read_b128 a[144:147], v11 offset:49152
  v_add_u32 v6, s50, v6
  v_add_u32 v7, s50, v7
  v_add_u32 v8, s50, v8
  v_mfma_f32_16x16x32_bf16 v[52:55], a[248:251], a[8:11], 0
  global_load_dwordx4 a[240:243], v1, s[24:25] offset:0 sc1
  ds_read_b128 a[148:151], v12 offset:49152
  v_add_u32 v9, s50, v9
  v_fma_f32 v80, v76, v56, v60
  v_fma_f32 v81, v76, v57, v61
  s_waitcnt vmcnt(19)
  v_mfma_f32_16x16x32_bf16 v[40:43], a[252:255], v[188:191], v[40:43]
  ds_read_b128 a[152:155], v13 offset:49152
  v_fma_f32 v82, v76, v58, v62
  v_fma_f32 v83, v76, v59, v63
  v_fma_f32 v80, v24, v72, v80
  v_mfma_f32_16x16x32_bf16 v[44:47], a[252:255], a[12:15], v[44:47]
  ds_read_b128 v[236:239], v10 offset:53248
  v_fma_f32 v81, v25, v72, v81
  v_fma_f32 v82, v26, v72, v82
  v_fma_f32 v83, v27, v72, v83
  v_mfma_f32_16x16x32_bf16 v[48:51], a[252:255], a[16:19], v[48:51]
  ds_read_b128 a[156:159], v11 offset:53248
  v_exp_f32 v84, v80
  v_exp_f32 v85, v81
  v_exp_f32 v86, v82
  v_mfma_f32_16x16x32_bf16 v[52:55], a[252:255], a[20:23], v[52:55]
  global_load_dwordx4 a[244:247], v1, s[24:25] offset:1024 sc1
  v_exp_f32 v87, v83
  v_fma_f32 v88, v84, 0.5, 1.0
  v_fma_f32 v89, v85, 0.5, 1.0
  s_waitcnt vmcnt(19)
  v_mfma_f32_16x16x32_bf16 v[40:43], v[108:111], v[192:195], v[40:43]
  ds_read_b128 a[160:163], v12 offset:53248
  v_fma_f32 v90, v86, 0.5, 1.0
  v_fma_f32 v91, v87, 0.5, 1.0
  v_fma_f32 v88, v88, v84, 1.0
  v_mfma_f32_16x16x32_bf16 v[44:47], v[108:111], a[24:27], v[44:47]
  ds_read_b128 a[164:167], v13 offset:53248
  v_fma_f32 v89, v89, v85, 1.0
  v_fma_f32 v90, v90, v86, 1.0
  v_fma_f32 v91, v91, v87, 1.0
  v_mfma_f32_16x16x32_bf16 v[48:51], v[108:111], a[28:31], v[48:51]
  ds_read_b128 v[240:243], v10 offset:57344
  v_rcp_f32 v88, v88
  v_rcp_f32 v89, v89
  v_rcp_f32 v90, v90
  v_mfma_f32_16x16x32_bf16 v[52:55], v[108:111], a[32:35], v[52:55]
  global_load_dwordx4 a[248:251], v1, s[24:25] offset:2048 sc1
  ds_read_b128 a[168:171], v11 offset:57344
  v_rcp_f32 v91, v91
  v_fma_f32 v80, -v80, v88, v80
  v_fma_f32 v81, -v81, v89, v81
  s_waitcnt vmcnt(19)
  v_mfma_f32_16x16x32_bf16 v[40:43], v[112:115], v[196:199], v[40:43]
  ds_read_b128 a[172:175], v12 offset:57344
  v_fma_f32 v82, -v82, v90, v82
  v_fma_f32 v83, -v83, v91, v83
  v_mfma_f32_16x16x32_bf16 v[44:47], v[112:115], a[36:39], v[44:47]
  v_cvt_pk_bf16_f32 v104, v80, v81
  v_cvt_pk_bf16_f32 v105, v82, v83
  ds_write_b64 v6, v[104:105] offset:0
  v_mfma_f32_16x16x32_bf16 v[48:51], v[112:115], a[40:43], v[48:51]
  ds_read_b128 a[176:179], v13 offset:57344
  v_fma_f32 v92, v77, v56, v60
  v_fma_f32 v93, v77, v57, v61
  v_fma_f32 v94, v77, v58, v62
  v_mfma_f32_16x16x32_bf16 v[52:55], v[112:115], a[44:47], v[52:55]
  global_load_dwordx4 a[252:255], v1, s[24:25] offset:3072 sc1
  s_add_u32 s24, s24, 8192
  s_addc_u32 s25, s25, 0
  ds_read_b128 v[244:247], v10 offset:61440
  v_fma_f32 v95, v77, v59, v63
  v_fma_f32 v92, v28, v73, v92
  v_fma_f32 v93, v29, v73, v93
  s_waitcnt vmcnt(19)
  v_mfma_f32_16x16x32_bf16 v[40:43], v[116:119], v[200:203], v[40:43]
  ds_read_b128 a[180:183], v11 offset:61440
  v_fma_f32 v94, v30, v73, v94
  v_fma_f32 v95, v31, v73, v95
  v_exp_f32 v96, v92
  v_mfma_f32_16x16x32_bf16 v[44:47], v[116:119], a[48:51], v[44:47]
  ds_read_b128 a[184:187], v12 offset:61440
  v_exp_f32 v97, v93
  v_exp_f32 v98, v94
  v_exp_f32 v99, v95
  v_mfma_f32_16x16x32_bf16 v[48:51], v[116:119], a[52:55], v[48:51]
  ds_read_b128 a[188:191], v13 offset:61440
  v_fma_f32 v100, v96, 0.5, 1.0
  v_fma_f32 v101, v97, 0.5, 1.0
  v_fma_f32 v102, v98, 0.5, 1.0
  v_mfma_f32_16x16x32_bf16 v[52:55], v[116:119], a[56:59], v[52:55]
  global_load_dwordx4 v[108:111], v1, s[24:25] offset:-4096 sc1
  v_fma_f32 v103, v99, 0.5, 1.0
  v_fma_f32 v100, v100, v96, 1.0
  v_fma_f32 v101, v101, v97, 1.0
  s_waitcnt vmcnt(19)
  v_mfma_f32_16x16x32_bf16 v[40:43], v[120:123], v[204:207], v[40:43]
  v_fma_f32 v102, v102, v98, 1.0
  v_fma_f32 v103, v103, v99, 1.0
  v_rcp_f32 v100, v100
  v_mfma_f32_16x16x32_bf16 v[44:47], v[120:123], a[60:63], v[44:47]
  v_rcp_f32 v101, v101
  v_rcp_f32 v102, v102
  v_rcp_f32 v103, v103
  v_mfma_f32_16x16x32_bf16 v[48:51], v[120:123], a[64:67], v[48:51]
  v_fma_f32 v92, -v92, v100, v92
  v_fma_f32 v93, -v93, v101, v93
  v_fma_f32 v94, -v94, v102, v94
  v_mfma_f32_16x16x32_bf16 v[52:55], v[120:123], a[68:71], v[52:55]
  global_load_dwordx4 v[112:115], v1, s[24:25] offset:-3072 sc1
  v_fma_f32 v95, -v95, v103, v95
  v_cvt_pk_bf16_f32 v106, v92, v93
  s_waitcnt vmcnt(19)
  v_mfma_f32_16x16x32_bf16 v[40:43], v[124:127], v[208:211], v[40:43]
  v_cvt_pk_bf16_f32 v107, v94, v95
  ds_write_b64 v7, v[106:107] offset:0
  v_fma_f32 v80, v78, v56, v60
  v_mfma_f32_16x16x32_bf16 v[44:47], v[124:127], a[72:75], v[44:47]
  v_fma_f32 v81, v78, v57, v61
  v_fma_f32 v82, v78, v58, v62
  v_fma_f32 v83, v78, v59, v63
  v_mfma_f32_16x16x32_bf16 v[48:51], v[124:127], a[76:79], v[48:51]
  v_fma_f32 v80, v32, v74, v80
  v_fma_f32 v81, v33, v74, v81
  v_fma_f32 v82, v34, v74, v82
  v_mfma_f32_16x16x32_bf16 v[52:55], v[124:127], a[80:83], v[52:55]
  global_load_dwordx4 v[116:119], v1, s[24:25] offset:-2048 sc1
  v_fma_f32 v83, v35, v74, v83
  v_exp_f32 v84, v80
  v_exp_f32 v85, v81
  s_waitcnt vmcnt(19)
  v_mfma_f32_16x16x32_bf16 v[40:43], v[128:131], v[212:215], v[40:43]
  v_exp_f32 v86, v82
  v_exp_f32 v87, v83
  v_fma_f32 v88, v84, 0.5, 1.0
  v_mfma_f32_16x16x32_bf16 v[44:47], v[128:131], a[84:87], v[44:47]
  v_fma_f32 v89, v85, 0.5, 1.0
  v_fma_f32 v90, v86, 0.5, 1.0
  v_fma_f32 v91, v87, 0.5, 1.0
  v_mfma_f32_16x16x32_bf16 v[48:51], v[128:131], a[88:91], v[48:51]
  v_fma_f32 v88, v88, v84, 1.0
  v_fma_f32 v89, v89, v85, 1.0
  v_fma_f32 v90, v90, v86, 1.0
  v_mfma_f32_16x16x32_bf16 v[52:55], v[128:131], a[92:95], v[52:55]
  global_load_dwordx4 v[120:123], v1, s[24:25] offset:-1024 sc1
  v_fma_f32 v91, v91, v87, 1.0
  v_rcp_f32 v88, v88
  v_rcp_f32 v89, v89
  s_waitcnt vmcnt(19)
  v_mfma_f32_16x16x32_bf16 v[40:43], v[132:135], v[216:219], v[40:43]
  v_rcp_f32 v90, v90
  v_rcp_f32 v91, v91
  v_fma_f32 v80, -v80, v88, v80
  v_mfma_f32_16x16x32_bf16 v[44:47], v[132:135], a[96:99], v[44:47]
  v_fma_f32 v81, -v81, v89, v81
  v_fma_f32 v82, -v82, v90, v82
  v_fma_f32 v83, -v83, v91, v83
  v_mfma_f32_16x16x32_bf16 v[48:51], v[132:135], a[100:103], v[48:51]
  v_cvt_pk_bf16_f32 v104, v80, v81
  v_cvt_pk_bf16_f32 v105, v82, v83
  v_mfma_f32_16x16x32_bf16 v[52:55], v[132:135], a[104:107], v[52:55]
  global_load_dwordx4 v[124:127], v1, s[24:25] offset:0 sc1
  ds_write_b64 v8, v[104:105] offset:0
  v_fma_f32 v92, v79, v56, v60
  v_fma_f32 v93, v79, v57, v61
  s_waitcnt vmcnt(19)
  v_mfma_f32_16x16x32_bf16 v[40:43], v[136:139], v[220:223], v[40:43]
  v_fma_f32 v94, v79, v58, v62
  v_fma_f32 v95, v79, v59, v63
  v_fma_f32 v92, v36, v75, v92
  v_mfma_f32_16x16x32_bf16 v[44:47], v[136:139], a[108:111], v[44:47]
  v_fma_f32 v93, v37, v75, v93
  v_fma_f32 v94, v38, v75, v94
  v_fma_f32 v95, v39, v75, v95
  v_mfma_f32_16x16x32_bf16 v[48:51], v[136:139], a[112:115], v[48:51]
  v_exp_f32 v96, v92
  v_exp_f32 v97, v93
  v_exp_f32 v98, v94
  v_mfma_f32_16x16x32_bf16 v[52:55], v[136:139], a[116:119], v[52:55]
  global_load_dwordx4 v[128:131], v1, s[24:25] offset:1024 sc1
  v_exp_f32 v99, v95
  v_fma_f32 v100, v96, 0.5, 1.0
  v_fma_f32 v101, v97, 0.5, 1.0
  s_waitcnt vmcnt(19)
  v_mfma_f32_16x16x32_bf16 v[40:43], v[140:143], v[224:227], v[40:43]
  v_fma_f32 v102, v98, 0.5, 1.0
  v_fma_f32 v103, v99, 0.5, 1.0
  v_fma_f32 v100, v100, v96, 1.0
  v_mfma_f32_16x16x32_bf16 v[44:47], v[140:143], a[120:123], v[44:47]
  v_fma_f32 v101, v101, v97, 1.0
  v_fma_f32 v102, v102, v98, 1.0
  v_fma_f32 v103, v103, v99, 1.0
  v_mfma_f32_16x16x32_bf16 v[48:51], v[140:143], a[124:127], v[48:51]
  v_rcp_f32 v100, v100
  v_rcp_f32 v101, v101
  v_rcp_f32 v102, v102
  v_mfma_f32_16x16x32_bf16 v[52:55], v[140:143], a[128:131], v[52:55]
  global_load_dwordx4 v[132:135], v1, s[24:25] offset:2048 sc1
  v_rcp_f32 v103, v103
  v_fma_f32 v92, -v92, v100, v92
  v_fma_f32 v93, -v93, v101, v93
  s_waitcnt vmcnt(19)
  v_mfma_f32_16x16x32_bf16 v[40:43], v[144:147], v[228:231], v[40:43]
  v_fma_f32 v94, -v94, v102, v94
  v_fma_f32 v95, -v95, v103, v95
  v_cvt_pk_bf16_f32 v106, v92, v93
  v_mfma_f32_16x16x32_bf16 v[44:47], v[144:147], a[132:135], v[44:47]
  v_cvt_pk_bf16_f32 v107, v94, v95
  ds_write_b64 v9, v[106:107] offset:0
  v_mfma_f32_16x16x32_bf16 v[48:51], v[144:147], a[136:139], v[48:51]
  s_waitcnt lgkmcnt(0)
  s_barrier
  v_add_u32 v10, 65536, v10
  v_add_u32 v11, 65536, v11
  v_add_u32 v12, 65536, v12
  v_add_u32 v13, 65536, v13
  ds_read_b128 v[248:251], v10 offset:0
  ds_read_b128 a[192:195], v11 offset:0
  ds_read_b128 a[196:199], v12 offset:0
  ds_read_b128 a[200:203], v13 offset:0
  ds_read_b128 v[252:255], v10 offset:4096
  ds_read_b128 a[204:207], v11 offset:4096
  ds_read_b128 a[208:211], v12 offset:4096
  ds_read_b128 a[212:215], v13 offset:4096
  v_mfma_f32_16x16x32_bf16 v[52:55], v[144:147], a[140:143], v[52:55]
  global_load_dwordx4 v[136:139], v1, s[24:25] offset:3072 sc1
  s_add_u32 s24, s24, 8192
  s_addc_u32 s25, s25, 0
  s_waitcnt vmcnt(19)
  v_mfma_f32_16x16x32_bf16 v[40:43], v[148:151], v[232:235], v[40:43]
  v_mfma_f32_16x16x32_bf16 v[44:47], v[148:151], a[144:147], v[44:47]
  v_mfma_f32_16x16x32_bf16 v[48:51], v[148:151], a[148:151], v[48:51]
  v_mfma_f32_16x16x32_bf16 v[52:55], v[148:151], a[152:155], v[52:55]
  global_load_dwordx4 v[140:143], v1, s[24:25] offset:-4096 sc1
  s_waitcnt vmcnt(19)
  v_mfma_f32_16x16x32_bf16 v[40:43], v[152:155], v[236:239], v[40:43]
  v_mfma_f32_16x16x32_bf16 v[44:47], v[152:155], a[156:159], v[44:47]
  v_mfma_f32_16x16x32_bf16 v[48:51], v[152:155], a[160:163], v[48:51]
  v_mfma_f32_16x16x32_bf16 v[52:55], v[152:155], a[164:167], v[52:55]
  global_load_dwordx4 v[144:147], v1, s[24:25] offset:-3072 sc1
  s_waitcnt vmcnt(19)
  v_mfma_f32_16x16x32_bf16 v[40:43], a[216:219], v[240:243], v[40:43]
  v_mfma_f32_16x16x32_bf16 v[44:47], a[216:219], a[168:171], v[44:47]
  v_mfma_f32_16x16x32_bf16 v[48:51], a[216:219], a[172:175], v[48:51]
  v_mfma_f32_16x16x32_bf16 v[52:55], a[216:219], a[176:179], v[52:55]
  global_load_dwordx4 v[148:151], v1, s[24:25] offset:-2048 sc1
  s_waitcnt vmcnt(19)
  v_mfma_f32_16x16x32_bf16 v[40:43], a[220:223], v[244:247], v[40:43]
  v_mfma_f32_16x16x32_bf16 v[44:47], a[220:223], a[180:183], v[44:47]
  v_mfma_f32_16x16x32_bf16 v[48:51], a[220:223], a[184:187], v[48:51]
  v_mfma_f32_16x16x32_bf16 v[52:55], a[220:223], a[188:191], v[52:55]
  global_load_dwordx4 v[152:155], v1, s[24:25] offset:-1024 sc1
  s_waitcnt vmcnt(19) lgkmcnt(7)
  v_mfma_f32_16x16x32_bf16 v[40:43], a[224:227], v[248:251], v[40:43]
  s_waitcnt lgkmcnt(6)
  v_mfma_f32_16x16x32_bf16 v[44:47], a[224:227], a[192:195], v[44:47]
  s_waitcnt lgkmcnt(5)
  v_mfma_f32_16x16x32_bf16 v[48:51], a[224:227], a[196:199], v[48:51]
  s_waitcnt lgkmcnt(4)
  v_mfma_f32_16x16x32_bf16 v[52:55], a[224:227], a[200:203], v[52:55]
  global_load_dwordx4 a[216:219], v1, s[24:25] offset:0 sc1
  s_waitcnt vmcnt(19) lgkmcnt(3)
  v_mfma_f32_16x16x32_bf16 v[40:43], a[228:231], v[252:255], v[40:43]
  s_waitcnt lgkmcnt(2)
  v_mfma_f32_16x16x32_bf16 v[44:47], a[228:231], a[204:207], v[44:47]
  s_waitcnt lgkmcnt(1)
  v_mfma_f32_16x16x32_bf16 v[48:51], a[228:231], a[208:211], v[48:51]
  s_waitcnt lgkmcnt(0)
  v_mfma_f32_16x16x32_bf16 v[52:55], a[228:231], a[212:215], v[52:55]
  global_load_dwordx4 a[220:223], v1, s[24:25] offset:1024 sc1
  s_waitcnt vmcnt(14)
  v_mfma_f32_16x16x32_bf16 v[24:27], a[232:235], v[184:187], 0
  v_mfma_f32_16x16x32_bf16 v[24:27], a[236:239], v[188:191], v[24:27]
  v_mfma_f32_16x16x32_bf16 v[24:27], a[240:243], v[192:195], v[24:27]
  s_add_u32 s26, s66, 1
  s_and_b32 s26, s26, 7
  s_mul_i32 s8, s26, 2359296
  v_mfma_f32_16x16x32_bf16 v[24:27], a[244:247], v[196:199], v[24:27]
  global_load_dwordx4 a[224:227], v1, s[24:25] offset:2048 sc1
  v_mfma_f32_16x16x32_bf16 v[24:27], a[248:251], v[200:203], v[24:27]
  v_mfma_f32_16x16x32_bf16 v[24:27], a[252:255], v[204:207], v[24:27]
  v_mfma_f32_16x16x32_bf16 v[28:31], a[232:235], a[0:3], 0
  v_mfma_f32_16x16x32_bf16 v[28:31], a[236:239], a[12:15], v[28:31]
  global_load_dwordx4 a[228:231], v1, s[24:25] offset:3072 sc1
  s_add_u32 s24, s24, 8192
  s_addc_u32 s25, s25, 0
  s_add_u32 s26, s66, 2
  s_and_b32 s26, s26, 7
  s_mul_i32 s9, s26, 2359296
  v_mfma_f32_16x16x32_bf16 v[28:31], a[240:243], a[24:27], v[28:31]
  v_mfma_f32_16x16x32_bf16 v[28:31], a[244:247], a[36:39], v[28:31]
  v_mfma_f32_16x16x32_bf16 v[28:31], a[248:251], a[48:51], v[28:31]
  v_mfma_f32_16x16x32_bf16 v[28:31], a[252:255], a[60:63], v[28:31]
  v_mfma_f32_16x16x32_bf16 v[32:35], a[232:235], a[4:7], 0
  s_add_u32 s26, s66, 3
  s_and_b32 s26, s26, 7
  s_mul_i32 s10, s26, 2359296
  v_mfma_f32_16x16x32_bf16 v[32:35], a[236:239], a[16:19], v[32:35]
  v_mfma_f32_16x16x32_bf16 v[32:35], a[240:243], a[28:31], v[32:35]
  v_mfma_f32_16x16x32_bf16 v[32:35], a[244:247], a[40:43], v[32:35]
  v_mfma_f32_16x16x32_bf16 v[32:35], a[248:251], a[52:55], v[32:35]
  v_mfma_f32_16x16x32_bf16 v[32:35], a[252:255], a[64:67], v[32:35]
  s_add_u32 s26, s66, 4
  s_and_b32 s26, s26, 7
  s_mul_i32 s11, s26, 2359296
  v_mfma_f32_16x16x32_bf16 v[36:39], a[232:235], a[8:11], 0
  v_mfma_f32_16x16x32_bf16 v[36:39], a[236:239], a[20:23], v[36:39]
  global_load_dwordx4 a[232:235], v1, s[24:25] offset:-4096 sc1
  global_load_dwordx4 a[236:239], v1, s[24:25] offset:-3072 sc1
  v_mfma_f32_16x16x32_bf16 v[36:39], a[240:243], a[32:35], v[36:39]
  v_mfma_f32_16x16x32_bf16 v[36:39], a[244:247], a[44:47], v[36:39]
  v_mfma_f32_16x16x32_bf16 v[36:39], a[248:251], a[56:59], v[36:39]
  v_mfma_f32_16x16x32_bf16 v[36:39], a[252:255], a[68:71], v[36:39]
  global_load_dwordx4 a[240:243], v1, s[24:25] offset:-2048 sc1
  global_load_dwordx4 a[244:247], v1, s[24:25] offset:-1024 sc1
  s_add_u32 s26, s66, 5
  s_and_b32 s26, s26, 7
  s_mul_i32 s12, s26, 2359296
  s_waitcnt vmcnt(14)
  v_mfma_f32_16x16x32_bf16 v[24:27], v[108:111], v[208:211], v[24:27]
  v_mfma_f32_16x16x32_bf16 v[24:27], v[112:115], v[212:215], v[24:27]
  v_mfma_f32_16x16x32_bf16 v[24:27], v[116:119], v[216:219], v[24:27]
  v_mfma_f32_16x16x32_bf16 v[24:27], v[120:123], v[220:223], v[24:27]
  global_load_dwordx4 a[248:251], v1, s[24:25] offset:0 sc1
  v_mfma_f32_16x16x32_bf16 v[24:27], v[124:127], v[224:227], v[24:27]
  s_add_u32 s26, s66, 6
  s_and_b32 s26, s26, 7
  s_mul_i32 s13, s26, 2359296
  v_mfma_f32_16x16x32_bf16 v[24:27], v[128:131], v[228:231], v[24:27]
  v_mfma_f32_16x16x32_bf16 v[28:31], v[108:111], a[72:75], v[28:31]
  v_mfma_f32_16x16x32_bf16 v[28:31], v[112:115], a[84:87], v[28:31]
  global_load_dwordx4 a[252:255], v1, s[24:25] offset:1024 sc1
  v_mfma_f32_16x16x32_bf16 v[28:31], v[116:119], a[96:99], v[28:31]
  v_mfma_f32_16x16x32_bf16 v[28:31], v[120:123], a[108:111], v[28:31]
  s_add_u32 s26, s66, 7
  s_and_b32 s26, s26, 7
  s_mul_i32 s14, s26, 2359296
  v_mfma_f32_16x16x32_bf16 v[28:31], v[124:127], a[120:123], v[28:31]
  v_mfma_f32_16x16x32_bf16 v[28:31], v[128:131], a[132:135], v[28:31]
  v_mfma_f32_16x16x32_bf16 v[32:35], v[108:111], a[76:79], v[32:35]
  v_mfma_f32_16x16x32_bf16 v[32:35], v[112:115], a[88:91], v[32:35]
  v_mfma_f32_16x16x32_bf16 v[32:35], v[116:119], a[100:103], v[32:35]
  s_lshr_b32 s26, s28, 11
  s_lshl_b32 s27, s3, 1
  s_add_u32 s26, s26, s27
  s_and_b32 s27, s28, 1024
  s_add_u32 s27, s27, 73728
  s_cmp_eq_u32 s26, s66
  s_cselect_b32 s16, 0x40000000, 0
  s_cselect_b32 s27, s27, 90112
  v_add_u32 v6, s27, v1
  v_mfma_f32_16x16x32_bf16 v[32:35], v[120:123], a[112:115], v[32:35]
  v_mfma_f32_16x16x32_bf16 v[32:35], v[124:127], a[124:127], v[32:35]
  v_mfma_f32_16x16x32_bf16 v[32:35], v[128:131], a[136:139], v[32:35]
  v_mfma_f32_16x16x32_bf16 v[36:39], v[108:111], a[80:83], v[36:39]
  v_mfma_f32_16x16x32_bf16 v[36:39], v[112:115], a[92:95], v[36:39]
  global_load_dwordx4 v[108:111], v1, s[24:25] offset:2048 sc1
  global_load_dwordx4 v[112:115], v1, s[24:25] offset:3072 sc1
  s_add_u32 s24, s24, 8192
  s_addc_u32 s25, s25, 0
  v_mfma_f32_16x16x32_bf16 v[36:39], v[116:119], a[104:107], v[36:39]
  s_lshr_b32 s26, s29, 11
  s_lshl_b32 s27, s3, 1
  s_add_u32 s26, s26, s27
  s_and_b32 s27, s29, 1024
  s_add_u32 s27, s27, 73728
  s_cmp_eq_u32 s26, s66
  s_cselect_b32 s17, 0x40000000, 0
  s_cselect_b32 s27, s27, 90112
  v_add_u32 v7, s27, v1
  v_mfma_f32_16x16x32_bf16 v[36:39], v[120:123], a[116:119], v[36:39]
  v_mfma_f32_16x16x32_bf16 v[36:39], v[124:127], a[128:131], v[36:39]
  v_mfma_f32_16x16x32_bf16 v[36:39], v[128:131], a[140:143], v[36:39]
  global_load_dwordx4 v[116:119], v1, s[24:25] offset:-4096 sc1
  global_load_dwordx4 v[120:123], v1, s[24:25] offset:-3072 sc1
  s_waitcnt vmcnt(14)
  v_mfma_f32_16x16x32_bf16 v[24:27], v[132:135], v[232:235], v[24:27]
  v_mfma_f32_16x16x32_bf16 v[24:27], v[136:139], v[236:239], v[24:27]
  s_lshr_b32 s26, s30, 11
  s_lshl_b32 s27, s3, 1
  s_add_u32 s26, s26, s27
  s_and_b32 s27, s30, 1024
  s_add_u32 s27, s27, 73728
  s_cmp_eq_u32 s26, s66
  s_cselect_b32 s18, 0x40000000, 0
  s_cselect_b32 s27, s27, 90112
  v_add_u32 v8, s27, v1
  v_mfma_f32_16x16x32_bf16 v[24:27], v[140:143], v[240:243], v[24:27]
  v_mfma_f32_16x16x32_bf16 v[24:27], v[144:147], v[244:247], v[24:27]
  global_load_dwordx4 v[124:127], v1, s[24:25] offset:-2048 sc1
  v_mfma_f32_16x16x32_bf16 v[24:27], v[148:151], v[248:251], v[24:27]
  v_mfma_f32_16x16x32_bf16 v[24:27], v[152:155], v[252:255], v[24:27]
  v_mfma_f32_16x16x32_bf16 v[28:31], v[132:135], a[144:147], v[28:31]
  s_lshr_b32 s26, s31, 11
  s_lshl_b32 s27, s3, 1
  s_add_u32 s26, s26, s27
  s_and_b32 s27, s31, 1024
  s_add_u32 s27, s27, 73728
  s_cmp_eq_u32 s26, s66
  s_cselect_b32 s19, 0x40000000, 0
  s_cselect_b32 s27, s27, 90112
  v_add_u32 v9, s27, v1
  v_mfma_f32_16x16x32_bf16 v[28:31], v[136:139], a[156:159], v[28:31]
  global_load_dwordx4 v[128:131], v1, s[24:25] offset:-1024 sc1
  v_mfma_f32_16x16x32_bf16 v[28:31], v[140:143], a[168:171], v[28:31]
  v_mfma_f32_16x16x32_bf16 v[28:31], v[144:147], a[180:183], v[28:31]
  v_mfma_f32_16x16x32_bf16 v[28:31], v[148:151], a[192:195], v[28:31]
  v_mfma_f32_16x16x32_bf16 v[28:31], v[152:155], a[204:207], v[28:31]
  v_mfma_f32_16x16x32_bf16 v[32:35], v[132:135], a[148:151], v[32:35]
  v_mfma_f32_16x16x32_bf16 v[32:35], v[136:139], a[160:163], v[32:35]
  v_mfma_f32_16x16x32_bf16 v[32:35], v[140:143], a[172:175], v[32:35]
  v_mfma_f32_16x16x32_bf16 v[32:35], v[144:147], a[184:187], v[32:35]
  v_mfma_f32_16x16x32_bf16 v[32:35], v[148:151], a[196:199], v[32:35]
  v_mfma_f32_16x16x32_bf16 v[32:35], v[152:155], a[208:211], v[32:35]
  v_mfma_f32_16x16x32_bf16 v[36:39], v[132:135], a[152:155], v[36:39]
  v_mfma_f32_16x16x32_bf16 v[36:39], v[136:139], a[164:167], v[36:39]
  global_load_dwordx4 v[132:135], v1, s[24:25] offset:0 sc1
  global_load_dwordx4 v[136:139], v1, s[24:25] offset:1024 sc1
  v_mfma_f32_16x16x32_bf16 v[36:39], v[140:143], a[176:179], v[36:39]
  v_mfma_f32_16x16x32_bf16 v[36:39], v[144:147], a[188:191], v[36:39]
  v_mfma_f32_16x16x32_bf16 v[36:39], v[148:151], a[200:203], v[36:39]
  v_mfma_f32_16x16x32_bf16 v[36:39], v[152:155], a[212:215], v[36:39]
  global_load_dwordx4 v[140:143], v1, s[24:25] offset:2048 sc1
  global_load_dwordx4 v[144:147], v1, s[24:25] offset:3072 sc1
  s_add_u32 s24, s24, 8192
  s_addc_u32 s25, s25, 0
  s_waitcnt vmcnt(14)
  v_mfma_f32_16x16x32_bf16 v[56:59], a[216:219], v[184:187], 0
  v_mfma_f32_16x16x32_bf16 v[56:59], a[220:223], v[188:191], v[56:59]
  v_mfma_f32_16x16x32_bf16 v[56:59], a[224:227], v[192:195], v[56:59]
  v_mfma_f32_16x16x32_bf16 v[56:59], a[228:231], v[196:199], v[56:59]
  global_load_dwordx4 v[148:151], v1, s[24:25] offset:-4096 sc1
  v_cvt_pk_bf16_f32 v88, v40, v41
  v_mfma_f32_16x16x32_bf16 v[56:59], a[232:235], v[200:203], v[56:59]
  v_cvt_pk_bf16_f32 v89, v42, v43
  v_mfma_f32_16x16x32_bf16 v[56:59], a[236:239], v[204:207], v[56:59]
  v_mfma_f32_16x16x32_bf16 v[60:63], a[216:219], a[0:3], 0
  v_cvt_pk_bf16_f32 v90, v24, v25
  v_mfma_f32_16x16x32_bf16 v[60:63], a[220:223], a[12:15], v[60:63]
  global_load_dwordx4 v[152:155], v1, s[24:25] offset:-3072 sc1
  v_cvt_pk_bf16_f32 v91, v26, v27
  v_mfma_f32_16x16x32_bf16 v[60:63], a[224:227], a[24:27], v[60:63]
  v_mfma_f32_16x16x32_bf16 v[60:63], a[228:231], a[36:39], v[60:63]
  s_cmp_eq_u32 s16, 0
  s_cbranch_scc1 L34_no
  ds_write_b128 v6, v[88:91] offset:0
L34_no:
  v_mfma_f32_16x16x32_bf16 v[60:63], a[232:235], a[48:51], v[60:63]
  s_add_u32 s26, s44, s28
  s_add_u32 s26, s26, 0
  s_add_u32 s26, s26, s16
  buffer_store_dwordx4 v[88:91], v1, s[40:43], s26 offen sc1
  v_mfma_f32_16x16x32_bf16 v[60:63], a[236:239], a[60:63], v[60:63]
  v_mfma_f32_16x16x32_bf16 v[64:67], a[216:219], a[4:7], 0
  v_mfma_f32_16x16x32_bf16 v[64:67], a[220:223], a[16:19], v[64:67]
  v_mfma_f32_16x16x32_bf16 v[64:67], a[224:227], a[28:31], v[64:67]
  v_mfma_f32_16x16x32_bf16 v[64:67], a[228:231], a[40:43], v[64:67]
  v_mfma_f32_16x16x32_bf16 v[64:67], a[232:235], a[52:55], v[64:67]
  v_mfma_f32_16x16x32_bf16 v[64:67], a[236:239], a[64:67], v[64:67]
  v_mfma_f32_16x16x32_bf16 v[68:71], a[216:219], a[8:11], 0
  v_mfma_f32_16x16x32_bf16 v[68:71], a[220:223], a[20:23], v[68:71]
  global_load_dwordx4 a[216:219], v1, s[24:25] offset:-2048 sc1
  global_load_dwordx4 a[220:223], v1, s[24:25] offset:-1024 sc1
  v_mfma_f32_16x16x32_bf16 v[68:71], a[224:227], a[32:35], v[68:71]
  v_mfma_f32_16x16x32_bf16 v[68:71], a[228:231], a[44:47], v[68:71]
  v_mfma_f32_16x16x32_bf16 v[68:71], a[232:235], a[56:59], v[68:71]
  v_mfma_f32_16x16x32_bf16 v[68:71], a[236:239], a[68:71], v[68:71]
  global_load_dwordx4 a[224:227], v1, s[24:25] offset:0 sc1
  global_load_dwordx4 a[228:231], v1, s[24:25] offset:1024 sc1
  s_waitcnt vmcnt(15)
  v_mfma_f32_16x16x32_bf16 v[56:59], a[240:243], v[208:211], v[56:59]
  v_mfma_f32_16x16x32_bf16 v[56:59], a[244:247], v[212:215], v[56:59]
  v_mfma_f32_16x16x32_bf16 v[56:59], a[248:251], v[216:219], v[56:59]
  v_mfma_f32_16x16x32_bf16 v[56:59], a[252:255], v[220:223], v[56:59]
  global_load_dwordx4 a[232:235], v1, s[24:25] offset:2048 sc1
  v_mfma_f32_16x16x32_bf16 v[56:59], v[108:111], v[224:227], v[56:59]
  v_mfma_f32_16x16x32_bf16 v[56:59], v[112:115], v[228:231], v[56:59]
  v_mfma_f32_16x16x32_bf16 v[60:63], a[240:243], a[72:75], v[60:63]
  v_mfma_f32_16x16x32_bf16 v[60:63], a[244:247], a[84:87], v[60:63]
  global_load_dwordx4 a[236:239], v1, s[24:25] offset:3072 sc1
  s_add_u32 s24, s24, 8192
  s_addc_u32 s25, s25, 0
  v_mfma_f32_16x16x32_bf16 v[60:63], a[248:251], a[96:99], v[60:63]
  v_mfma_f32_16x16x32_bf16 v[60:63], a[252:255], a[108:111], v[60:63]
  v_mfma_f32_16x16x32_bf16 v[60:63], v[108:111], a[120:123], v[60:63]
  v_mfma_f32_16x16x32_bf16 v[60:63], v[112:115], a[132:135], v[60:63]
  v_mfma_f32_16x16x32_bf16 v[64:67], a[240:243], a[76:79], v[64:67]
  v_mfma_f32_16x16x32_bf16 v[64:67], a[244:247], a[88:91], v[64:67]
  v_mfma_f32_16x16x32_bf16 v[64:67], a[248:251], a[100:103], v[64:67]
  v_mfma_f32_16x16x32_bf16 v[64:67], a[252:255], a[112:115], v[64:67]
  v_cvt_pk_bf16_f32 v92, v44, v45
  v_mfma_f32_16x16x32_bf16 v[64:67], v[108:111], a[124:127], v[64:67]
  v_cvt_pk_bf16_f32 v93, v46, v47
  v_mfma_f32_16x16x32_bf16 v[64:67], v[112:115], a[136:139], v[64:67]
  v_mfma_f32_16x16x32_bf16 v[68:71], a[240:243], a[80:83], v[68:71]
  v_cvt_pk_bf16_f32 v94, v28, v29
  v_mfma_f32_16x16x32_bf16 v[68:71], a[244:247], a[92:95], v[68:71]
  global_load_dwordx4 a[240:243], v1, s[24:25] offset:-4096 sc1
  global_load_dwordx4 a[244:247], v1, s[24:25] offset:-3072 sc1
  v_cvt_pk_bf16_f32 v95, v30, v31
  v_mfma_f32_16x16x32_bf16 v[68:71], a[248:251], a[104:107], v[68:71]
  v_mfma_f32_16x16x32_bf16 v[68:71], a[252:255], a[116:119], v[68:71]
  s_cmp_eq_u32 s17, 0
  s_cbranch_scc1 L35_no
  ds_write_b128 v7, v[92:95] offset:0
L35_no:
  v_mfma_f32_16x16x32_bf16 v[68:71], v[108:111], a[128:131], v[68:71]
  s_add_u32 s26, s44, s29
  s_add_u32 s26, s26, 0
  s_add_u32 s26, s26, s17
  buffer_store_dwordx4 v[92:95], v1, s[40:43], s26 offen sc1
  v_mfma_f32_16x16x32_bf16 v[68:71], v[112:115], a[140:143], v[68:71]
  global_load_dwordx4 a[248:251], v1, s[24:25] offset:-2048 sc1
  global_load_dwordx4 a[252:255], v1, s[24:25] offset:-1024 sc1
  s_waitcnt vmcnt(16)
  v_mfma_f32_16x16x32_bf16 v[56:59], v[116:119], v[232:235], v[56:59]
  v_mfma_f32_16x16x32_bf16 v[56:59], v[120:123], v[236:239], v[56:59]
  v_mfma_f32_16x16x32_bf16 v[56:59], v[124:127], v[240:243], v[56:59]
  v_mfma_f32_16x16x32_bf16 v[56:59], v[128:131], v[244:247], v[56:59]
  global_load_dwordx4 v[108:111], v1, s[24:25] offset:0 sc1
  v_mfma_f32_16x16x32_bf16 v[56:59], v[132:135], v[248:251], v[56:59]
  v_mfma_f32_16x16x32_bf16 v[56:59], v[136:139], v[252:255], v[56:59]
  v_mfma_f32_16x16x32_bf16 v[60:63], v[116:119], a[144:147], v[60:63]
  v_mfma_f32_16x16x32_bf16 v[60:63], v[120:123], a[156:159], v[60:63]
  global_load_dwordx4 v[112:115], v1, s[24:25] offset:1024 sc1
  v_mfma_f32_16x16x32_bf16 v[60:63], v[124:127], a[168:171], v[60:63]
  v_mfma_f32_16x16x32_bf16 v[60:63], v[128:131], a[180:183], v[60:63]
  v_mfma_f32_16x16x32_bf16 v[60:63], v[132:135], a[192:195], v[60:63]
  v_mfma_f32_16x16x32_bf16 v[60:63], v[136:139], a[204:207], v[60:63]
  v_mfma_f32_16x16x32_bf16 v[64:67], v[116:119], a[148:151], v[64:67]
  v_mfma_f32_16x16x32_bf16 v[64:67], v[120:123], a[160:163], v[64:67]
  v_mfma_f32_16x16x32_bf16 v[64:67], v[124:127], a[172:175], v[64:67]
  v_mfma_f32_16x16x32_bf16 v[64:67], v[128:131], a[184:187], v[64:67]
  v_mfma_f32_16x16x32_bf16 v[64:67], v[132:135], a[196:199], v[64:67]
  v_mfma_f32_16x16x32_bf16 v[64:67], v[136:139], a[208:211], v[64:67]
  v_mfma_f32_16x16x32_bf16 v[68:71], v[116:119], a[152:155], v[68:71]
  v_mfma_f32_16x16x32_bf16 v[68:71], v[120:123], a[164:167], v[68:71]
  global_load_dwordx4 v[116:119], v1, s[24:25] offset:2048 sc1
  global_load_dwordx4 v[120:123], v1, s[24:25] offset:3072 sc1
  s_add_u32 s24, s24, 8192
  s_addc_u32 s25, s25, 0
  v_mfma_f32_16x16x32_bf16 v[68:71], v[124:127], a[176:179], v[68:71]
  v_mfma_f32_16x16x32_bf16 v[68:71], v[128:131], a[188:191], v[68:71]
  v_mfma_f32_16x16x32_bf16 v[68:71], v[132:135], a[200:203], v[68:71]
  v_mfma_f32_16x16x32_bf16 v[68:71], v[136:139], a[212:215], v[68:71]
  global_load_dwordx4 v[124:127], v1, s[24:25] offset:-4096 sc1
  global_load_dwordx4 v[128:131], v1, s[24:25] offset:-3072 sc1
  s_waitcnt vmcnt(15)
  v_mfma_f32_16x16x32_bf16 v[72:75], v[140:143], v[184:187], 0
  v_mfma_f32_16x16x32_bf16 v[72:75], v[144:147], v[188:191], v[72:75]
  v_mfma_f32_16x16x32_bf16 v[72:75], v[148:151], v[192:195], v[72:75]
  v_mfma_f32_16x16x32_bf16 v[72:75], v[152:155], v[196:199], v[72:75]
  global_load_dwordx4 v[132:135], v1, s[24:25] offset:-2048 sc1
  v_cvt_pk_bf16_f32 v88, v48, v49
  v_mfma_f32_16x16x32_bf16 v[72:75], a[216:219], v[200:203], v[72:75]
  v_cvt_pk_bf16_f32 v89, v50, v51
  v_mfma_f32_16x16x32_bf16 v[72:75], a[220:223], v[204:207], v[72:75]
  v_mfma_f32_16x16x32_bf16 v[76:79], v[140:143], a[0:3], 0
  v_cvt_pk_bf16_f32 v90, v32, v33
  v_mfma_f32_16x16x32_bf16 v[76:79], v[144:147], a[12:15], v[76:79]
  global_load_dwordx4 v[136:139], v1, s[24:25] offset:-1024 sc1
  v_cvt_pk_bf16_f32 v91, v34, v35
  v_mfma_f32_16x16x32_bf16 v[76:79], v[148:151], a[24:27], v[76:79]
  v_mfma_f32_16x16x32_bf16 v[76:79], v[152:155], a[36:39], v[76:79]
  s_cmp_eq_u32 s18, 0
  s_cbranch_scc1 L36_no
  ds_write_b128 v8, v[88:91] offset:0
L36_no:
  v_mfma_f32_16x16x32_bf16 v[76:79], a[216:219], a[48:51], v[76:79]
  s_add_u32 s26, s44, s30
  s_add_u32 s26, s26, 0
  s_add_u32 s26, s26, s18
  buffer_store_dwordx4 v[88:91], v1, s[40:43], s26 offen sc1
  v_mfma_f32_16x16x32_bf16 v[76:79], a[220:223], a[60:63], v[76:79]
  v_mfma_f32_16x16x32_bf16 v[80:83], v[140:143], a[4:7], 0
  v_mfma_f32_16x16x32_bf16 v[80:83], v[144:147], a[16:19], v[80:83]
  v_mfma_f32_16x16x32_bf16 v[80:83], v[148:151], a[28:31], v[80:83]
  v_mfma_f32_16x16x32_bf16 v[80:83], v[152:155], a[40:43], v[80:83]
  v_mfma_f32_16x16x32_bf16 v[80:83], a[216:219], a[52:55], v[80:83]
  v_mfma_f32_16x16x32_bf16 v[80:83], a[220:223], a[64:67], v[80:83]
  v_mfma_f32_16x16x32_bf16 v[84:87], v[140:143], a[8:11], 0
  v_mfma_f32_16x16x32_bf16 v[84:87], v[144:147], a[20:23], v[84:87]
  global_load_dwordx4 v[140:143], v1, s[24:25] offset:0 sc1
  global_load_dwordx4 v[144:147], v1, s[24:25] offset:1024 sc1
  v_mfma_f32_16x16x32_bf16 v[84:87], v[148:151], a[32:35], v[84:87]
  v_mfma_f32_16x16x32_bf16 v[84:87], v[152:155], a[44:47], v[84:87]
  v_mfma_f32_16x16x32_bf16 v[84:87], a[216:219], a[56:59], v[84:87]
  v_mfma_f32_16x16x32_bf16 v[84:87], a[220:223], a[68:71], v[84:87]
  global_load_dwordx4 v[148:151], v1, s[24:25] offset:2048 sc1
  global_load_dwordx4 v[152:155], v1, s[24:25] offset:3072 sc1
  s_add_u32 s24, s24, 8192
  s_addc_u32 s25, s25, 0
  s_waitcnt vmcnt(16)
  v_mfma_f32_16x16x32_bf16 v[72:75], a[224:227], v[208:211], v[72:75]
  v_mfma_f32_16x16x32_bf16 v[72:75], a[228:231], v[212:215], v[72:75]
  v_mfma_f32_16x16x32_bf16 v[72:75], a[232:235], v[216:219], v[72:75]
  v_mfma_f32_16x16x32_bf16 v[72:75], a[236:239], v[220:223], v[72:75]
  global_load_dwordx4 a[216:219], v1, s[24:25] offset:-4096 sc1
  v_mfma_f32_16x16x32_bf16 v[72:75], a[240:243], v[224:227], v[72:75]
  v_mfma_f32_16x16x32_bf16 v[72:75], a[244:247], v[228:231], v[72:75]
  v_mfma_f32_16x16x32_bf16 v[76:79], a[224:227], a[72:75], v[76:79]
  v_mfma_f32_16x16x32_bf16 v[76:79], a[228:231], a[84:87], v[76:79]
  global_load_dwordx4 a[220:223], v1, s[24:25] offset:-3072 sc1
  v_mfma_f32_16x16x32_bf16 v[76:79], a[232:235], a[96:99], v[76:79]
  v_mfma_f32_16x16x32_bf16 v[76:79], a[236:239], a[108:111], v[76:79]
  v_mfma_f32_16x16x32_bf16 v[76:79], a[240:243], a[120:123], v[76:79]
  v_mfma_f32_16x16x32_bf16 v[76:79], a[244:247], a[132:135], v[76:79]
  v_mfma_f32_16x16x32_bf16 v[80:83], a[224:227], a[76:79], v[80:83]
  v_mfma_f32_16x16x32_bf16 v[80:83], a[228:231], a[88:91], v[80:83]
  v_mfma_f32_16x16x32_bf16 v[80:83], a[232:235], a[100:103], v[80:83]
  v_mfma_f32_16x16x32_bf16 v[80:83], a[236:239], a[112:115], v[80:83]
  v_cvt_pk_bf16_f32 v92, v52, v53
  v_mfma_f32_16x16x32_bf16 v[80:83], a[240:243], a[124:127], v[80:83]
  v_cvt_pk_bf16_f32 v93, v54, v55
  v_mfma_f32_16x16x32_bf16 v[80:83], a[244:247], a[136:139], v[80:83]
  v_mfma_f32_16x16x32_bf16 v[84:87], a[224:227], a[80:83], v[84:87]
  v_cvt_pk_bf16_f32 v94, v36, v37
  v_mfma_f32_16x16x32_bf16 v[84:87], a[228:231], a[92:95], v[84:87]
  global_load_dwordx4 a[224:227], v1, s[24:25] offset:-2048 sc1
  global_load_dwordx4 a[228:231], v1, s[24:25] offset:-1024 sc1
  v_cvt_pk_bf16_f32 v95, v38, v39
  v_mfma_f32_16x16x32_bf16 v[84:87], a[232:235], a[104:107], v[84:87]
  v_mfma_f32_16x16x32_bf16 v[84:87], a[236:239], a[116:119], v[84:87]
  s_cmp_eq_u32 s19, 0
  s_cbranch_scc1 L37_no
  ds_write_b128 v9, v[92:95] offset:0
L37_no:
  v_mfma_f32_16x16x32_bf16 v[84:87], a[240:243], a[128:131], v[84:87]
  s_add_u32 s26, s44, s31
  s_add_u32 s26, s26, 0
  s_add_u32 s26, s26, s19
  buffer_store_dwordx4 v[92:95], v1, s[40:43], s26 offen sc1
  v_mfma_f32_16x16x32_bf16 v[84:87], a[244:247], a[140:143], v[84:87]
  global_load_dwordx4 a[232:235], v1, s[24:25] offset:0 sc1
  global_load_dwordx4 a[236:239], v1, s[24:25] offset:1024 sc1
  s_waitcnt vmcnt(16)
  v_mfma_f32_16x16x32_bf16 v[72:75], a[248:251], v[232:235], v[72:75]
  v_mfma_f32_16x16x32_bf16 v[72:75], a[252:255], v[236:239], v[72:75]
  v_mfma_f32_16x16x32_bf16 v[72:75], v[108:111], v[240:243], v[72:75]
  v_mfma_f32_16x16x32_bf16 v[72:75], v[112:115], v[244:247], v[72:75]
  global_load_dwordx4 a[240:243], v1, s[24:25] offset:2048 sc1
  v_mfma_f32_16x16x32_bf16 v[72:75], v[116:119], v[248:251], v[72:75]
  v_mfma_f32_16x16x32_bf16 v[72:75], v[120:123], v[252:255], v[72:75]
  v_mfma_f32_16x16x32_bf16 v[76:79], a[248:251], a[144:147], v[76:79]
  v_mfma_f32_16x16x32_bf16 v[76:79], a[252:255], a[156:159], v[76:79]
  global_load_dwordx4 a[244:247], v1, s[24:25] offset:3072 sc1
  s_add_u32 s24, s24, 8192
  s_addc_u32 s25, s25, 0
  v_mfma_f32_16x16x32_bf16 v[76:79], v[108:111], a[168:171], v[76:79]
  v_mfma_f32_16x16x32_bf16 v[76:79], v[112:115], a[180:183], v[76:79]
  v_mfma_f32_16x16x32_bf16 v[76:79], v[116:119], a[192:195], v[76:79]
  v_mfma_f32_16x16x32_bf16 v[76:79], v[120:123], a[204:207], v[76:79]
  v_mfma_f32_16x16x32_bf16 v[80:83], a[248:251], a[148:151], v[80:83]
  v_mfma_f32_16x16x32_bf16 v[80:83], a[252:255], a[160:163], v[80:83]
  v_mfma_f32_16x16x32_bf16 v[80:83], v[108:111], a[172:175], v[80:83]
  v_mfma_f32_16x16x32_bf16 v[80:83], v[112:115], a[184:187], v[80:83]
  v_mfma_f32_16x16x32_bf16 v[80:83], v[116:119], a[196:199], v[80:83]
  v_mfma_f32_16x16x32_bf16 v[80:83], v[120:123], a[208:211], v[80:83]
  v_mfma_f32_16x16x32_bf16 v[84:87], a[248:251], a[152:155], v[84:87]
  v_mfma_f32_16x16x32_bf16 v[84:87], a[252:255], a[164:167], v[84:87]
  global_load_dwordx4 a[248:251], v1, s[24:25] offset:-4096 sc1
  global_load_dwordx4 a[252:255], v1, s[24:25] offset:-3072 sc1
  v_mfma_f32_16x16x32_bf16 v[84:87], v[108:111], a[176:179], v[84:87]
  v_mfma_f32_16x16x32_bf16 v[84:87], v[112:115], a[188:191], v[84:87]
  v_mfma_f32_16x16x32_bf16 v[84:87], v[116:119], a[200:203], v[84:87]
  v_mfma_f32_16x16x32_bf16 v[84:87], v[120:123], a[212:215], v[84:87]
  global_load_dwordx4 v[108:111], v1, s[24:25] offset:-2048 sc1
  global_load_dwordx4 v[112:115], v1, s[24:25] offset:-1024 sc1
  s_waitcnt vmcnt(15)
  v_mfma_f32_16x16x32_bf16 v[40:43], v[124:127], v[184:187], 0
  v_mfma_f32_16x16x32_bf16 v[40:43], v[128:131], v[188:191], v[40:43]
  v_mfma_f32_16x16x32_bf16 v[40:43], v[132:135], v[192:195], v[40:43]
  v_mfma_f32_16x16x32_bf16 v[40:43], v[136:139], v[196:199], v[40:43]
  global_load_dwordx4 v[116:119], v1, s[24:25] offset:0 sc1
  v_cvt_pk_bf16_f32 v88, v56, v57
  v_mfma_f32_16x16x32_bf16 v[40:43], v[140:143], v[200:203], v[40:43]
  v_cvt_pk_bf16_f32 v89, v58, v59
  v_mfma_f32_16x16x32_bf16 v[40:43], v[144:147], v[204:207], v[40:43]
  v_mfma_f32_16x16x32_bf16 v[44:47], v[124:127], a[0:3], 0
  v_cvt_pk_bf16_f32 v90, v72, v73
  v_mfma_f32_16x16x32_bf16 v[44:47], v[128:131], a[12:15], v[44:47]
  global_load_dwordx4 v[120:123], v1, s[24:25] offset:1024 sc1
  v_cvt_pk_bf16_f32 v91, v74, v75
  v_mfma_f32_16x16x32_bf16 v[44:47], v[132:135], a[24:27], v[44:47]
  v_mfma_f32_16x16x32_bf16 v[44:47], v[136:139], a[36:39], v[44:47]
  s_cmp_eq_u32 s16, 0
  s_cbranch_scc1 L38_no
  ds_write_b128 v6, v[88:91] offset:2048
L38_no:
  v_mfma_f32_16x16x32_bf16 v[44:47], v[140:143], a[48:51], v[44:47]
  s_add_u32 s26, s44, s28
  s_add_u32 s26, s26, 4096
  s_add_u32 s26, s26, s16
  buffer_store_dwordx4 v[88:91], v1, s[40:43], s26 offen sc1
  v_mfma_f32_16x16x32_bf16 v[44:47], v[144:147], a[60:63], v[44:47]
  v_mfma_f32_16x16x32_bf16 v[48:51], v[124:127], a[4:7], 0
  v_mfma_f32_16x16x32_bf16 v[48:51], v[128:131], a[16:19], v[48:51]
  v_mfma_f32_16x16x32_bf16 v[48:51], v[132:135], a[28:31], v[48:51]
  v_mfma_f32_16x16x32_bf16 v[48:51], v[136:139], a[40:43], v[48:51]
  v_mfma_f32_16x16x32_bf16 v[48:51], v[140:143], a[52:55], v[48:51]
  v_mfma_f32_16x16x32_bf16 v[48:51], v[144:147], a[64:67], v[48:51]
  v_mfma_f32_16x16x32_bf16 v[52:55], v[124:127], a[8:11], 0
  v_mfma_f32_16x16x32_bf16 v[52:55], v[128:131], a[20:23], v[52:55]
  global_load_dwordx4 v[124:127], v1, s[24:25] offset:2048 sc1
  global_load_dwordx4 v[128:131], v1, s[24:25] offset:3072 sc1
  s_add_u32 s24, s24, 8192
  s_addc_u32 s25, s25, 0
  v_mfma_f32_16x16x32_bf16 v[52:55], v[132:135], a[32:35], v[52:55]
  v_mfma_f32_16x16x32_bf16 v[52:55], v[136:139], a[44:47], v[52:55]
  v_mfma_f32_16x16x32_bf16 v[52:55], v[140:143], a[56:59], v[52:55]
  v_mfma_f32_16x16x32_bf16 v[52:55], v[144:147], a[68:71], v[52:55]
  global_load_dwordx4 v[132:135], v1, s[24:25] offset:-4096 sc1
  global_load_dwordx4 v[136:139], v1, s[24:25] offset:-3072 sc1
  s_waitcnt vmcnt(16)
  v_mfma_f32_16x16x32_bf16 v[40:43], v[148:151], v[208:211], v[40:43]
  v_mfma_f32_16x16x32_bf16 v[40:43], v[152:155], v[212:215], v[40:43]
  v_mfma_f32_16x16x32_bf16 v[40:43], a[216:219], v[216:219], v[40:43]
  v_mfma_f32_16x16x32_bf16 v[40:43], a[220:223], v[220:223], v[40:43]
  global_load_dwordx4 v[140:143], v1, s[24:25] offset:-2048 sc1
  v_mfma_f32_16x16x32_bf16 v[40:43], a[224:227], v[224:227], v[40:43]
  v_mfma_f32_16x16x32_bf16 v[40:43], a[228:231], v[228:231], v[40:43]
  v_mfma_f32_16x16x32_bf16 v[44:47], v[148:151], a[72:75], v[44:47]
  v_mfma_f32_16x16x32_bf16 v[44:47], v[152:155], a[84:87], v[44:47]
  global_load_dwordx4 v[144:147], v1, s[24:25] offset:-1024 sc1
  v_mfma_f32_16x16x32_bf16 v[44:47], a[216:219], a[96:99], v[44:47]
  v_mfma_f32_16x16x32_bf16 v[44:47], a[220:223], a[108:111], v[44:47]
  v_mfma_f32_16x16x32_bf16 v[44:47], a[224:227], a[120:123], v[44:47]
  v_mfma_f32_16x16x32_bf16 v[44:47], a[228:231], a[132:135], v[44:47]
  v_mfma_f32_16x16x32_bf16 v[48:51], v[148:151], a[76:79], v[48:51]
  v_mfma_f32_16x16x32_bf16 v[48:51], v[152:155], a[88:91], v[48:51]
  v_mfma_f32_16x16x32_bf16 v[48:51], a[216:219], a[100:103], v[48:51]
  v_mfma_f32_16x16x32_bf16 v[48:51], a[220:223], a[112:115], v[48:51]
  v_cvt_pk_bf16_f32 v92, v60, v61
  v_mfma_f32_16x16x32_bf16 v[48:51], a[224:227], a[124:127], v[48:51]
  v_cvt_pk_bf16_f32 v93, v62, v63
  v_mfma_f32_16x16x32_bf16 v[48:51], a[228:231], a[136:139], v[48:51]
  v_mfma_f32_16x16x32_bf16 v[52:55], v[148:151], a[80:83], v[52:55]
  v_cvt_pk_bf16_f32 v94, v76, v77
  v_mfma_f32_16x16x32_bf16 v[52:55], v[152:155], a[92:95], v[52:55]
  global_load_dwordx4 v[148:151], v1, s[24:25] offset:0 sc1
  global_load_dwordx4 v[152:155], v1, s[24:25] offset:1024 sc1
  v_cvt_pk_bf16_f32 v95, v78, v79
  v_mfma_f32_16x16x32_bf16 v[52:55], a[216:219], a[104:107], v[52:55]
  v_mfma_f32_16x16x32_bf16 v[52:55], a[220:223], a[116:119], v[52:55]
  s_cmp_eq_u32 s17, 0
  s_cbranch_scc1 L39_no
  ds_write_b128 v7, v[92:95] offset:2048
L39_no:
  v_mfma_f32_16x16x32_bf16 v[52:55], a[224:227], a[128:131], v[52:55]
  s_add_u32 s26, s44, s29
  s_add_u32 s26, s26, 4096
  s_add_u32 s26, s26, s17
  buffer_store_dwordx4 v[92:95], v1, s[40:43], s26 offen sc1
  v_mfma_f32_16x16x32_bf16 v[52:55], a[228:231], a[140:143], v[52:55]
  global_load_dwordx4 a[216:219], v1, s[24:25] offset:2048 sc1
  global_load_dwordx4 a[220:223], v1, s[24:25] offset:3072 sc1
  s_add_u32 s24, s24, 8192
  s_addc_u32 s25, s25, 0
  s_waitcnt vmcnt(16)
  v_mfma_f32_16x16x32_bf16 v[40:43], a[232:235], v[232:235], v[40:43]
  v_mfma_f32_16x16x32_bf16 v[40:43], a[236:239], v[236:239], v[40:43]
  v_mfma_f32_16x16x32_bf16 v[40:43], a[240:243], v[240:243], v[40:43]
  v_mfma_f32_16x16x32_bf16 v[40:43], a[244:247], v[244:247], v[40:43]
  global_load_dwordx4 a[224:227], v1, s[24:25] offset:-4096 sc1
  v_mfma_f32_16x16x32_bf16 v[40:43], a[248:251], v[248:251], v[40:43]
  v_mfma_f32_16x16x32_bf16 v[40:43], a[252:255], v[252:255], v[40:43]
  v_mfma_f32_16x16x32_bf16 v[44:47], a[232:235], a[144:147], v[44:47]
  v_mfma_f32_16x16x32_bf16 v[44:47], a[236:239], a[156:159], v[44:47]
  global_load_dwordx4 a[228:231], v1, s[24:25] offset:-3072 sc1
  v_mfma_f32_16x16x32_bf16 v[44:47], a[240:243], a[168:171], v[44:47]
  v_mfma_f32_16x16x32_bf16 v[44:47], a[244:247], a[180:183], v[44:47]
  v_mfma_f32_16x16x32_bf16 v[44:47], a[248:251], a[192:195], v[44:47]
  v_mfma_f32_16x16x32_bf16 v[44:47], a[252:255], a[204:207], v[44:47]
  v_mfma_f32_16x16x32_bf16 v[48:51], a[232:235], a[148:151], v[48:51]
  v_mfma_f32_16x16x32_bf16 v[48:51], a[236:239], a[160:163], v[48:51]
  v_mfma_f32_16x16x32_bf16 v[48:51], a[240:243], a[172:175], v[48:51]
  v_mfma_f32_16x16x32_bf16 v[48:51], a[244:247], a[184:187], v[48:51]
  v_mfma_f32_16x16x32_bf16 v[48:51], a[248:251], a[196:199], v[48:51]
  v_mfma_f32_16x16x32_bf16 v[48:51], a[252:255], a[208:211], v[48:51]
  v_mfma_f32_16x16x32_bf16 v[52:55], a[232:235], a[152:155], v[52:55]
  v_mfma_f32_16x16x32_bf16 v[52:55], a[236:239], a[164:167], v[52:55]
  global_load_dwordx4 a[232:235], v1, s[24:25] offset:-2048 sc1
  global_load_dwordx4 a[236:239], v1, s[24:25] offset:-1024 sc1
  v_mfma_f32_16x16x32_bf16 v[52:55], a[240:243], a[176:179], v[52:55]
  v_mfma_f32_16x16x32_bf16 v[52:55], a[244:247], a[188:191], v[52:55]
  v_mfma_f32_16x16x32_bf16 v[52:55], a[248:251], a[200:203], v[52:55]
  v_mfma_f32_16x16x32_bf16 v[52:55], a[252:255], a[212:215], v[52:55]
  global_load_dwordx4 a[240:243], v1, s[24:25] offset:0 sc1
  global_load_dwordx4 a[244:247], v1, s[24:25] offset:1024 sc1
  s_waitcnt vmcnt(15)
  v_mfma_f32_16x16x32_bf16 v[24:27], v[108:111], v[184:187], 0
  v_mfma_f32_16x16x32_bf16 v[24:27], v[112:115], v[188:191], v[24:27]
  v_mfma_f32_16x16x32_bf16 v[24:27], v[116:119], v[192:195], v[24:27]
  v_mfma_f32_16x16x32_bf16 v[24:27], v[120:123], v[196:199], v[24:27]
  global_load_dwordx4 a[248:251], v1, s[24:25] offset:2048 sc1
  v_cvt_pk_bf16_f32 v88, v64, v65
  v_mfma_f32_16x16x32_bf16 v[24:27], v[124:127], v[200:203], v[24:27]
  v_cvt_pk_bf16_f32 v89, v66, v67
  v_mfma_f32_16x16x32_bf16 v[24:27], v[128:131], v[204:207], v[24:27]
  v_mfma_f32_16x16x32_bf16 v[28:31], v[108:111], a[0:3], 0
  v_cvt_pk_bf16_f32 v90, v80, v81
  v_mfma_f32_16x16x32_bf16 v[28:31], v[112:115], a[12:15], v[28:31]
  global_load_dwordx4 a[252:255], v1, s[24:25] offset:3072 sc1
  s_add_u32 s24, s24, 8192
  s_addc_u32 s25, s25, 0
  v_cvt_pk_bf16_f32 v91, v82, v83
  v_mfma_f32_16x16x32_bf16 v[28:31], v[116:119], a[24:27], v[28:31]
  v_mfma_f32_16x16x32_bf16 v[28:31], v[120:123], a[36:39], v[28:31]
  s_cmp_eq_u32 s18, 0
  s_cbranch_scc1 L40_no
  ds_write_b128 v8, v[88:91] offset:2048
L40_no:
  v_mfma_f32_16x16x32_bf16 v[28:31], v[124:127], a[48:51], v[28:31]
  s_add_u32 s26, s44, s30
  s_add_u32 s26, s26, 4096
  s_add_u32 s26, s26, s18
  buffer_store_dwordx4 v[88:91], v1, s[40:43], s26 offen sc1
  v_mfma_f32_16x16x32_bf16 v[28:31], v[128:131], a[60:63], v[28:31]
  v_mfma_f32_16x16x32_bf16 v[32:35], v[108:111], a[4:7], 0
  v_mfma_f32_16x16x32_bf16 v[32:35], v[112:115], a[16:19], v[32:35]
  v_mfma_f32_16x16x32_bf16 v[32:35], v[116:119], a[28:31], v[32:35]
  v_mfma_f32_16x16x32_bf16 v[32:35], v[120:123], a[40:43], v[32:35]
  v_mfma_f32_16x16x32_bf16 v[32:35], v[124:127], a[52:55], v[32:35]
  v_mfma_f32_16x16x32_bf16 v[32:35], v[128:131], a[64:67], v[32:35]
  v_mfma_f32_16x16x32_bf16 v[36:39], v[108:111], a[8:11], 0
  v_mfma_f32_16x16x32_bf16 v[36:39], v[112:115], a[20:23], v[36:39]
  global_load_dwordx4 v[108:111], v1, s[24:25] offset:-4096 sc1
  global_load_dwordx4 v[112:115], v1, s[24:25] offset:-3072 sc1
  v_mfma_f32_16x16x32_bf16 v[36:39], v[116:119], a[32:35], v[36:39]
  v_mfma_f32_16x16x32_bf16 v[36:39], v[120:123], a[44:47], v[36:39]
  v_mfma_f32_16x16x32_bf16 v[36:39], v[124:127], a[56:59], v[36:39]
  v_mfma_f32_16x16x32_bf16 v[36:39], v[128:131], a[68:71], v[36:39]
  global_load_dwordx4 v[116:119], v1, s[24:25] offset:-2048 sc1
  global_load_dwordx4 v[120:123], v1, s[24:25] offset:-1024 sc1
  s_waitcnt vmcnt(16)
  v_mfma_f32_16x16x32_bf16 v[24:27], v[132:135], v[208:211], v[24:27]
  v_mfma_f32_16x16x32_bf16 v[24:27], v[136:139], v[212:215], v[24:27]
  v_mfma_f32_16x16x32_bf16 v[24:27], v[140:143], v[216:219], v[24:27]
  v_mfma_f32_16x16x32_bf16 v[24:27], v[144:147], v[220:223], v[24:27]
  global_load_dwordx4 v[124:127], v1, s[24:25] offset:0 sc1
  v_mfma_f32_16x16x32_bf16 v[24:27], v[148:151], v[224:227], v[24:27]
  v_mfma_f32_16x16x32_bf16 v[24:27], v[152:155], v[228:231], v[24:27]
  v_mfma_f32_16x16x32_bf16 v[28:31], v[132:135], a[72:75], v[28:31]
  v_mfma_f32_16x16x32_bf16 v[28:31], v[136:139], a[84:87], v[28:31]
  global_load_dwordx4 v[128:131], v1, s[24:25] offset:1024 sc1
  v_mfma_f32_16x16x32_bf16 v[28:31], v[140:143], a[96:99], v[28:31]
  v_mfma_f32_16x16x32_bf16 v[28:31], v[144:147], a[108:111], v[28:31]
  v_mfma_f32_16x16x32_bf16 v[28:31], v[148:151], a[120:123], v[28:31]
  v_mfma_f32_16x16x32_bf16 v[28:31], v[152:155], a[132:135], v[28:31]
  v_mfma_f32_16x16x32_bf16 v[32:35], v[132:135], a[76:79], v[32:35]
  v_mfma_f32_16x16x32_bf16 v[32:35], v[136:139], a[88:91], v[32:35]
  v_mfma_f32_16x16x32_bf16 v[32:35], v[140:143], a[100:103], v[32:35]
  v_mfma_f32_16x16x32_bf16 v[32:35], v[144:147], a[112:115], v[32:35]
  v_cvt_pk_bf16_f32 v92, v68, v69
  v_mfma_f32_16x16x32_bf16 v[32:35], v[148:151], a[124:127], v[32:35]
  v_cvt_pk_bf16_f32 v93, v70, v71
  v_mfma_f32_16x16x32_bf16 v[32:35], v[152:155], a[136:139], v[32:35]
  v_mfma_f32_16x16x32_bf16 v[36:39], v[132:135], a[80:83], v[36:39]
  v_cvt_pk_bf16_f32 v94, v84, v85
  v_mfma_f32_16x16x32_bf16 v[36:39], v[136:139], a[92:95], v[36:39]
  global_load_dwordx4 v[132:135], v1, s[24:25] offset:2048 sc1
  global_load_dwordx4 v[136:139], v1, s[24:25] offset:3072 sc1
  s_add_u32 s24, s24, 8192
  s_addc_u32 s25, s25, 0
  v_cvt_pk_bf16_f32 v95, v86, v87
  v_mfma_f32_16x16x32_bf16 v[36:39], v[140:143], a[104:107], v[36:39]
  v_mfma_f32_16x16x32_bf16 v[36:39], v[144:147], a[116:119], v[36:39]
  s_cmp_eq_u32 s19, 0
  s_cbranch_scc1 L41_no
  ds_write_b128 v9, v[92:95] offset:2048
L41_no:
  v_mfma_f32_16x16x32_bf16 v[36:39], v[148:151], a[128:131], v[36:39]
  s_add_u32 s26, s44, s31
  s_add_u32 s26, s26, 4096
  s_add_u32 s26, s26, s19
  buffer_store_dwordx4 v[92:95], v1, s[40:43], s26 offen sc1
  v_mfma_f32_16x16x32_bf16 v[36:39], v[152:155], a[140:143], v[36:39]
  global_load_dwordx4 v[140:143], v1, s[24:25] offset:-4096 sc1
  global_load_dwordx4 v[144:147], v1, s[24:25] offset:-3072 sc1
  s_waitcnt vmcnt(16)
  v_mfma_f32_16x16x32_bf16 v[24:27], a[216:219], v[232:235], v[24:27]
  v_mfma_f32_16x16x32_bf16 v[24:27], a[220:223], v[236:239], v[24:27]
  v_mfma_f32_16x16x32_bf16 v[24:27], a[224:227], v[240:243], v[24:27]
  v_mfma_f32_16x16x32_bf16 v[24:27], a[228:231], v[244:247], v[24:27]
  global_load_dwordx4 v[148:151], v1, s[24:25] offset:-2048 sc1
  v_mfma_f32_16x16x32_bf16 v[24:27], a[232:235], v[248:251], v[24:27]
  v_mfma_f32_16x16x32_bf16 v[24:27], a[236:239], v[252:255], v[24:27]
  v_mfma_f32_16x16x32_bf16 v[28:31], a[216:219], a[144:147], v[28:31]
  v_mfma_f32_16x16x32_bf16 v[28:31], a[220:223], a[156:159], v[28:31]
  global_load_dwordx4 v[152:155], v1, s[24:25] offset:-1024 sc1
  v_mfma_f32_16x16x32_bf16 v[28:31], a[224:227], a[168:171], v[28:31]
  v_mfma_f32_16x16x32_bf16 v[28:31], a[228:231], a[180:183], v[28:31]
  v_mfma_f32_16x16x32_bf16 v[28:31], a[232:235], a[192:195], v[28:31]
  v_mfma_f32_16x16x32_bf16 v[28:31], a[236:239], a[204:207], v[28:31]
  v_mfma_f32_16x16x32_bf16 v[32:35], a[216:219], a[148:151], v[32:35]
  v_mfma_f32_16x16x32_bf16 v[32:35], a[220:223], a[160:163], v[32:35]
  v_mfma_f32_16x16x32_bf16 v[32:35], a[224:227], a[172:175], v[32:35]
  v_mfma_f32_16x16x32_bf16 v[32:35], a[228:231], a[184:187], v[32:35]
  v_mfma_f32_16x16x32_bf16 v[32:35], a[232:235], a[196:199], v[32:35]
  v_mfma_f32_16x16x32_bf16 v[32:35], a[236:239], a[208:211], v[32:35]
  v_mfma_f32_16x16x32_bf16 v[36:39], a[216:219], a[152:155], v[36:39]
  v_mfma_f32_16x16x32_bf16 v[36:39], a[220:223], a[164:167], v[36:39]
  global_load_dwordx4 a[216:219], v1, s[24:25] offset:0 sc1
  global_load_dwordx4 a[220:223], v1, s[24:25] offset:1024 sc1
  v_mfma_f32_16x16x32_bf16 v[36:39], a[224:227], a[176:179], v[36:39]
  v_mfma_f32_16x16x32_bf16 v[36:39], a[228:231], a[188:191], v[36:39]
  v_mfma_f32_16x16x32_bf16 v[36:39], a[232:235], a[200:203], v[36:39]
  v_mfma_f32_16x16x32_bf16 v[36:39], a[236:239], a[212:215], v[36:39]
  global_load_dwordx4 a[224:227], v1, s[24:25] offset:2048 sc1
  global_load_dwordx4 a[228:231], v1, s[24:25] offset:3072 sc1
  s_add_u32 s24, s24, 8192
  s_addc_u32 s25, s25, 0
  s_waitcnt vmcnt(15)
  v_mfma_f32_16x16x32_bf16 v[56:59], a[240:243], v[184:187], 0
  v_mfma_f32_16x16x32_bf16 v[56:59], a[244:247], v[188:191], v[56:59]
  v_mfma_f32_16x16x32_bf16 v[56:59], a[248:251], v[192:195], v[56:59]
  v_mfma_f32_16x16x32_bf16 v[56:59], a[252:255], v[196:199], v[56:59]
  global_load_dwordx4 a[232:235], v1, s[24:25] offset:-4096 sc1
  v_cvt_pk_bf16_f32 v88, v40, v41
  v_mfma_f32_16x16x32_bf16 v[56:59], v[108:111], v[200:203], v[56:59]
  v_cvt_pk_bf16_f32 v89, v42, v43
  v_mfma_f32_16x16x32_bf16 v[56:59], v[112:115], v[204:207], v[56:59]
  v_mfma_f32_16x16x32_bf16 v[60:63], a[240:243], a[0:3], 0
  v_cvt_pk_bf16_f32 v90, v24, v25
  v_mfma_f32_16x16x32_bf16 v[60:63], a[244:247], a[12:15], v[60:63]
  global_load_dwordx4 a[236:239], v1, s[24:25] offset:-3072 sc1
  v_cvt_pk_bf16_f32 v91, v26, v27
  v_mfma_f32_16x16x32_bf16 v[60:63], a[248:251], a[24:27], v[60:63]
  v_mfma_f32_16x16x32_bf16 v[60:63], a[252:255], a[36:39], v[60:63]
  s_cmp_eq_u32 s16, 0
  s_cbranch_scc1 L42_no
  ds_write_b128 v6, v[88:91] offset:4096
L42_no:
  v_mfma_f32_16x16x32_bf16 v[60:63], v[108:111], a[48:51], v[60:63]
  s_add_u32 s26, s44, s28
  s_add_u32 s26, s26, 8192
  s_add_u32 s26, s26, s16
  buffer_store_dwordx4 v[88:91], v1, s[40:43], s26 offen sc1
  v_mfma_f32_16x16x32_bf16 v[60:63], v[112:115], a[60:63], v[60:63]
  v_mfma_f32_16x16x32_bf16 v[64:67], a[240:243], a[4:7], 0
  v_mfma_f32_16x16x32_bf16 v[64:67], a[244:247], a[16:19], v[64:67]
  v_mfma_f32_16x16x32_bf16 v[64:67], a[248:251], a[28:31], v[64:67]
  v_mfma_f32_16x16x32_bf16 v[64:67], a[252:255], a[40:43], v[64:67]
  v_mfma_f32_16x16x32_bf16 v[64:67], v[108:111], a[52:55], v[64:67]
  v_mfma_f32_16x16x32_bf16 v[64:67], v[112:115], a[64:67], v[64:67]
  v_mfma_f32_16x16x32_bf16 v[68:71], a[240:243], a[8:11], 0
  v_mfma_f32_16x16x32_bf16 v[68:71], a[244:247], a[20:23], v[68:71]
  global_load_dwordx4 a[240:243], v1, s[24:25] offset:-2048 sc1
  global_load_dwordx4 a[244:247], v1, s[24:25] offset:-1024 sc1
  v_mfma_f32_16x16x32_bf16 v[68:71], a[248:251], a[32:35], v[68:71]
  v_mfma_f32_16x16x32_bf16 v[68:71], a[252:255], a[44:47], v[68:71]
  v_mfma_f32_16x16x32_bf16 v[68:71], v[108:111], a[56:59], v[68:71]
  v_mfma_f32_16x16x32_bf16 v[68:71], v[112:115], a[68:71], v[68:71]
  global_load_dwordx4 a[248:251], v1, s[24:25] offset:0 sc1
  global_load_dwordx4 a[252:255], v1, s[24:25] offset:1024 sc1
  s_waitcnt vmcnt(16)
  v_mfma_f32_16x16x32_bf16 v[56:59], v[116:119], v[208:211], v[56:59]
  v_mfma_f32_16x16x32_bf16 v[56:59], v[120:123], v[212:215], v[56:59]
  v_mfma_f32_16x16x32_bf16 v[56:59], v[124:127], v[216:219], v[56:59]
  v_mfma_f32_16x16x32_bf16 v[56:59], v[128:131], v[220:223], v[56:59]
  global_load_dwordx4 v[108:111], v1, s[24:25] offset:2048 sc1
  v_mfma_f32_16x16x32_bf16 v[56:59], v[132:135], v[224:227], v[56:59]
  v_mfma_f32_16x16x32_bf16 v[56:59], v[136:139], v[228:231], v[56:59]
  v_mfma_f32_16x16x32_bf16 v[60:63], v[116:119], a[72:75], v[60:63]
  v_mfma_f32_16x16x32_bf16 v[60:63], v[120:123], a[84:87], v[60:63]
  global_load_dwordx4 v[112:115], v1, s[24:25] offset:3072 sc1
  s_add_u32 s24, s24, 8192
  s_addc_u32 s25, s25, 0
  v_mfma_f32_16x16x32_bf16 v[60:63], v[124:127], a[96:99], v[60:63]
  v_mfma_f32_16x16x32_bf16 v[60:63], v[128:131], a[108:111], v[60:63]
  v_mfma_f32_16x16x32_bf16 v[60:63], v[132:135], a[120:123], v[60:63]
  v_mfma_f32_16x16x32_bf16 v[60:63], v[136:139], a[132:135], v[60:63]
  v_mfma_f32_16x16x32_bf16 v[64:67], v[116:119], a[76:79], v[64:67]
  v_mfma_f32_16x16x32_bf16 v[64:67], v[120:123], a[88:91], v[64:67]
  v_mfma_f32_16x16x32_bf16 v[64:67], v[124:127], a[100:103], v[64:67]
  v_mfma_f32_16x16x32_bf16 v[64:67], v[128:131], a[112:115], v[64:67]
  v_cvt_pk_bf16_f32 v92, v44, v45
  v_mfma_f32_16x16x32_bf16 v[64:67], v[132:135], a[124:127], v[64:67]
  v_cvt_pk_bf16_f32 v93, v46, v47
  v_mfma_f32_16x16x32_bf16 v[64:67], v[136:139], a[136:139], v[64:67]
  v_mfma_f32_16x16x32_bf16 v[68:71], v[116:119], a[80:83], v[68:71]
  v_cvt_pk_bf16_f32 v94, v28, v29
  v_mfma_f32_16x16x32_bf16 v[68:71], v[120:123], a[92:95], v[68:71]
  global_load_dwordx4 v[116:119], v1, s[24:25] offset:-4096 sc1
  global_load_dwordx4 v[120:123], v1, s[24:25] offset:-3072 sc1
  v_cvt_pk_bf16_f32 v95, v30, v31
  v_mfma_f32_16x16x32_bf16 v[68:71], v[124:127], a[104:107], v[68:71]
  v_mfma_f32_16x16x32_bf16 v[68:71], v[128:131], a[116:119], v[68:71]
  s_cmp_eq_u32 s17, 0
  s_cbranch_scc1 L43_no
  ds_write_b128 v7, v[92:95] offset:4096
L43_no:
  v_mfma_f32_16x16x32_bf16 v[68:71], v[132:135], a[128:131], v[68:71]
  s_add_u32 s26, s44, s29
  s_add_u32 s26, s26, 8192
  s_add_u32 s26, s26, s17
  buffer_store_dwordx4 v[92:95], v1, s[40:43], s26 offen sc1
  v_mfma_f32_16x16x32_bf16 v[68:71], v[136:139], a[140:143], v[68:71]
  global_load_dwordx4 v[124:127], v1, s[24:25] offset:-2048 sc1
  global_load_dwordx4 v[128:131], v1, s[24:25] offset:-1024 sc1
  s_waitcnt vmcnt(16)
  v_mfma_f32_16x16x32_bf16 v[56:59], v[140:143], v[232:235], v[56:59]
  v_mfma_f32_16x16x32_bf16 v[56:59], v[144:147], v[236:239], v[56:59]
  v_mfma_f32_16x16x32_bf16 v[56:59], v[148:151], v[240:243], v[56:59]
  v_mfma_f32_16x16x32_bf16 v[56:59], v[152:155], v[244:247], v[56:59]
  global_load_dwordx4 v[132:135], v1, s[24:25] offset:0 sc1
  v_mfma_f32_16x16x32_bf16 v[56:59], a[216:219], v[248:251], v[56:59]
  v_mfma_f32_16x16x32_bf16 v[56:59], a[220:223], v[252:255], v[56:59]
  v_mfma_f32_16x16x32_bf16 v[60:63], v[140:143], a[144:147], v[60:63]
  v_mfma_f32_16x16x32_bf16 v[60:63], v[144:147], a[156:159], v[60:63]
  global_load_dwordx4 v[136:139], v1, s[24:25] offset:1024 sc1
  v_mfma_f32_16x16x32_bf16 v[60:63], v[148:151], a[168:171], v[60:63]
  v_mfma_f32_16x16x32_bf16 v[60:63], v[152:155], a[180:183], v[60:63]
  v_mfma_f32_16x16x32_bf16 v[60:63], a[216:219], a[192:195], v[60:63]
  v_mfma_f32_16x16x32_bf16 v[60:63], a[220:223], a[204:207], v[60:63]
  v_mfma_f32_16x16x32_bf16 v[64:67], v[140:143], a[148:151], v[64:67]
  v_mfma_f32_16x16x32_bf16 v[64:67], v[144:147], a[160:163], v[64:67]
  v_mfma_f32_16x16x32_bf16 v[64:67], v[148:151], a[172:175], v[64:67]
  v_mfma_f32_16x16x32_bf16 v[64:67], v[152:155], a[184:187], v[64:67]
  v_mfma_f32_16x16x32_bf16 v[64:67], a[216:219], a[196:199], v[64:67]
  v_mfma_f32_16x16x32_bf16 v[64:67], a[220:223], a[208:211], v[64:67]
  v_mfma_f32_16x16x32_bf16 v[68:71], v[140:143], a[152:155], v[68:71]
  v_mfma_f32_16x16x32_bf16 v[68:71], v[144:147], a[164:167], v[68:71]
  global_load_dwordx4 v[140:143], v1, s[24:25] offset:2048 sc1
  global_load_dwordx4 v[144:147], v1, s[24:25] offset:3072 sc1
  s_add_u32 s24, s24, 8192
  s_addc_u32 s25, s25, 0
  v_mfma_f32_16x16x32_bf16 v[68:71], v[148:151], a[176:179], v[68:71]
  v_mfma_f32_16x16x32_bf16 v[68:71], v[152:155], a[188:191], v[68:71]
  v_mfma_f32_16x16x32_bf16 v[68:71], a[216:219], a[200:203], v[68:71]
  v_mfma_f32_16x16x32_bf16 v[68:71], a[220:223], a[212:215], v[68:71]
  global_load_dwordx4 v[148:151], v1, s[24:25] offset:-4096 sc1
  global_load_dwordx4 v[152:155], v1, s[24:25] offset:-3072 sc1
  s_waitcnt vmcnt(15)
  v_mfma_f32_16x16x32_bf16 v[72:75], a[224:227], v[184:187], 0
  v_mfma_f32_16x16x32_bf16 v[72:75], a[228:231], v[188:191], v[72:75]
  v_mfma_f32_16x16x32_bf16 v[72:75], a[232:235], v[192:195], v[72:75]
  v_mfma_f32_16x16x32_bf16 v[72:75], a[236:239], v[196:199], v[72:75]
  global_load_dwordx4 a[216:219], v1, s[24:25] offset:-2048 sc1
  v_cvt_pk_bf16_f32 v88, v48, v49
  v_mfma_f32_16x16x32_bf16 v[72:75], a[240:243], v[200:203], v[72:75]
  v_cvt_pk_bf16_f32 v89, v50, v51
  v_mfma_f32_16x16x32_bf16 v[72:75], a[244:247], v[204:207], v[72:75]
  v_mfma_f32_16x16x32_bf16 v[76:79], a[224:227], a[0:3], 0
  v_cvt_pk_bf16_f32 v90, v32, v33
  v_mfma_f32_16x16x32_bf16 v[76:79], a[228:231], a[12:15], v[76:79]
  global_load_dwordx4 a[220:223], v1, s[24:25] offset:-1024 sc1
  v_cvt_pk_bf16_f32 v91, v34, v35
  v_mfma_f32_16x16x32_bf16 v[76:79], a[232:235], a[24:27], v[76:79]
  v_mfma_f32_16x16x32_bf16 v[76:79], a[236:239], a[36:39], v[76:79]
  s_cmp_eq_u32 s18, 0
  s_cbranch_scc1 L44_no
  ds_write_b128 v8, v[88:91] offset:4096
L44_no:
  v_mfma_f32_16x16x32_bf16 v[76:79], a[240:243], a[48:51], v[76:79]
  s_add_u32 s26, s44, s30
  s_add_u32 s26, s26, 8192
  s_add_u32 s26, s26, s18
  buffer_store_dwordx4 v[88:91], v1, s[40:43], s26 offen sc1
  v_mfma_f32_16x16x32_bf16 v[76:79], a[244:247], a[60:63], v[76:79]
  v_mfma_f32_16x16x32_bf16 v[80:83], a[224:227], a[4:7], 0
  v_mfma_f32_16x16x32_bf16 v[80:83], a[228:231], a[16:19], v[80:83]
  v_mfma_f32_16x16x32_bf16 v[80:83], a[232:235], a[28:31], v[80:83]
  v_mfma_f32_16x16x32_bf16 v[80:83], a[236:239], a[40:43], v[80:83]
  v_mfma_f32_16x16x32_bf16 v[80:83], a[240:243], a[52:55], v[80:83]
  v_mfma_f32_16x16x32_bf16 v[80:83], a[244:247], a[64:67], v[80:83]
  v_mfma_f32_16x16x32_bf16 v[84:87], a[224:227], a[8:11], 0
  v_mfma_f32_16x16x32_bf16 v[84:87], a[228:231], a[20:23], v[84:87]
  global_load_dwordx4 a[224:227], v1, s[24:25] offset:0 sc1
  global_load_dwordx4 a[228:231], v1, s[24:25] offset:1024 sc1
  v_mfma_f32_16x16x32_bf16 v[84:87], a[232:235], a[32:35], v[84:87]
  v_mfma_f32_16x16x32_bf16 v[84:87], a[236:239], a[44:47], v[84:87]
  v_mfma_f32_16x16x32_bf16 v[84:87], a[240:243], a[56:59], v[84:87]
  v_mfma_f32_16x16x32_bf16 v[84:87], a[244:247], a[68:71], v[84:87]
  global_load_dwordx4 a[232:235], v1, s[24:25] offset:2048 sc1
  global_load_dwordx4 a[236:239], v1, s[24:25] offset:3072 sc1
  s_add_u32 s24, s24, 8192
  s_addc_u32 s25, s25, 0
  s_waitcnt vmcnt(16)
  v_mfma_f32_16x16x32_bf16 v[72:75], a[248:251], v[208:211], v[72:75]
  v_mfma_f32_16x16x32_bf16 v[72:75], a[252:255], v[212:215], v[72:75]
  v_mfma_f32_16x16x32_bf16 v[72:75], v[108:111], v[216:219], v[72:75]
  v_mfma_f32_16x16x32_bf16 v[72:75], v[112:115], v[220:223], v[72:75]
  global_load_dwordx4 a[240:243], v1, s[24:25] offset:-4096 sc1
  v_mfma_f32_16x16x32_bf16 v[72:75], v[116:119], v[224:227], v[72:75]
  v_mfma_f32_16x16x32_bf16 v[72:75], v[120:123], v[228:231], v[72:75]
  v_mfma_f32_16x16x32_bf16 v[76:79], a[248:251], a[72:75], v[76:79]
  v_mfma_f32_16x16x32_bf16 v[76:79], a[252:255], a[84:87], v[76:79]
  global_load_dwordx4 a[244:247], v1, s[24:25] offset:-3072 sc1
  v_mfma_f32_16x16x32_bf16 v[76:79], v[108:111], a[96:99], v[76:79]
  v_mfma_f32_16x16x32_bf16 v[76:79], v[112:115], a[108:111], v[76:79]
  v_mfma_f32_16x16x32_bf16 v[76:79], v[116:119], a[120:123], v[76:79]
  v_mfma_f32_16x16x32_bf16 v[76:79], v[120:123], a[132:135], v[76:79]
  v_mfma_f32_16x16x32_bf16 v[80:83], a[248:251], a[76:79], v[80:83]
  v_mfma_f32_16x16x32_bf16 v[80:83], a[252:255], a[88:91], v[80:83]
  v_mfma_f32_16x16x32_bf16 v[80:83], v[108:111], a[100:103], v[80:83]
  v_mfma_f32_16x16x32_bf16 v[80:83], v[112:115], a[112:115], v[80:83]
  v_cvt_pk_bf16_f32 v92, v52, v53
  v_mfma_f32_16x16x32_bf16 v[80:83], v[116:119], a[124:127], v[80:83]
  v_cvt_pk_bf16_f32 v93, v54, v55
  v_mfma_f32_16x16x32_bf16 v[80:83], v[120:123], a[136:139], v[80:83]
  v_mfma_f32_16x16x32_bf16 v[84:87], a[248:251], a[80:83], v[84:87]
  v_cvt_pk_bf16_f32 v94, v36, v37
  v_mfma_f32_16x16x32_bf16 v[84:87], a[252:255], a[92:95], v[84:87]
  global_load_dwordx4 a[248:251], v1, s[24:25] offset:-2048 sc1
  global_load_dwordx4 a[252:255], v1, s[24:25] offset:-1024 sc1
  v_cvt_pk_bf16_f32 v95, v38, v39
  v_mfma_f32_16x16x32_bf16 v[84:87], v[108:111], a[104:107], v[84:87]
  v_mfma_f32_16x16x32_bf16 v[84:87], v[112:115], a[116:119], v[84:87]
  s_cmp_eq_u32 s19, 0
  s_cbranch_scc1 L45_no
  ds_write_b128 v9, v[92:95] offset:4096
L45_no:
  v_mfma_f32_16x16x32_bf16 v[84:87], v[116:119], a[128:131], v[84:87]
  s_add_u32 s26, s44, s31
  s_add_u32 s26, s26, 8192
  s_add_u32 s26, s26, s19
  buffer_store_dwordx4 v[92:95], v1, s[40:43], s26 offen sc1
  v_mfma_f32_16x16x32_bf16 v[84:87], v[120:123], a[140:143], v[84:87]
  global_load_dwordx4 v[108:111], v1, s[24:25] offset:0 sc1
  global_load_dwordx4 v[112:115], v1, s[24:25] offset:1024 sc1
  s_waitcnt vmcnt(16)
  v_mfma_f32_16x16x32_bf16 v[72:75], v[124:127], v[232:235], v[72:75]
  v_mfma_f32_16x16x32_bf16 v[72:75], v[128:131], v[236:239], v[72:75]
  v_mfma_f32_16x16x32_bf16 v[72:75], v[132:135], v[240:243], v[72:75]
  v_mfma_f32_16x16x32_bf16 v[72:75], v[136:139], v[244:247], v[72:75]
  global_load_dwordx4 v[116:119], v1, s[24:25] offset:2048 sc1
  v_mfma_f32_16x16x32_bf16 v[72:75], v[140:143], v[248:251], v[72:75]
  v_mfma_f32_16x16x32_bf16 v[72:75], v[144:147], v[252:255], v[72:75]
  v_mfma_f32_16x16x32_bf16 v[76:79], v[124:127], a[144:147], v[76:79]
  v_mfma_f32_16x16x32_bf16 v[76:79], v[128:131], a[156:159], v[76:79]
  global_load_dwordx4 v[120:123], v1, s[24:25] offset:3072 sc1
  s_add_u32 s24, s24, 8192
  s_addc_u32 s25, s25, 0
  v_mfma_f32_16x16x32_bf16 v[76:79], v[132:135], a[168:171], v[76:79]
  v_mfma_f32_16x16x32_bf16 v[76:79], v[136:139], a[180:183], v[76:79]
  v_mfma_f32_16x16x32_bf16 v[76:79], v[140:143], a[192:195], v[76:79]
  v_mfma_f32_16x16x32_bf16 v[76:79], v[144:147], a[204:207], v[76:79]
  v_mfma_f32_16x16x32_bf16 v[80:83], v[124:127], a[148:151], v[80:83]
  v_mfma_f32_16x16x32_bf16 v[80:83], v[128:131], a[160:163], v[80:83]
  v_mfma_f32_16x16x32_bf16 v[80:83], v[132:135], a[172:175], v[80:83]
  v_mfma_f32_16x16x32_bf16 v[80:83], v[136:139], a[184:187], v[80:83]
  v_mfma_f32_16x16x32_bf16 v[80:83], v[140:143], a[196:199], v[80:83]
  v_mfma_f32_16x16x32_bf16 v[80:83], v[144:147], a[208:211], v[80:83]
  v_mfma_f32_16x16x32_bf16 v[84:87], v[124:127], a[152:155], v[84:87]
  v_mfma_f32_16x16x32_bf16 v[84:87], v[128:131], a[164:167], v[84:87]
  global_load_dwordx4 v[124:127], v1, s[24:25] offset:-4096 sc1
  global_load_dwordx4 v[128:131], v1, s[24:25] offset:-3072 sc1
  v_mfma_f32_16x16x32_bf16 v[84:87], v[132:135], a[176:179], v[84:87]
  v_mfma_f32_16x16x32_bf16 v[84:87], v[136:139], a[188:191], v[84:87]
  v_mfma_f32_16x16x32_bf16 v[84:87], v[140:143], a[200:203], v[84:87]
  v_mfma_f32_16x16x32_bf16 v[84:87], v[144:147], a[212:215], v[84:87]
  s_waitcnt vmcnt(13)
  v_mfma_f32_16x16x32_bf16 v[40:43], v[148:151], v[184:187], 0
  v_mfma_f32_16x16x32_bf16 v[40:43], v[152:155], v[188:191], v[40:43]
  s_waitcnt vmcnt(6)
  s_add_u32 s26, s36, 8192
  s_mov_b64 exec, 1
  v_mov_b32 v107, s6
  buffer_store_dword v107, off, s[52:55], s26 sc1
  s_mov_b64 exec, -1
  v_mfma_f32_16x16x32_bf16 v[40:43], a[216:219], v[192:195], v[40:43]
  v_mfma_f32_16x16x32_bf16 v[40:43], a[220:223], v[196:199], v[40:43]
  v_cvt_pk_bf16_f32 v88, v56, v57
  v_mfma_f32_16x16x32_bf16 v[40:43], a[224:227], v[200:203], v[40:43]
  v_cvt_pk_bf16_f32 v89, v58, v59
  v_mfma_f32_16x16x32_bf16 v[40:43], a[228:231], v[204:207], v[40:43]
  v_cvt_pk_bf16_f32 v90, v72, v73
  v_mfma_f32_16x16x32_bf16 v[44:47], v[148:151], a[0:3], 0
  v_cvt_pk_bf16_f32 v91, v74, v75
  v_mfma_f32_16x16x32_bf16 v[44:47], v[152:155], a[12:15], v[44:47]
  s_cmp_eq_u32 s16, 0
  s_cbranch_scc1 L46_no
  ds_write_b128 v6, v[88:91] offset:6144
L46_no:
  v_mfma_f32_16x16x32_bf16 v[44:47], a[216:219], a[24:27], v[44:47]
  v_mfma_f32_16x16x32_bf16 v[44:47], a[220:223], a[36:39], v[44:47]
  s_add_u32 s26, s44, s28
  s_add_u32 s26, s26, 12288
  s_add_u32 s26, s26, s16
  buffer_store_dwordx4 v[88:91], v1, s[40:43], s26 offen sc1
  v_mfma_f32_16x16x32_bf16 v[44:47], a[224:227], a[48:51], v[44:47]
  v_cvt_pk_bf16_f32 v92, v60, v61
  v_mfma_f32_16x16x32_bf16 v[44:47], a[228:231], a[60:63], v[44:47]
  v_cvt_pk_bf16_f32 v93, v62, v63
  v_mfma_f32_16x16x32_bf16 v[48:51], v[148:151], a[4:7], 0
  v_cvt_pk_bf16_f32 v94, v76, v77
  v_mfma_f32_16x16x32_bf16 v[48:51], v[152:155], a[16:19], v[48:51]
  v_cvt_pk_bf16_f32 v95, v78, v79
  v_mfma_f32_16x16x32_bf16 v[48:51], a[216:219], a[28:31], v[48:51]
  v_mfma_f32_16x16x32_bf16 v[48:51], a[220:223], a[40:43], v[48:51]
  s_cmp_eq_u32 s17, 0
  s_cbranch_scc1 L47_no
  ds_write_b128 v7, v[92:95] offset:6144
L47_no:
  v_mfma_f32_16x16x32_bf16 v[48:51], a[224:227], a[52:55], v[48:51]
  s_add_u32 s26, s44, s29
  s_add_u32 s26, s26, 12288
  s_add_u32 s26, s26, s17
  buffer_store_dwordx4 v[92:95], v1, s[40:43], s26 offen sc1
  v_mfma_f32_16x16x32_bf16 v[48:51], a[228:231], a[64:67], v[48:51]
  v_cvt_pk_bf16_f32 v88, v64, v65
  v_mfma_f32_16x16x32_bf16 v[52:55], v[148:151], a[8:11], 0
  v_cvt_pk_bf16_f32 v89, v66, v67
  v_mfma_f32_16x16x32_bf16 v[52:55], v[152:155], a[20:23], v[52:55]
  v_cvt_pk_bf16_f32 v90, v80, v81
  v_mfma_f32_16x16x32_bf16 v[52:55], a[216:219], a[32:35], v[52:55]
  v_mfma_f32_16x16x32_bf16 v[52:55], a[220:223], a[44:47], v[52:55]
  v_cvt_pk_bf16_f32 v91, v82, v83
  v_mfma_f32_16x16x32_bf16 v[52:55], a[224:227], a[56:59], v[52:55]
  s_cmp_eq_u32 s18, 0
  s_cbranch_scc1 L48_no
  ds_write_b128 v8, v[88:91] offset:6144
L48_no:
  v_mfma_f32_16x16x32_bf16 v[52:55], a[228:231], a[68:71], v[52:55]
  s_add_u32 s26, s44, s30
  s_add_u32 s26, s26, 12288
  s_add_u32 s26, s26, s18
  buffer_store_dwordx4 v[88:91], v1, s[40:43], s26 offen sc1
  v_mfma_f32_16x16x32_bf16 v[40:43], a[232:235], v[208:211], v[40:43]
  v_cvt_pk_bf16_f32 v92, v68, v69
  v_mfma_f32_16x16x32_bf16 v[40:43], a[236:239], v[212:215], v[40:43]
  v_cvt_pk_bf16_f32 v93, v70, v71
  v_mfma_f32_16x16x32_bf16 v[40:43], a[240:243], v[216:219], v[40:43]
  v_mfma_f32_16x16x32_bf16 v[40:43], a[244:247], v[220:223], v[40:43]
  v_cvt_pk_bf16_f32 v94, v84, v85
  v_mfma_f32_16x16x32_bf16 v[40:43], a[248:251], v[224:227], v[40:43]
  v_cvt_pk_bf16_f32 v95, v86, v87
  v_mfma_f32_16x16x32_bf16 v[40:43], a[252:255], v[228:231], v[40:43]
  s_cmp_eq_u32 s19, 0
  s_cbranch_scc1 L49_no
  ds_write_b128 v9, v[92:95] offset:6144
L49_no:
  v_mfma_f32_16x16x32_bf16 v[44:47], a[232:235], a[72:75], v[44:47]
  s_add_u32 s26, s44, s31
  s_add_u32 s26, s26, 12288
  s_add_u32 s26, s26, s19
  buffer_store_dwordx4 v[92:95], v1, s[40:43], s26 offen sc1
  v_mfma_f32_16x16x32_bf16 v[44:47], a[236:239], a[84:87], v[44:47]
  v_mfma_f32_16x16x32_bf16 v[44:47], a[240:243], a[96:99], v[44:47]
  v_mfma_f32_16x16x32_bf16 v[44:47], a[244:247], a[108:111], v[44:47]
  v_mfma_f32_16x16x32_bf16 v[44:47], a[248:251], a[120:123], v[44:47]
  v_mfma_f32_16x16x32_bf16 v[44:47], a[252:255], a[132:135], v[44:47]
  v_mfma_f32_16x16x32_bf16 v[48:51], a[232:235], a[76:79], v[48:51]
  v_mfma_f32_16x16x32_bf16 v[48:51], a[236:239], a[88:91], v[48:51]
  v_mfma_f32_16x16x32_bf16 v[48:51], a[240:243], a[100:103], v[48:51]
  v_mfma_f32_16x16x32_bf16 v[48:51], a[244:247], a[112:115], v[48:51]
  v_mfma_f32_16x16x32_bf16 v[48:51], a[248:251], a[124:127], v[48:51]
  v_mfma_f32_16x16x32_bf16 v[48:51], a[252:255], a[136:139], v[48:51]
  v_mfma_f32_16x16x32_bf16 v[52:55], a[232:235], a[80:83], v[52:55]
  v_mfma_f32_16x16x32_bf16 v[52:55], a[236:239], a[92:95], v[52:55]
  v_mfma_f32_16x16x32_bf16 v[52:55], a[240:243], a[104:107], v[52:55]
  v_mfma_f32_16x16x32_bf16 v[52:55], a[244:247], a[116:119], v[52:55]
  v_mfma_f32_16x16x32_bf16 v[52:55], a[248:251], a[128:131], v[52:55]
  v_mfma_f32_16x16x32_bf16 v[52:55], a[252:255], a[140:143], v[52:55]
  s_waitcnt vmcnt(5)
  v_mfma_f32_16x16x32_bf16 v[40:43], v[108:111], v[232:235], v[40:43]
  v_mfma_f32_16x16x32_bf16 v[40:43], v[112:115], v[236:239], v[40:43]
  v_mfma_f32_16x16x32_bf16 v[40:43], v[116:119], v[240:243], v[40:43]
  v_mfma_f32_16x16x32_bf16 v[40:43], v[120:123], v[244:247], v[40:43]
  v_mfma_f32_16x16x32_bf16 v[40:43], v[124:127], v[248:251], v[40:43]
  v_mfma_f32_16x16x32_bf16 v[40:43], v[128:131], v[252:255], v[40:43]
  v_mfma_f32_16x16x32_bf16 v[44:47], v[108:111], a[144:147], v[44:47]
  v_mfma_f32_16x16x32_bf16 v[44:47], v[112:115], a[156:159], v[44:47]
  v_mfma_f32_16x16x32_bf16 v[44:47], v[116:119], a[168:171], v[44:47]
  s_add_u32 s27, s37, 8192
  buffer_load_dword v21, v22, s[52:55], s27 offen sc1
  v_mfma_f32_16x16x32_bf16 v[44:47], v[120:123], a[180:183], v[44:47]
  v_mfma_f32_16x16x32_bf16 v[44:47], v[124:127], a[192:195], v[44:47]
  v_mfma_f32_16x16x32_bf16 v[44:47], v[128:131], a[204:207], v[44:47]
  v_mfma_f32_16x16x32_bf16 v[48:51], v[108:111], a[148:151], v[48:51]
  v_mfma_f32_16x16x32_bf16 v[48:51], v[112:115], a[160:163], v[48:51]
  v_mfma_f32_16x16x32_bf16 v[48:51], v[116:119], a[172:175], v[48:51]
  v_mfma_f32_16x16x32_bf16 v[48:51], v[120:123], a[184:187], v[48:51]
  v_mfma_f32_16x16x32_bf16 v[48:51], v[124:127], a[196:199], v[48:51]
  v_mfma_f32_16x16x32_bf16 v[48:51], v[128:131], a[208:211], v[48:51]
  v_mfma_f32_16x16x32_bf16 v[52:55], v[108:111], a[152:155], v[52:55]
  v_mfma_f32_16x16x32_bf16 v[52:55], v[112:115], a[164:167], v[52:55]
  v_mfma_f32_16x16x32_bf16 v[52:55], v[116:119], a[176:179], v[52:55]
  v_mfma_f32_16x16x32_bf16 v[52:55], v[120:123], a[188:191], v[52:55]
  v_mfma_f32_16x16x32_bf16 v[52:55], v[124:127], a[200:203], v[52:55]
  v_mfma_f32_16x16x32_bf16 v[52:55], v[128:131], a[212:215], v[52:55]
  v_cvt_pk_bf16_f32 v88, v40, v41
  v_cvt_pk_bf16_f32 v89, v42, v43
  v_subrev_u32 v97, 73728, v6
  v_lshrrev_b32 v97, 1, v97
  v_add_u32 v97, 81920, v97
  ds_write_b64 v97, v[88:89]
  s_lshr_b32 s26, s28, 1
  s_add_u32 s26, s26, s45
  s_add_u32 s26, s26, s16
  v_lshrrev_b32 v96, 1, v1
  buffer_store_dwordx2 v[88:89], v96, s[40:43], s26 offen sc1
  v_cvt_pk_bf16_f32 v92, v44, v45
  v_cvt_pk_bf16_f32 v93, v46, v47
  v_subrev_u32 v97, 73728, v7
  v_lshrrev_b32 v97, 1, v97
  v_add_u32 v97, 81920, v97
  ds_write_b64 v97, v[92:93]
  s_lshr_b32 s26, s29, 1
  s_add_u32 s26, s26, s45
  s_add_u32 s26, s26, s17
  v_lshrrev_b32 v96, 1, v1
  buffer_store_dwordx2 v[92:93], v96, s[40:43], s26 offen sc1
  v_cvt_pk_bf16_f32 v88, v48, v49
  v_cvt_pk_bf16_f32 v89, v50, v51
  v_subrev_u32 v97, 73728, v8
  v_lshrrev_b32 v97, 1, v97
  v_add_u32 v97, 81920, v97
  ds_write_b64 v97, v[88:89]
  s_lshr_b32 s26, s30, 1
  s_add_u32 s26, s26, s45
  s_add_u32 s26, s26, s18
  v_lshrrev_b32 v96, 1, v1
  buffer_store_dwordx2 v[88:89], v96, s[40:43], s26 offen sc1
  v_cvt_pk_bf16_f32 v92, v52, v53
  v_cvt_pk_bf16_f32 v93, v54, v55
  v_subrev_u32 v97, 73728, v9
  v_lshrrev_b32 v97, 1, v97
  v_add_u32 v97, 81920, v97
  ds_write_b64 v97, v[92:93]
  s_lshr_b32 s26, s31, 1
  s_add_u32 s26, s26, s45
  s_add_u32 s26, s26, s19
  v_lshrrev_b32 v96, 1, v1
  buffer_store_dwordx2 v[92:93], v96, s[40:43], s26 offen sc1
  s_waitcnt lgkmcnt(0)
  s_barrier
  s_waitcnt vmcnt(4)
  v_cmp_ne_u32 vcc, s6, v21
  s_nop 3
  s_cbranch_vccz L50_ok
  s_mov_b32 s7, 262144
L51_poll:
  buffer_load_dword v21, v22, s[52:55], s27 offen sc1
  s_waitcnt vmcnt(0)
  v_cmp_ne_u32 vcc, s6, v21
  s_sub_u32 s7, s7, 1
  s_cmp_eq_u32 s7, 0
  s_cbranch_scc1 L52_pollx
  s_nop 0
  s_cbranch_vccnz L51_poll
L52_pollx:
L50_ok:
  s_waitcnt vmcnt(0)
  s_add_u32 s26, s36, 12288
  s_mov_b64 exec, 1
  v_mov_b32 v107, s6
  buffer_store_dword v107, off, s[52:55], s26 sc1
  s_mov_b64 exec, -1
  s_lshl_b32 s26, s3, 10
  s_add_u32 s26, s26, 73728
  v_add_u32 v99, s26, v1
  ds_read_b128 v[108:111], v99 offset:0
  v_add_u32 v98, 0, v156
  buffer_load_dwordx4 v[112:115], v98, s[40:43], s8 offen sc1
  buffer_load_dwordx4 v[116:119], v98, s[40:43], s9 offen sc1
  buffer_load_dwordx4 v[120:123], v98, s[40:43], s10 offen sc1
  buffer_load_dwordx4 v[124:127], v98, s[40:43], s11 offen sc1
  buffer_load_dwordx4 v[128:131], v98, s[40:43], s12 offen sc1
  buffer_load_dwordx4 v[132:135], v98, s[40:43], s13 offen sc1
  buffer_load_dwordx4 v[136:139], v98, s[40:43], s14 offen sc1
  s_add_u32 s27, s37, 12288
  buffer_load_dword v21, v22, s[52:55], s27 offen sc1
  ds_read_b64_tr_b16 v[72:73], v19 offset:0
  ds_read_b64_tr_b16 v[74:75], v19 offset:512
  s_waitcnt lgkmcnt(2)
  v_lshlrev_b32 v56, 16, v108
  v_and_b32 v57, s48, v108
  v_lshlrev_b32 v58, 16, v109
  v_and_b32 v59, s48, v109
  v_lshlrev_b32 v60, 16, v110
  v_and_b32 v61, s48, v110
  v_lshlrev_b32 v62, 16, v111
  v_and_b32 v63, s48, v111
  s_waitcnt vmcnt(7)
  v_lshlrev_b32 v64, 16, v112
  v_and_b32 v65, s48, v112
  v_lshlrev_b32 v66, 16, v113
  v_and_b32 v67, s48, v113
  v_lshlrev_b32 v68, 16, v114
  v_and_b32 v69, s48, v114
  v_lshlrev_b32 v70, 16, v115
  v_and_b32 v71, s48, v115
  v_pk_add_f32 v[56:57], v[56:57], v[64:65]
  v_pk_add_f32 v[58:59], v[58:59], v[66:67]
  v_pk_add_f32 v[60:61], v[60:61], v[68:69]
  v_pk_add_f32 v[62:63], v[62:63], v[70:71]
  s_waitcnt vmcnt(6)
  v_lshlrev_b32 v64, 16, v116
  v_and_b32 v65, s48, v116
  v_lshlrev_b32 v66, 16, v117
  v_and_b32 v67, s48, v117
  v_lshlrev_b32 v68, 16, v118
  v_and_b32 v69, s48, v118
  v_lshlrev_b32 v70, 16, v119
  v_and_b32 v71, s48, v119
  v_pk_add_f32 v[56:57], v[56:57], v[64:65]
  v_pk_add_f32 v[58:59], v[58:59], v[66:67]
  v_pk_add_f32 v[60:61], v[60:61], v[68:69]
  v_pk_add_f32 v[62:63], v[62:63], v[70:71]
  s_waitcnt vmcnt(5)
  v_lshlrev_b32 v64, 16, v120
  v_and_b32 v65, s48, v120
  v_lshlrev_b32 v66, 16, v121
  v_and_b32 v67, s48, v121
  v_lshlrev_b32 v68, 16, v122
  v_and_b32 v69, s48, v122
  v_lshlrev_b32 v70, 16, v123
  v_and_b32 v71, s48, v123
  v_pk_add_f32 v[56:57], v[56:57], v[64:65]
  v_pk_add_f32 v[58:59], v[58:59], v[66:67]
  v_pk_add_f32 v[60:61], v[60:61], v[68:69]
  v_pk_add_f32 v[62:63], v[62:63], v[70:71]
  s_waitcnt vmcnt(4)
  v_lshlrev_b32 v64, 16, v124
  v_and_b32 v65, s48, v124
  v_lshlrev_b32 v66, 16, v125
  v_and_b32 v67, s48, v125
  v_lshlrev_b32 v68, 16, v126
  v_and_b32 v69, s48, v126
  v_lshlrev_b32 v70, 16, v127
  v_and_b32 v71, s48, v127
  v_pk_add_f32 v[56:57], v[56:57], v[64:65]
  v_pk_add_f32 v[58:59], v[58:59], v[66:67]
  v_pk_add_f32 v[60:61], v[60:61], v[68:69]
  v_pk_add_f32 v[62:63], v[62:63], v[70:71]
  s_waitcnt vmcnt(3)
  v_lshlrev_b32 v64, 16, v128
  v_and_b32 v65, s48, v128
  v_lshlrev_b32 v66, 16, v129
  v_and_b32 v67, s48, v129
  v_lshlrev_b32 v68, 16, v130
  v_and_b32 v69, s48, v130
  v_lshlrev_b32 v70, 16, v131
  v_and_b32 v71, s48, v131
  v_pk_add_f32 v[56:57], v[56:57], v[64:65]
  v_pk_add_f32 v[58:59], v[58:59], v[66:67]
  v_pk_add_f32 v[60:61], v[60:61], v[68:69]
  v_pk_add_f32 v[62:63], v[62:63], v[70:71]
  s_waitcnt vmcnt(2)
  v_lshlrev_b32 v64, 16, v132
  v_and_b32 v65, s48, v132
  v_lshlrev_b32 v66, 16, v133
  v_and_b32 v67, s48, v133
  v_lshlrev_b32 v68, 16, v134
  v_and_b32 v69, s48, v134
  v_lshlrev_b32 v70, 16, v135
  v_and_b32 v71, s48, v135
  v_pk_add_f32 v[56:57], v[56:57], v[64:65]
  v_pk_add_f32 v[58:59], v[58:59], v[66:67]
  v_pk_add_f32 v[60:61], v[60:61], v[68:69]
  v_pk_add_f32 v[62:63], v[62:63], v[70:71]
  s_waitcnt vmcnt(1)
  v_lshlrev_b32 v64, 16, v136
  v_and_b32 v65, s48, v136
  v_lshlrev_b32 v66, 16, v137
  v_and_b32 v67, s48, v137
  v_lshlrev_b32 v68, 16, v138
  v_and_b32 v69, s48, v138
  v_lshlrev_b32 v70, 16, v139
  v_and_b32 v71, s48, v139
  v_pk_add_f32 v[56:57], v[56:57], v[64:65]
  v_pk_add_f32 v[58:59], v[58:59], v[66:67]
  v_pk_add_f32 v[60:61], v[60:61], v[68:69]
  v_pk_add_f32 v[62:63], v[62:63], v[70:71]
  s_waitcnt lgkmcnt(1)
  v_lshlrev_b32 v64, 16, v72
  v_and_b32 v65, s48, v72
  v_lshlrev_b32 v66, 16, v73
  v_and_b32 v67, s48, v73
  s_waitcnt lgkmcnt(0)
  v_lshlrev_b32 v68, 16, v74
  v_and_b32 v69, s48, v74
  v_lshlrev_b32 v70, 16, v75
  v_and_b32 v71, s48, v75
  v_fma_f32 v56, v56, s60, v64
  v_fma_f32 v57, v57, s60, v65
  v_fma_f32 v58, v58, s60, v66
  v_fma_f32 v59, v59, s60, v67
  v_fma_f32 v60, v60, s60, v68
  v_fma_f32 v61, v61, s60, v69
  v_fma_f32 v62, v62, s60, v70
  v_fma_f32 v63, v63, s60, v71
  v_cvt_pk_bf16_f32 v56, v56, v57
  v_cvt_pk_bf16_f32 v57, v58, v59
  v_cvt_pk_bf16_f32 v58, v60, v61
  v_cvt_pk_bf16_f32 v59, v62, v63
  buffer_store_dwordx4 v[56:59], v158, s[56:59], 0 offen offset:0
  s_waitcnt vmcnt(1)
  v_cmp_ne_u32 vcc, s6, v21
  s_nop 3
  s_cbranch_vccz L53_ok
  s_mov_b32 s7, 262144
L54_poll:
  buffer_load_dword v21, v22, s[52:55], s27 offen sc1
  s_waitcnt vmcnt(0)
  v_cmp_ne_u32 vcc, s6, v21
  s_sub_u32 s7, s7, 1
  s_cmp_eq_u32 s7, 0
  s_cbranch_scc1 L55_pollx
  s_nop 0
  s_cbranch_vccnz L54_poll
L55_pollx:
L53_ok:
  s_lshl_b32 s26, s3, 10
  s_add_u32 s26, s26, 73728
  v_add_u32 v99, s26, v1
  ds_read_b128 v[24:27], v99 offset:4096
  v_add_u32 v98, 8192, v156
  buffer_load_dwordx4 v[28:31], v98, s[40:43], s8 offen sc1
  buffer_load_dwordx4 v[32:35], v98, s[40:43], s9 offen sc1
  buffer_load_dwordx4 v[36:39], v98, s[40:43], s10 offen sc1
  buffer_load_dwordx4 v[40:43], v98, s[40:43], s11 offen sc1
  buffer_load_dwordx4 v[44:47], v98, s[40:43], s12 offen sc1
  buffer_load_dwordx4 v[48:51], v98, s[40:43], s13 offen sc1
  buffer_load_dwordx4 v[52:55], v98, s[40:43], s14 offen sc1
  s_lshr_b32 s26, s3, 1
  s_lshl_b32 s26, s26, 9
  s_and_b32 s27, s3, 1
  s_lshl_b32 s27, s27, 6
  s_add_u32 s26, s26, s27
  s_add_u32 s26, s26, 81920
  v_and_b32 v96, 15, v0
  v_lshrrev_b32 v97, 4, v0
  v_lshlrev_b32 v97, 7, v97
  v_lshl_add_u32 v96, v96, 2, v97
  v_add_u32 v96, s26, v96
  ds_read_b32 v160, v96
  buffer_load_dword v161, v157, s[40:43], s8 offen sc1
  buffer_load_dword v162, v157, s[40:43], s9 offen sc1
  buffer_load_dword v163, v157, s[40:43], s10 offen sc1
  buffer_load_dword v164, v157, s[40:43], s11 offen sc1
  buffer_load_dword v165, v157, s[40:43], s12 offen sc1
  buffer_load_dword v166, v157, s[40:43], s13 offen sc1
  buffer_load_dword v167, v157, s[40:43], s14 offen sc1
  ds_read_b64_tr_b16 v[72:73], v19 offset:8192
  ds_read_b64_tr_b16 v[74:75], v19 offset:8704
  s_waitcnt lgkmcnt(3)
  v_lshlrev_b32 v76, 16, v24
  v_and_b32 v77, s48, v24
  v_lshlrev_b32 v78, 16, v25
  v_and_b32 v79, s48, v25
  v_lshlrev_b32 v80, 16, v26
  v_and_b32 v81, s48, v26
  v_lshlrev_b32 v82, 16, v27
  v_and_b32 v83, s48, v27
  s_waitcnt vmcnt(13)
  v_lshlrev_b32 v64, 16, v28
  v_and_b32 v65, s48, v28
  v_lshlrev_b32 v66, 16, v29
  v_and_b32 v67, s48, v29
  v_lshlrev_b32 v68, 16, v30
  v_and_b32 v69, s48, v30
  v_lshlrev_b32 v70, 16, v31
  v_and_b32 v71, s48, v31
  v_pk_add_f32 v[76:77], v[76:77], v[64:65]
  v_pk_add_f32 v[78:79], v[78:79], v[66:67]
  v_pk_add_f32 v[80:81], v[80:81], v[68:69]
  v_pk_add_f32 v[82:83], v[82:83], v[70:71]
  s_waitcnt vmcnt(12)
  v_lshlrev_b32 v64, 16, v32
  v_and_b32 v65, s48, v32
  v_lshlrev_b32 v66, 16, v33
  v_and_b32 v67, s48, v33
  v_lshlrev_b32 v68, 16, v34
  v_and_b32 v69, s48, v34
  v_lshlrev_b32 v70, 16, v35
  v_and_b32 v71, s48, v35
  v_pk_add_f32 v[76:77], v[76:77], v[64:65]
  v_pk_add_f32 v[78:79], v[78:79], v[66:67]
  v_pk_add_f32 v[80:81], v[80:81], v[68:69]
  v_pk_add_f32 v[82:83], v[82:83], v[70:71]
  s_waitcnt vmcnt(11)
  v_lshlrev_b32 v64, 16, v36
  v_and_b32 v65, s48, v36
  v_lshlrev_b32 v66, 16, v37
  v_and_b32 v67, s48, v37
  v_lshlrev_b32 v68, 16, v38
  v_and_b32 v69, s48, v38
  v_lshlrev_b32 v70, 16, v39
  v_and_b32 v71, s48, v39
  v_pk_add_f32 v[76:77], v[76:77], v[64:65]
  v_pk_add_f32 v[78:79], v[78:79], v[66:67]
  v_pk_add_f32 v[80:81], v[80:81], v[68:69]
  v_pk_add_f32 v[82:83], v[82:83], v[70:71]
  s_waitcnt vmcnt(10)
  v_lshlrev_b32 v64, 16, v40
  v_and_b32 v65, s48, v40
  v_lshlrev_b32 v66, 16, v41
  v_and_b32 v67, s48, v41
  v_lshlrev_b32 v68, 16, v42
  v_and_b32 v69, s48, v42
  v_lshlrev_b32 v70, 16, v43
  v_and_b32 v71, s48, v43
  v_pk_add_f32 v[76:77], v[76:77], v[64:65]
  v_pk_add_f32 v[78:79], v[78:79], v[66:67]
  v_pk_add_f32 v[80:81], v[80:81], v[68:69]
  v_pk_add_f32 v[82:83], v[82:83], v[70:71]
  s_waitcnt vmcnt(9)
  v_lshlrev_b32 v64, 16, v44
  v_and_b32 v65, s48, v44
  v_lshlrev_b32 v66, 16, v45
  v_and_b32 v67, s48, v45
  v_lshlrev_b32 v68, 16, v46
  v_and_b32 v69, s48, v46
  v_lshlrev_b32 v70, 16, v47
  v_and_b32 v71, s48, v47
  v_pk_add_f32 v[76:77], v[76:77], v[64:65]
  v_pk_add_f32 v[78:79], v[78:79], v[66:67]
  v_pk_add_f32 v[80:81], v[80:81], v[68:69]
  v_pk_add_f32 v[82:83], v[82:83], v[70:71]
  s_waitcnt vmcnt(8)
  v_lshlrev_b32 v64, 16, v48
  v_and_b32 v65, s48, v48
  v_lshlrev_b32 v66, 16, v49
  v_and_b32 v67, s48, v49
  v_lshlrev_b32 v68, 16, v50
  v_and_b32 v69, s48, v50
  v_lshlrev_b32 v70, 16, v51
  v_and_b32 v71, s48, v51
  v_pk_add_f32 v[76:77], v[76:77], v[64:65]
  v_pk_add_f32 v[78:79], v[78:79], v[66:67]
  v_pk_add_f32 v[80:81], v[80:81], v[68:69]
  v_pk_add_f32 v[82:83], v[82:83], v[70:71]
  s_waitcnt vmcnt(7)
  v_lshlrev_b32 v64, 16, v52
  v_and_b32 v65, s48, v52
  v_lshlrev_b32 v66, 16, v53
  v_and_b32 v67, s48, v53
  v_lshlrev_b32 v68, 16, v54
  v_and_b32 v69, s48, v54
  v_lshlrev_b32 v70, 16, v55
  v_and_b32 v71, s48, v55
  v_pk_add_f32 v[76:77], v[76:77], v[64:65]
  v_pk_add_f32 v[78:79], v[78:79], v[66:67]
  v_pk_add_f32 v[80:81], v[80:81], v[68:69]
  v_pk_add_f32 v[82:83], v[82:83], v[70:71]
  s_waitcnt lgkmcnt(1)
  v_lshlrev_b32 v64, 16, v72
  v_and_b32 v65, s48, v72
  v_lshlrev_b32 v66, 16, v73
  v_and_b32 v67, s48, v73
  s_waitcnt lgkmcnt(0)
  v_lshlrev_b32 v68, 16, v74
  v_and_b32 v69, s48, v74
  v_lshlrev_b32 v70, 16, v75
  v_and_b32 v71, s48, v75
  v_fma_f32 v76, v76, s60, v64
  v_fma_f32 v77, v77, s60, v65
  v_fma_f32 v78, v78, s60, v66
  v_fma_f32 v79, v79, s60, v67
  v_fma_f32 v80, v80, s60, v68
  v_fma_f32 v81, v81, s60, v69
  v_fma_f32 v82, v82, s60, v70
  v_fma_f32 v83, v83, s60, v71
  v_cvt_pk_bf16_f32 v76, v76, v77
  v_cvt_pk_bf16_f32 v77, v78, v79
  v_cvt_pk_bf16_f32 v78, v80, v81
  v_cvt_pk_bf16_f32 v79, v82, v83
  buffer_store_dwordx4 v[76:79], v158, s[56:59], 0 offen offset:128
  ds_read_u16_d16_hi v180, v23 offset:0
  ds_read_u16_d16_hi v181, v23 offset:128
  v_lshlrev_b32 v176, 16, v160
  v_and_b32 v177, s48, v160
  s_waitcnt vmcnt(7)
  v_lshlrev_b32 v96, 16, v161
  v_and_b32 v97, s48, v161
  v_add_f32 v176, v176, v96
  v_add_f32 v177, v177, v97
  s_waitcnt vmcnt(6)
  v_lshlrev_b32 v96, 16, v162
  v_and_b32 v97, s48, v162
  v_add_f32 v176, v176, v96
  v_add_f32 v177, v177, v97
  s_waitcnt vmcnt(5)
  v_lshlrev_b32 v96, 16, v163
  v_and_b32 v97, s48, v163
  v_add_f32 v176, v176, v96
  v_add_f32 v177, v177, v97
  s_waitcnt vmcnt(4)
  v_lshlrev_b32 v96, 16, v164
  v_and_b32 v97, s48, v164
  v_add_f32 v176, v176, v96
  v_add_f32 v177, v177, v97
  s_waitcnt vmcnt(3)
  v_lshlrev_b32 v96, 16, v165
  v_and_b32 v97, s48, v165
  v_add_f32 v176, v176, v96
  v_add_f32 v177, v177, v97
  s_waitcnt vmcnt(2)
  v_lshlrev_b32 v96, 16, v166
  v_and_b32 v97, s48, v166
  v_add_f32 v176, v176, v96
  v_add_f32 v177, v177, v97
  s_waitcnt vmcnt(1)
  v_lshlrev_b32 v96, 16, v167
  v_and_b32 v97, s48, v167
  v_add_f32 v176, v176, v96
  v_add_f32 v177, v177, v97
  s_waitcnt lgkmcnt(1)
  v_fma_f32 v176, v176, s60, v180
  s_waitcnt lgkmcnt(0)
  v_fma_f32 v177, v177, s60, v181
  v_cvt_pk_bf16_f32 v176, v176, v177
  buffer_store_dword v176, v159, s[56:59], 0 offen
code_pf_end:
L_end:
  s_endpgm
.section .rodata,"a"
.p2align 6
.amdhsa_kernel sequential_preLN__ssm_conv_h3__dense_activation_mish__prompt_kernel
  .amdhsa_next_free_vgpr 512
  .amdhsa_next_free_sgpr 102
  .amdhsa_accum_offset 256
  .amdhsa_group_segment_fixed_size 0
  .amdhsa_kernarg_size 104
  .amdhsa_user_sgpr_count 2
  .amdhsa_user_sgpr_kernarg_segment_ptr 1
  .amdhsa_system_sgpr_workgroup_id_x 1
  .amdhsa_float_denorm_mode_32 3
.end_amdhsa_kernel
```
